```python
import torch

def _softmax(x, axis=-1):
    return torch.softmax(x, dim=axis)
def _gelu(x):
    return torch.nn.functional.gelu(x, approximate="tanh")
def _silu(x):
    return torch.nn.functional.silu(x)
def _sigmoid(x):
    return torch.sigmoid(x)
def _layernorm(x, axis=-1, eps=1e-5):
    m = x.mean(dim=axis, keepdim=True)
    v = x.var(dim=axis, keepdim=True, unbiased=False)
    return (x - m) / torch.sqrt(v + eps)
def _scatter_add(tgt, idx, src, axis=0):
    return tgt.clone().index_add_(axis, idx, src)
def _segment_sum(src, seg, n):
    out = torch.zeros((n,) + src.shape[1:], dtype=src.dtype)
    return out.index_add_(0, seg, src)
def _pad(x, pw):
    flat = tuple(v for pair in reversed(pw) for v in pair)
    return torch.nn.functional.pad(x, flat)

kernel_name = 'concat_heads__mha_block_cached__mha_block_cached__near_ridge'

def setup_inputs():

    _w = (lambda a: (lambda t: t.to(torch.bfloat16) if t.is_floating_point() else t)(torch.as_tensor(a)))
    def _A_setup():
        B, Sq, D = 16, 192, 512
        H, Sk, Dh = 32, 512, 128
        return {
            "x": _w((lambda *s: torch.randn(*s, dtype=torch.bfloat16) * 0.8)(B, Sq, D)),
            "k_cache": _w((lambda *s: torch.randn(*s, dtype=torch.bfloat16) * 0.8)(B, H, Sk, Dh)),
            "v_cache": _w((lambda *s: torch.randn(*s, dtype=torch.bfloat16) * 0.05)(B, H, Sk, Dh)),
            "wq": _w((lambda *s: torch.randn(*s, dtype=torch.bfloat16) * 0.8)(D, H * Dh) * (D ** -0.5)),
            "wo": _w((lambda *s: torch.randn(*s, dtype=torch.bfloat16) * 0.05)(H * Dh, D) * ((H * Dh) ** -0.5)),
        }
    _A_in = _A_setup()

    def _B_setup():
        B, Sq, D = 16, 192, 512
        H, Sk, Dh = 32, 512, 128
        return {
            "x": _w((lambda *s: torch.randn(*s, dtype=torch.bfloat16) * 0.8)(B, Sq, D)),
            "k_cache": _w((lambda *s: torch.randn(*s, dtype=torch.bfloat16) * 0.8)(B, H, Sk, Dh)),
            "v_cache": _w((lambda *s: torch.randn(*s, dtype=torch.bfloat16) * 0.05)(B, H, Sk, Dh)),
            "wq": _w((lambda *s: torch.randn(*s, dtype=torch.bfloat16) * 0.8)(D, H * Dh) * (D ** -0.5)),
            "wo": _w((lambda *s: torch.randn(*s, dtype=torch.bfloat16) * 0.05)(H * Dh, D) * ((H * Dh) ** -0.5)),
        }
    _B_in = _B_setup()

    return {
        "A_x": _A_in["x"],
        "A_k_cache": _A_in["k_cache"],
        "A_v_cache": _A_in["v_cache"],
        "A_wq": _A_in["wq"],
        "A_wo": _A_in["wo"],
        "B_x": _B_in["x"],
        "B_k_cache": _B_in["k_cache"],
        "B_v_cache": _B_in["v_cache"],
        "B_wq": _B_in["wq"],
        "B_wo": _B_in["wo"],
    }

def reference(A_x, A_k_cache, A_v_cache, A_wq, A_wo, B_x, B_k_cache, B_v_cache, B_wq, B_wo):
    def _A_ref(x, k_cache, v_cache, wq, wo):
        B, Sq, D = x.shape
        H, Dh = 32, 128
        q = (lambda x, *d: x.permute(*d))((x @ wq).reshape(B, Sq, H, Dh), 0, 2, 1, 3)
        scores = torch.einsum("bhqd,bhkd->bhqk", q, k_cache) * (Dh ** -0.5)
        p = _softmax(scores, axis=-1)
        o = torch.einsum("bhqk,bhkd->bhqd", p, v_cache)
        return (lambda x, *d: x.permute(*d))(o, 0, 2, 1, 3).reshape(B, Sq, H * Dh) @ wo

    def _B_ref(x, k_cache, v_cache, wq, wo):
        B, Sq, D = x.shape
        H, Dh = 32, 128
        q = (lambda x, *d: x.permute(*d))((x @ wq).reshape(B, Sq, H, Dh), 0, 2, 1, 3)
        scores = torch.einsum("bhqd,bhkd->bhqk", q, k_cache) * (Dh ** -0.5)
        p = _softmax(scores, axis=-1)
        o = torch.einsum("bhqk,bhkd->bhqd", p, v_cache)
        return (lambda x, *d: x.permute(*d))(o, 0, 2, 1, 3).reshape(B, Sq, H * Dh) @ wo

    a = _A_ref(A_x, A_k_cache, A_v_cache, A_wq, A_wo)
    b = _B_ref(B_x, B_k_cache, B_v_cache, B_wq, B_wo)
    return torch.concatenate([a, b], axis=-1)
```

```asm
; @launch grid=(256,1,1) block=(256,1,1) lds=159808
.amdgcn_target "amdgcn-amd-amdhsa--gfx950"
.text
.globl concat_heads__mha_block_cached__mha_block_cached__near_ridge_kernel
.p2align 8
.type concat_heads__mha_block_cached__mha_block_cached__near_ridge_kernel,@function
concat_heads__mha_block_cached__mha_block_cached__near_ridge_kernel:
    s_cmp_ge_u32 s2, 256
    s_cbranch_scc1 A_EXIT
    s_load_dwordx8 s[32:39], s[0:1], 0
    s_load_dwordx8 s[40:47], s[0:1], 40
    s_load_dwordx2 s[48:49], s[0:1], 96
    s_load_dwordx2 s[84:85], s[0:1], 32
    s_load_dwordx2 s[86:87], s[0:1], 72
    s_load_dwordx2 s[100:101], s[0:1], 88
    s_and_b32 s50, s2, 7
    s_lshr_b32 s51, s2, 3
    s_lshr_b32 s64, s50, 2
    s_and_b32 s55, s50, 3
    s_lshr_b32 s58, s51, 3
    s_lshl_b32 s55, s55, 2
    s_add_u32 s67, s55, s58
    s_and_b32 s65, s51, 7
    s_lshl_b32 s31, s65, 2
    s_getpc_b64 s[70:71]
A_PC:
    s_mul_i32 s72, s51, 12
    v_add_u32 v8, s72, v0
    v_cmp_gt_u32 vcc, 12, v0
    s_nop 3
    s_mov_b64 s[72:73], vcc
    v_cmp_gt_u32 vcc, (A_CODE_END-A_PC)/128, v8
    s_nop 3
    s_and_b64 vcc, vcc, s[72:73]
    v_lshlrev_b32 v8, 7, v8
    s_and_saveexec_b64 s[72:73], vcc
    s_cbranch_execz A_NOCPF
    global_load_dword v9, v8, s[70:71]
A_NOCPF:
    s_mov_b64 exec, s[72:73]
    v_lshrrev_b32 v8, 6, v0
    s_nop 0
    v_readfirstlane_b32 s24, v8
    v_and_b32 v0, 63, v0
    s_waitcnt lgkmcnt(0)
    s_cmp_eq_u32 s64, 0
    s_cselect_b64 s[32:33], s[32:33], s[40:41]
    s_cselect_b64 s[34:35], s[34:35], s[42:43]
    s_cselect_b64 s[36:37], s[36:37], s[44:45]
    s_cselect_b64 s[38:39], s[38:39], s[46:47]
    s_cselect_b64 s[84:85], s[84:85], s[86:87]
    s_mul_i32 s55, s67, 0x30000
    s_add_u32 s4, s32, s55
    s_addc_u32 s5, s33, 0
    s_and_b32 s5, s5, 0xffff
    s_mov_b32 s6, 0x30000
    s_mov_b32 s7, 0x20000
    s_lshl_b32 s55, s31, 8
    s_add_u32 s8, s38, s55
    s_addc_u32 s9, s39, 0
    s_and_b32 s9, s9, 0xffff
    s_sub_u32 s10, 0x400000, s55
    s_mov_b32 s11, 0x20000
    s_lshl_b32 s55, s67, 5
    s_add_u32 s55, s55, s31
    s_lshl_b32 s55, s55, 17
    s_add_u32 s12, s34, s55
    s_addc_u32 s13, s35, 0
    s_and_b32 s13, s13, 0xffff
    s_mov_b32 s14, 0x80000
    s_mov_b32 s15, 0x20000
    s_add_u32 s16, s36, s55
    s_addc_u32 s17, s37, 0
    s_and_b32 s17, s17, 0xffff
    s_mov_b32 s18, 0x80000
    s_mov_b32 s19, 0x20000
    s_lshl_b32 s55, s64, 4
    s_add_u32 s55, s55, s67
    s_mul_i32 s55, s55, 0x180000
    s_add_u32 s20, s48, s55
    s_addc_u32 s21, s49, 0
    s_and_b32 s21, s21, 0xffff
    s_mov_b32 s22, 0x180000
    s_mov_b32 s23, 0x20000
    s_mul_i32 s25, s24, 2112
    s_mul_i32 s26, s24, 2056
    s_mov_b32 s28, 16384
    s_mov_b32 s29, 32768
    s_mov_b32 s52, 0
    s_mov_b32 s53, 131072
    s_mov_b32 s54, 262144
    s_mov_b32 s30, 0
    s_mov_b32 s62, 0
    s_mov_b32 s63, 0
    s_mov_b32 s60, 0x3e0293ee
    s_mov_b32 s61, 0x3e0293ee
    v_and_b32 v16, 15, v0
    v_lshrrev_b32 v17, 4, v0
    v_bfe_u32 v18, v0, 2, 2
    v_and_b32 v19, 3, v0
    s_mul_i32 s55, s24, 48
    v_lshrrev_b32 v20, 2, v0
    v_add_u32 v20, s55, v20
    v_lshlrev_b32 v20, 10, v20
    v_lshrrev_b32 v21, 5, v0
    v_mul_u32_u24 v21, 3, v21
    v_xor_b32 v21, v21, v19
    v_lshl_add_u32 v64, v21, 4, v20
    v_lshrrev_b32 v21, 3, v16
    v_mul_u32_u24 v21, 3, v21
    v_xor_b32 v21, v21, v17
    v_lshlrev_b32 v20, 6, v16
    v_lshl_add_u32 v20, v21, 4, v20
    s_mul_i32 s59, s24, 6144
    s_add_u32 s59, s59, 135168
    v_add_u32 v65, s59, v20
    v_subrev_u32 v66, 135168, v65
    s_lshl_b32 s55, s24, 3
    v_add_u32 v20, s55, v18
    v_lshlrev_b32 v21, 13, v20
    v_lshl_add_u32 v21, v17, 6, v21
    v_lshl_add_u32 v5, v19, 4, v21
    v_lshlrev_b32 v21, 8, v20
    v_lshl_add_u32 v21, v17, 6, v21
    v_lshl_add_u32 v4, v19, 4, v21
    v_mul_u32_u24 v20, 2056, v17
    v_lshl_add_u32 v20, v18, 6, v20
    v_lshl_add_u32 v3, v19, 4, v20
    v_lshrrev_b32 v20, 2, v16
    v_mul_u32_u24 v20, 1056, v20
    v_and_b32 v21, 3, v16
    v_lshl_add_u32 v20, v21, 6, v20
    v_lshl_add_u32 v1, v17, 4, v20
    v_mul_u32_u24 v20, 1056, v17
    v_lshl_add_u32 v20, v18, 6, v20
    v_lshl_add_u32 v2, v19, 3, v20
    v_add_u32 v2, 50688, v2
    s_mul_i32 s55, s24, 393216
    s_lshl_b32 s58, s31, 12
    s_add_u32 s55, s55, s58
    v_lshlrev_b32 v20, 4, v0
    v_add_u32 v6, s55, v20
    v_mov_b32 v12, 0x3f803f80
    v_mov_b32 v13, 0x3f803f80
    v_mov_b32 v14, 0x3f803f80
    v_mov_b32 v15, 0x3f803f80
    v_mov_b32 v24, 0
    v_mov_b32 v25, 0
    v_mov_b32 v26, 0
    v_mov_b32 v27, 0
    v_mov_b32 v20, 159744
    ds_write_b128 v20, v[24:27]
    s_mul_i32 s55, s65, 24
    s_mul_i32 s58, s24, 6
    s_add_u32 s55, s55, s58
    v_lshrrev_b32 v20, 3, v0
    v_add_u32 v20, s55, v20
    v_lshlrev_b32 v20, 10, v20
    v_and_b32 v21, 7, v0
    v_lshl_add_u32 v20, v21, 7, v20
    v_cmp_gt_u32 vcc, 48, v0
    v_mov_b32 v21, 0x7fffffff
    s_nop 0
    v_cndmask_b32 v20, v21, v20, vcc
    buffer_load_dword v22, v20, s[4:7], 0 offen
    s_and_b32 s55, s67, 3
    s_mul_i32 s55, s55, 128
    s_mul_i32 s58, s24, 32
    s_add_u32 s55, s55, s58
    v_lshrrev_b32 v20, 1, v0
    v_add_u32 v20, s55, v20
    v_lshlrev_b32 v20, 13, v20
    v_and_b32 v21, 1, v0
    v_lshl_add_u32 v20, v21, 7, v20
    buffer_load_dword v23, v20, s[8:11], 0 offen
    s_add_u32 m0, s59, 0
    s_mov_b32 s27, 0
    buffer_load_dwordx4 v64, s[4:7], s27 offen lds
    s_add_u32 m0, s59, 1024
    s_mov_b32 s27, 64
    buffer_load_dwordx4 v64, s[4:7], s27 offen lds
    s_add_u32 m0, s59, 2048
    s_mov_b32 s27, 16384
    buffer_load_dwordx4 v64, s[4:7], s27 offen lds
    s_add_u32 m0, s59, 3072
    s_mov_b32 s27, 16448
    buffer_load_dwordx4 v64, s[4:7], s27 offen lds
    s_add_u32 m0, s59, 4096
    s_mov_b32 s27, 32768
    buffer_load_dwordx4 v64, s[4:7], s27 offen lds
    s_add_u32 m0, s59, 5120
    s_mov_b32 s27, 32832
    buffer_load_dwordx4 v64, s[4:7], s27 offen lds
    s_add_u32 m0, s26, 126720
    s_add_u32 s27, s63, 0
    buffer_load_dwordx4 v5, s[8:11], s27 offen lds
    s_add_u32 m0, s26, 127744
    s_add_u32 s27, s63, 32768
    buffer_load_dwordx4 v5, s[8:11], s27 offen lds
    s_add_u32 m0, s26, 118272
    s_add_u32 s27, s63, 262144
    buffer_load_dwordx4 v5, s[8:11], s27 offen lds
    s_add_u32 m0, s26, 119296
    s_add_u32 s27, s63, 294912
    buffer_load_dwordx4 v5, s[8:11], s27 offen lds
    s_add_u32 m0, s26, 109824
    s_add_u32 s27, s63, 524288
    buffer_load_dwordx4 v5, s[8:11], s27 offen lds
    s_add_u32 m0, s26, 110848
    s_add_u32 s27, s63, 557056
    buffer_load_dwordx4 v5, s[8:11], s27 offen lds
    s_add_u32 m0, s26, 101376
    s_add_u32 s27, s63, 786432
    buffer_load_dwordx4 v5, s[8:11], s27 offen lds
    s_add_u32 m0, s26, 102400
    s_add_u32 s27, s63, 819200
    buffer_load_dwordx4 v5, s[8:11], s27 offen lds
    s_add_u32 m0, s26, 92928
    s_add_u32 s27, s63, 1048576
    buffer_load_dwordx4 v5, s[8:11], s27 offen lds
    s_add_u32 m0, s26, 93952
    s_add_u32 s27, s63, 1081344
    buffer_load_dwordx4 v5, s[8:11], s27 offen lds
    s_add_u32 m0, s26, 67584
    s_add_u32 s27, s63, 1310720
    buffer_load_dwordx4 v5, s[8:11], s27 offen lds
    s_add_u32 m0, s26, 68608
    s_add_u32 s27, s63, 1343488
    buffer_load_dwordx4 v5, s[8:11], s27 offen lds
    s_add_u32 m0, s26, 59136
    s_add_u32 s27, s63, 1572864
    buffer_load_dwordx4 v5, s[8:11], s27 offen lds
    s_add_u32 m0, s26, 60160
    s_add_u32 s27, s63, 1605632
    buffer_load_dwordx4 v5, s[8:11], s27 offen lds
    s_add_u32 m0, s25, 84480
    s_add_u32 s27, s62, 0
    buffer_load_dwordx4 v4, s[12:15], s27 offen nt lds
    s_add_u32 m0, s25, 84512
    s_nop 0
    buffer_load_dwordx4 v4, s[12:15], s27 offen offset:1024 nt lds
    s_add_u32 m0, s25, 76032
    s_add_u32 s27, s62, 8192
    buffer_load_dwordx4 v4, s[12:15], s27 offen nt lds
    s_add_u32 m0, s25, 76064
    s_nop 0
    buffer_load_dwordx4 v4, s[12:15], s27 offen offset:1024 nt lds
    s_waitcnt vmcnt(16)
    s_barrier
    ds_read_b128 a[0:3], v65 offset:0
    ds_read_b128 a[12:15], v65 offset:1024
    ds_read_b128 a[4:7], v65 offset:2048
    ds_read_b128 a[16:19], v65 offset:3072
    ds_read_b128 a[8:11], v65 offset:4096
    ds_read_b128 a[20:23], v65 offset:5120
    v_add_u32 v3, 0x1ef00, v3
    ds_read_b64_tr_b16 a[192:193], v3 offset:0
    ds_read_b64_tr_b16 a[194:195], v3 offset:1024
    ds_read_b64_tr_b16 a[196:197], v3 offset:8
    ds_read_b64_tr_b16 a[198:199], v3 offset:1032
    ds_read_b64_tr_b16 a[200:201], v3 offset:256
    ds_read_b64_tr_b16 a[202:203], v3 offset:1280
    ds_read_b64_tr_b16 a[204:205], v3 offset:264
    ds_read_b64_tr_b16 a[206:207], v3 offset:1288
    ds_read_b64_tr_b16 a[208:209], v3 offset:512
    ds_read_b64_tr_b16 a[210:211], v3 offset:1536
    ds_read_b64_tr_b16 a[212:213], v3 offset:520
    ds_read_b64_tr_b16 a[214:215], v3 offset:1544
    ds_read_b64_tr_b16 a[216:217], v3 offset:768
    ds_read_b64_tr_b16 a[218:219], v3 offset:1792
    ds_read_b64_tr_b16 a[220:221], v3 offset:776
    ds_read_b64_tr_b16 a[222:223], v3 offset:1800
    s_waitcnt lgkmcnt(0)
    s_waitcnt vmcnt(12)
    s_barrier
    v_mfma_f32_16x16x32_bf16 v[160:163], a[192:195], a[0:3], 0
    s_add_u32 m0, s59, 0
    s_mov_b32 s27, 128
    buffer_load_dwordx4 v64, s[4:7], s27 offen lds
    s_add_u32 m0, s59, 1024
    s_mov_b32 s27, 192
    buffer_load_dwordx4 v64, s[4:7], s27 offen lds
    s_add_u32 m0, s59, 2048
    s_mov_b32 s27, 16512
    buffer_load_dwordx4 v64, s[4:7], s27 offen lds
    s_add_u32 m0, s59, 3072
    s_mov_b32 s27, 16576
    buffer_load_dwordx4 v64, s[4:7], s27 offen lds
    s_add_u32 m0, s59, 4096
    s_mov_b32 s27, 32896
    buffer_load_dwordx4 v64, s[4:7], s27 offen lds
    s_add_u32 m0, s59, 5120
    s_mov_b32 s27, 32960
    buffer_load_dwordx4 v64, s[4:7], s27 offen lds
    v_add_u32 v3, 0xffffdf00, v3
    v_mfma_f32_16x16x32_bf16 v[164:167], a[192:195], a[4:7], 0
    ds_read_b64_tr_b16 a[224:225], v3 offset:0
    v_mfma_f32_16x16x32_bf16 v[168:171], a[192:195], a[8:11], 0
    ds_read_b64_tr_b16 a[226:227], v3 offset:1024
    v_mfma_f32_16x16x32_bf16 v[172:175], a[196:199], a[0:3], 0
    ds_read_b64_tr_b16 a[228:229], v3 offset:8
    v_mfma_f32_16x16x32_bf16 v[176:179], a[196:199], a[4:7], 0
    ds_read_b64_tr_b16 a[230:231], v3 offset:1032
    v_mfma_f32_16x16x32_bf16 v[180:183], a[196:199], a[8:11], 0
    ds_read_b64_tr_b16 a[232:233], v3 offset:256
    v_mfma_f32_16x16x32_bf16 v[184:187], a[200:203], a[0:3], 0
    ds_read_b64_tr_b16 a[234:235], v3 offset:1280
    s_add_u32 m0, s26, 126720
    v_mfma_f32_16x16x32_bf16 v[188:191], a[200:203], a[4:7], 0
    ds_read_b64_tr_b16 a[236:237], v3 offset:264
    s_add_u32 s27, s63, 1835008
    v_mfma_f32_16x16x32_bf16 v[192:195], a[200:203], a[8:11], 0
    ds_read_b64_tr_b16 a[238:239], v3 offset:1288
    buffer_load_dwordx4 v5, s[8:11], s27 offen lds
    v_mfma_f32_16x16x32_bf16 v[196:199], a[204:207], a[0:3], 0
    ds_read_b64_tr_b16 a[240:241], v3 offset:512
    v_mfma_f32_16x16x32_bf16 v[200:203], a[204:207], a[4:7], 0
    ds_read_b64_tr_b16 a[242:243], v3 offset:1536
    v_mfma_f32_16x16x32_bf16 v[204:207], a[204:207], a[8:11], 0
    ds_read_b64_tr_b16 a[244:245], v3 offset:520
    v_mfma_f32_16x16x32_bf16 v[208:211], a[208:211], a[0:3], 0
    ds_read_b64_tr_b16 a[246:247], v3 offset:1544
    v_mfma_f32_16x16x32_bf16 v[212:215], a[208:211], a[4:7], 0
    ds_read_b64_tr_b16 a[248:249], v3 offset:768
    v_mfma_f32_16x16x32_bf16 v[216:219], a[208:211], a[8:11], 0
    ds_read_b64_tr_b16 a[250:251], v3 offset:1792
    v_mfma_f32_16x16x32_bf16 v[220:223], a[212:215], a[0:3], 0
    ds_read_b64_tr_b16 a[252:253], v3 offset:776
    v_mfma_f32_16x16x32_bf16 v[224:227], a[212:215], a[4:7], 0
    ds_read_b64_tr_b16 a[254:255], v3 offset:1800
    s_add_u32 m0, s26, 127744
    v_mfma_f32_16x16x32_bf16 v[228:231], a[212:215], a[8:11], 0
    s_add_u32 s27, s63, 1867776
    v_mfma_f32_16x16x32_bf16 v[232:235], a[216:219], a[0:3], 0
    buffer_load_dwordx4 v5, s[8:11], s27 offen lds
    v_mfma_f32_16x16x32_bf16 v[236:239], a[216:219], a[4:7], 0
    v_mfma_f32_16x16x32_bf16 v[240:243], a[216:219], a[8:11], 0
    v_mfma_f32_16x16x32_bf16 v[244:247], a[220:223], a[0:3], 0
    v_mfma_f32_16x16x32_bf16 v[248:251], a[220:223], a[4:7], 0
    v_mfma_f32_16x16x32_bf16 v[252:255], a[220:223], a[8:11], 0
    s_waitcnt lgkmcnt(0)
    v_mfma_f32_16x16x32_bf16 v[160:163], a[224:227], a[12:15], v[160:163]
    v_add_u32 v3, 0xffffdf00, v3
    v_mfma_f32_16x16x32_bf16 v[164:167], a[224:227], a[16:19], v[164:167]
    ds_read_b64_tr_b16 a[192:193], v3 offset:0
    v_mfma_f32_16x16x32_bf16 v[168:171], a[224:227], a[20:23], v[168:171]
    ds_read_b64_tr_b16 a[194:195], v3 offset:1024
    v_mfma_f32_16x16x32_bf16 v[172:175], a[228:231], a[12:15], v[172:175]
    ds_read_b64_tr_b16 a[196:197], v3 offset:8
    v_mfma_f32_16x16x32_bf16 v[176:179], a[228:231], a[16:19], v[176:179]
    ds_read_b64_tr_b16 a[198:199], v3 offset:1032
    v_mfma_f32_16x16x32_bf16 v[180:183], a[228:231], a[20:23], v[180:183]
    ds_read_b64_tr_b16 a[200:201], v3 offset:256
    v_mfma_f32_16x16x32_bf16 v[184:187], a[232:235], a[12:15], v[184:187]
    ds_read_b64_tr_b16 a[202:203], v3 offset:1280
    s_add_u32 m0, s26, 50688
    v_mfma_f32_16x16x32_bf16 v[188:191], a[232:235], a[16:19], v[188:191]
    ds_read_b64_tr_b16 a[204:205], v3 offset:264
    s_add_u32 s27, s63, 2097152
    v_mfma_f32_16x16x32_bf16 v[192:195], a[232:235], a[20:23], v[192:195]
    ds_read_b64_tr_b16 a[206:207], v3 offset:1288
    buffer_load_dwordx4 v5, s[8:11], s27 offen lds
    v_mfma_f32_16x16x32_bf16 v[196:199], a[236:239], a[12:15], v[196:199]
    ds_read_b64_tr_b16 a[208:209], v3 offset:512
    v_mfma_f32_16x16x32_bf16 v[200:203], a[236:239], a[16:19], v[200:203]
    ds_read_b64_tr_b16 a[210:211], v3 offset:1536
    v_mfma_f32_16x16x32_bf16 v[204:207], a[236:239], a[20:23], v[204:207]
    ds_read_b64_tr_b16 a[212:213], v3 offset:520
    v_mfma_f32_16x16x32_bf16 v[208:211], a[240:243], a[12:15], v[208:211]
    ds_read_b64_tr_b16 a[214:215], v3 offset:1544
    v_mfma_f32_16x16x32_bf16 v[212:215], a[240:243], a[16:19], v[212:215]
    ds_read_b64_tr_b16 a[216:217], v3 offset:768
    v_mfma_f32_16x16x32_bf16 v[216:219], a[240:243], a[20:23], v[216:219]
    ds_read_b64_tr_b16 a[218:219], v3 offset:1792
    v_mfma_f32_16x16x32_bf16 v[220:223], a[244:247], a[12:15], v[220:223]
    ds_read_b64_tr_b16 a[220:221], v3 offset:776
    v_mfma_f32_16x16x32_bf16 v[224:227], a[244:247], a[16:19], v[224:227]
    ds_read_b64_tr_b16 a[222:223], v3 offset:1800
    s_add_u32 m0, s26, 51712
    v_mfma_f32_16x16x32_bf16 v[228:231], a[244:247], a[20:23], v[228:231]
    s_add_u32 s27, s63, 2129920
    v_mfma_f32_16x16x32_bf16 v[232:235], a[248:251], a[12:15], v[232:235]
    buffer_load_dwordx4 v5, s[8:11], s27 offen lds
    s_waitcnt vmcnt(4)
    ds_read_b128 a[24:27], v65 offset:0
    ds_read_b128 a[36:39], v65 offset:1024
    ds_read_b128 a[28:31], v65 offset:2048
    ds_read_b128 a[40:43], v65 offset:3072
    ds_read_b128 a[32:35], v65 offset:4096
    ds_read_b128 a[44:47], v65 offset:5120
    v_mfma_f32_16x16x32_bf16 v[236:239], a[248:251], a[16:19], v[236:239]
    v_mfma_f32_16x16x32_bf16 v[240:243], a[248:251], a[20:23], v[240:243]
    v_mfma_f32_16x16x32_bf16 v[244:247], a[252:255], a[12:15], v[244:247]
    v_mfma_f32_16x16x32_bf16 v[248:251], a[252:255], a[16:19], v[248:251]
    v_mfma_f32_16x16x32_bf16 v[252:255], a[252:255], a[20:23], v[252:255]
    s_waitcnt lgkmcnt(6)
    s_barrier
    s_waitcnt lgkmcnt(5)
    v_mfma_f32_16x16x32_bf16 v[160:163], a[192:195], a[24:27], v[160:163]
    s_waitcnt lgkmcnt(0)
    s_add_u32 m0, s59, 0
    s_mov_b32 s27, 256
    buffer_load_dwordx4 v64, s[4:7], s27 offen lds
    s_add_u32 m0, s59, 1024
    s_mov_b32 s27, 320
    buffer_load_dwordx4 v64, s[4:7], s27 offen lds
    s_add_u32 m0, s59, 2048
    s_mov_b32 s27, 16640
    buffer_load_dwordx4 v64, s[4:7], s27 offen lds
    s_add_u32 m0, s59, 3072
    s_mov_b32 s27, 16704
    buffer_load_dwordx4 v64, s[4:7], s27 offen lds
    s_add_u32 m0, s59, 4096
    s_mov_b32 s27, 33024
    buffer_load_dwordx4 v64, s[4:7], s27 offen lds
    s_add_u32 m0, s59, 5120
    s_mov_b32 s27, 33088
    buffer_load_dwordx4 v64, s[4:7], s27 offen lds
    v_add_u32 v3, 0xffffdf00, v3
    v_mfma_f32_16x16x32_bf16 v[164:167], a[192:195], a[28:31], v[164:167]
    ds_read_b64_tr_b16 a[224:225], v3 offset:0
    v_mfma_f32_16x16x32_bf16 v[168:171], a[192:195], a[32:35], v[168:171]
    ds_read_b64_tr_b16 a[226:227], v3 offset:1024
    v_mfma_f32_16x16x32_bf16 v[172:175], a[196:199], a[24:27], v[172:175]
    ds_read_b64_tr_b16 a[228:229], v3 offset:8
    v_mfma_f32_16x16x32_bf16 v[176:179], a[196:199], a[28:31], v[176:179]
    ds_read_b64_tr_b16 a[230:231], v3 offset:1032
    v_mfma_f32_16x16x32_bf16 v[180:183], a[196:199], a[32:35], v[180:183]
    ds_read_b64_tr_b16 a[232:233], v3 offset:256
    v_mfma_f32_16x16x32_bf16 v[184:187], a[200:203], a[24:27], v[184:187]
    ds_read_b64_tr_b16 a[234:235], v3 offset:1280
    s_add_u32 m0, s26, 118272
    v_mfma_f32_16x16x32_bf16 v[188:191], a[200:203], a[28:31], v[188:191]
    ds_read_b64_tr_b16 a[236:237], v3 offset:264
    s_add_u32 s27, s63, 2359296
    v_mfma_f32_16x16x32_bf16 v[192:195], a[200:203], a[32:35], v[192:195]
    ds_read_b64_tr_b16 a[238:239], v3 offset:1288
    buffer_load_dwordx4 v5, s[8:11], s27 offen lds
    v_mfma_f32_16x16x32_bf16 v[196:199], a[204:207], a[24:27], v[196:199]
    ds_read_b64_tr_b16 a[240:241], v3 offset:512
    v_mfma_f32_16x16x32_bf16 v[200:203], a[204:207], a[28:31], v[200:203]
    ds_read_b64_tr_b16 a[242:243], v3 offset:1536
    v_mfma_f32_16x16x32_bf16 v[204:207], a[204:207], a[32:35], v[204:207]
    ds_read_b64_tr_b16 a[244:245], v3 offset:520
    v_mfma_f32_16x16x32_bf16 v[208:211], a[208:211], a[24:27], v[208:211]
    ds_read_b64_tr_b16 a[246:247], v3 offset:1544
    v_mfma_f32_16x16x32_bf16 v[212:215], a[208:211], a[28:31], v[212:215]
    ds_read_b64_tr_b16 a[248:249], v3 offset:768
    v_mfma_f32_16x16x32_bf16 v[216:219], a[208:211], a[32:35], v[216:219]
    ds_read_b64_tr_b16 a[250:251], v3 offset:1792
    v_mfma_f32_16x16x32_bf16 v[220:223], a[212:215], a[24:27], v[220:223]
    ds_read_b64_tr_b16 a[252:253], v3 offset:776
    v_mfma_f32_16x16x32_bf16 v[224:227], a[212:215], a[28:31], v[224:227]
    ds_read_b64_tr_b16 a[254:255], v3 offset:1800
    s_add_u32 m0, s26, 119296
    v_mfma_f32_16x16x32_bf16 v[228:231], a[212:215], a[32:35], v[228:231]
    s_add_u32 s27, s63, 2392064
    v_mfma_f32_16x16x32_bf16 v[232:235], a[216:219], a[24:27], v[232:235]
    buffer_load_dwordx4 v5, s[8:11], s27 offen lds
    v_mfma_f32_16x16x32_bf16 v[236:239], a[216:219], a[28:31], v[236:239]
    v_mfma_f32_16x16x32_bf16 v[240:243], a[216:219], a[32:35], v[240:243]
    v_mfma_f32_16x16x32_bf16 v[244:247], a[220:223], a[24:27], v[244:247]
    v_mfma_f32_16x16x32_bf16 v[248:251], a[220:223], a[28:31], v[248:251]
    v_mfma_f32_16x16x32_bf16 v[252:255], a[220:223], a[32:35], v[252:255]
    s_waitcnt lgkmcnt(0)
    v_mfma_f32_16x16x32_bf16 v[160:163], a[224:227], a[36:39], v[160:163]
    v_add_u32 v3, 0xffffdf00, v3
    v_mfma_f32_16x16x32_bf16 v[164:167], a[224:227], a[40:43], v[164:167]
    ds_read_b64_tr_b16 a[192:193], v3 offset:0
    v_mfma_f32_16x16x32_bf16 v[168:171], a[224:227], a[44:47], v[168:171]
    ds_read_b64_tr_b16 a[194:195], v3 offset:1024
    v_mfma_f32_16x16x32_bf16 v[172:175], a[228:231], a[36:39], v[172:175]
    ds_read_b64_tr_b16 a[196:197], v3 offset:8
    v_mfma_f32_16x16x32_bf16 v[176:179], a[228:231], a[40:43], v[176:179]
    ds_read_b64_tr_b16 a[198:199], v3 offset:1032
    v_mfma_f32_16x16x32_bf16 v[180:183], a[228:231], a[44:47], v[180:183]
    ds_read_b64_tr_b16 a[200:201], v3 offset:256
    v_mfma_f32_16x16x32_bf16 v[184:187], a[232:235], a[36:39], v[184:187]
    ds_read_b64_tr_b16 a[202:203], v3 offset:1280
    s_add_u32 m0, s26, 109824
    v_mfma_f32_16x16x32_bf16 v[188:191], a[232:235], a[40:43], v[188:191]
    ds_read_b64_tr_b16 a[204:205], v3 offset:264
    s_add_u32 s27, s63, 2621440
    v_mfma_f32_16x16x32_bf16 v[192:195], a[232:235], a[44:47], v[192:195]
    ds_read_b64_tr_b16 a[206:207], v3 offset:1288
    buffer_load_dwordx4 v5, s[8:11], s27 offen lds
    v_mfma_f32_16x16x32_bf16 v[196:199], a[236:239], a[36:39], v[196:199]
    ds_read_b64_tr_b16 a[208:209], v3 offset:512
    v_mfma_f32_16x16x32_bf16 v[200:203], a[236:239], a[40:43], v[200:203]
    ds_read_b64_tr_b16 a[210:211], v3 offset:1536
    v_mfma_f32_16x16x32_bf16 v[204:207], a[236:239], a[44:47], v[204:207]
    ds_read_b64_tr_b16 a[212:213], v3 offset:520
    v_mfma_f32_16x16x32_bf16 v[208:211], a[240:243], a[36:39], v[208:211]
    ds_read_b64_tr_b16 a[214:215], v3 offset:1544
    v_mfma_f32_16x16x32_bf16 v[212:215], a[240:243], a[40:43], v[212:215]
    ds_read_b64_tr_b16 a[216:217], v3 offset:768
    v_mfma_f32_16x16x32_bf16 v[216:219], a[240:243], a[44:47], v[216:219]
    ds_read_b64_tr_b16 a[218:219], v3 offset:1792
    v_mfma_f32_16x16x32_bf16 v[220:223], a[244:247], a[36:39], v[220:223]
    ds_read_b64_tr_b16 a[220:221], v3 offset:776
    v_mfma_f32_16x16x32_bf16 v[224:227], a[244:247], a[40:43], v[224:227]
    ds_read_b64_tr_b16 a[222:223], v3 offset:1800
    s_add_u32 m0, s26, 110848
    v_mfma_f32_16x16x32_bf16 v[228:231], a[244:247], a[44:47], v[228:231]
    s_add_u32 s27, s63, 2654208
    v_mfma_f32_16x16x32_bf16 v[232:235], a[248:251], a[36:39], v[232:235]
    buffer_load_dwordx4 v5, s[8:11], s27 offen lds
    s_waitcnt vmcnt(4)
    ds_read_b128 a[48:51], v65 offset:0
    ds_read_b128 a[60:63], v65 offset:1024
    ds_read_b128 a[52:55], v65 offset:2048
    ds_read_b128 a[64:67], v65 offset:3072
    ds_read_b128 a[56:59], v65 offset:4096
    ds_read_b128 a[68:71], v65 offset:5120
    v_mfma_f32_16x16x32_bf16 v[236:239], a[248:251], a[40:43], v[236:239]
    v_mfma_f32_16x16x32_bf16 v[240:243], a[248:251], a[44:47], v[240:243]
    v_mfma_f32_16x16x32_bf16 v[244:247], a[252:255], a[36:39], v[244:247]
    v_mfma_f32_16x16x32_bf16 v[248:251], a[252:255], a[40:43], v[248:251]
    v_mfma_f32_16x16x32_bf16 v[252:255], a[252:255], a[44:47], v[252:255]
    s_waitcnt lgkmcnt(6)
    s_barrier
    s_waitcnt lgkmcnt(5)
    v_mfma_f32_16x16x32_bf16 v[160:163], a[192:195], a[48:51], v[160:163]
    s_waitcnt lgkmcnt(0)
    s_add_u32 m0, s59, 0
    s_mov_b32 s27, 384
    buffer_load_dwordx4 v64, s[4:7], s27 offen lds
    s_add_u32 m0, s59, 1024
    s_mov_b32 s27, 448
    buffer_load_dwordx4 v64, s[4:7], s27 offen lds
    s_add_u32 m0, s59, 2048
    s_mov_b32 s27, 16768
    buffer_load_dwordx4 v64, s[4:7], s27 offen lds
    s_add_u32 m0, s59, 3072
    s_mov_b32 s27, 16832
    buffer_load_dwordx4 v64, s[4:7], s27 offen lds
    s_add_u32 m0, s59, 4096
    s_mov_b32 s27, 33152
    buffer_load_dwordx4 v64, s[4:7], s27 offen lds
    s_add_u32 m0, s59, 5120
    s_mov_b32 s27, 33216
    buffer_load_dwordx4 v64, s[4:7], s27 offen lds
    v_add_u32 v3, 0xffff9d00, v3
    v_mfma_f32_16x16x32_bf16 v[164:167], a[192:195], a[52:55], v[164:167]
    ds_read_b64_tr_b16 a[224:225], v3 offset:0
    v_mfma_f32_16x16x32_bf16 v[168:171], a[192:195], a[56:59], v[168:171]
    ds_read_b64_tr_b16 a[226:227], v3 offset:1024
    v_mfma_f32_16x16x32_bf16 v[172:175], a[196:199], a[48:51], v[172:175]
    ds_read_b64_tr_b16 a[228:229], v3 offset:8
    s_add_u32 m0, s26, 101376
    v_mfma_f32_16x16x32_bf16 v[176:179], a[196:199], a[52:55], v[176:179]
    ds_read_b64_tr_b16 a[230:231], v3 offset:1032
    s_add_u32 s27, s63, 2883584
    v_mfma_f32_16x16x32_bf16 v[180:183], a[196:199], a[56:59], v[180:183]
    ds_read_b64_tr_b16 a[232:233], v3 offset:256
    buffer_load_dwordx4 v5, s[8:11], s27 offen lds
    v_mfma_f32_16x16x32_bf16 v[184:187], a[200:203], a[48:51], v[184:187]
    ds_read_b64_tr_b16 a[234:235], v3 offset:1280
    v_mfma_f32_16x16x32_bf16 v[188:191], a[200:203], a[52:55], v[188:191]
    ds_read_b64_tr_b16 a[236:237], v3 offset:264
    v_mfma_f32_16x16x32_bf16 v[192:195], a[200:203], a[56:59], v[192:195]
    ds_read_b64_tr_b16 a[238:239], v3 offset:1288
    s_add_u32 m0, s26, 102400
    v_mfma_f32_16x16x32_bf16 v[196:199], a[204:207], a[48:51], v[196:199]
    ds_read_b64_tr_b16 a[240:241], v3 offset:512
    s_add_u32 s27, s63, 2916352
    v_mfma_f32_16x16x32_bf16 v[200:203], a[204:207], a[52:55], v[200:203]
    ds_read_b64_tr_b16 a[242:243], v3 offset:1536
    buffer_load_dwordx4 v5, s[8:11], s27 offen lds
    v_mfma_f32_16x16x32_bf16 v[204:207], a[204:207], a[56:59], v[204:207]
    ds_read_b64_tr_b16 a[244:245], v3 offset:520
    v_mfma_f32_16x16x32_bf16 v[208:211], a[208:211], a[48:51], v[208:211]
    ds_read_b64_tr_b16 a[246:247], v3 offset:1544
    v_mfma_f32_16x16x32_bf16 v[212:215], a[208:211], a[52:55], v[212:215]
    ds_read_b64_tr_b16 a[248:249], v3 offset:768
    s_add_u32 m0, s26, 92928
    v_mfma_f32_16x16x32_bf16 v[216:219], a[208:211], a[56:59], v[216:219]
    ds_read_b64_tr_b16 a[250:251], v3 offset:1792
    s_add_u32 s27, s63, 3145728
    v_mfma_f32_16x16x32_bf16 v[220:223], a[212:215], a[48:51], v[220:223]
    ds_read_b64_tr_b16 a[252:253], v3 offset:776
    buffer_load_dwordx4 v5, s[8:11], s27 offen lds
    v_mfma_f32_16x16x32_bf16 v[224:227], a[212:215], a[52:55], v[224:227]
    ds_read_b64_tr_b16 a[254:255], v3 offset:1800
    v_mfma_f32_16x16x32_bf16 v[228:231], a[212:215], a[56:59], v[228:231]
    v_mfma_f32_16x16x32_bf16 v[232:235], a[216:219], a[48:51], v[232:235]
    s_add_u32 m0, s26, 93952
    v_mfma_f32_16x16x32_bf16 v[236:239], a[216:219], a[52:55], v[236:239]
    s_add_u32 s27, s63, 3178496
    v_mfma_f32_16x16x32_bf16 v[240:243], a[216:219], a[56:59], v[240:243]
    buffer_load_dwordx4 v5, s[8:11], s27 offen lds
    v_mfma_f32_16x16x32_bf16 v[244:247], a[220:223], a[48:51], v[244:247]
    v_mfma_f32_16x16x32_bf16 v[248:251], a[220:223], a[52:55], v[248:251]
    v_mfma_f32_16x16x32_bf16 v[252:255], a[220:223], a[56:59], v[252:255]
    s_waitcnt lgkmcnt(0)
    v_mfma_f32_16x16x32_bf16 v[160:163], a[224:227], a[60:63], v[160:163]
    v_add_u32 v3, 0xffffdf00, v3
    v_mfma_f32_16x16x32_bf16 v[164:167], a[224:227], a[64:67], v[164:167]
    ds_read_b64_tr_b16 a[192:193], v3 offset:0
    v_mfma_f32_16x16x32_bf16 v[168:171], a[224:227], a[68:71], v[168:171]
    ds_read_b64_tr_b16 a[194:195], v3 offset:1024
    v_mfma_f32_16x16x32_bf16 v[172:175], a[228:231], a[60:63], v[172:175]
    ds_read_b64_tr_b16 a[196:197], v3 offset:8
    v_mfma_f32_16x16x32_bf16 v[176:179], a[228:231], a[64:67], v[176:179]
    ds_read_b64_tr_b16 a[198:199], v3 offset:1032
    v_mfma_f32_16x16x32_bf16 v[180:183], a[228:231], a[68:71], v[180:183]
    ds_read_b64_tr_b16 a[200:201], v3 offset:256
    v_mfma_f32_16x16x32_bf16 v[184:187], a[232:235], a[60:63], v[184:187]
    ds_read_b64_tr_b16 a[202:203], v3 offset:1280
    s_add_u32 m0, s25, 42240
    v_mfma_f32_16x16x32_bf16 v[188:191], a[232:235], a[64:67], v[188:191]
    ds_read_b64_tr_b16 a[204:205], v3 offset:264
    s_add_u32 s27, s62, 16384
    v_mfma_f32_16x16x32_bf16 v[192:195], a[232:235], a[68:71], v[192:195]
    ds_read_b64_tr_b16 a[206:207], v3 offset:1288
    buffer_load_dwordx4 v4, s[12:15], s27 offen nt lds
    v_mfma_f32_16x16x32_bf16 v[196:199], a[236:239], a[60:63], v[196:199]
    ds_read_b64_tr_b16 a[208:209], v3 offset:512
    v_mfma_f32_16x16x32_bf16 v[200:203], a[236:239], a[64:67], v[200:203]
    ds_read_b64_tr_b16 a[210:211], v3 offset:1536
    v_mfma_f32_16x16x32_bf16 v[204:207], a[236:239], a[68:71], v[204:207]
    ds_read_b64_tr_b16 a[212:213], v3 offset:520
    v_mfma_f32_16x16x32_bf16 v[208:211], a[240:243], a[60:63], v[208:211]
    ds_read_b64_tr_b16 a[214:215], v3 offset:1544
    v_mfma_f32_16x16x32_bf16 v[212:215], a[240:243], a[64:67], v[212:215]
    ds_read_b64_tr_b16 a[216:217], v3 offset:768
    v_mfma_f32_16x16x32_bf16 v[216:219], a[240:243], a[68:71], v[216:219]
    ds_read_b64_tr_b16 a[218:219], v3 offset:1792
    v_mfma_f32_16x16x32_bf16 v[220:223], a[244:247], a[60:63], v[220:223]
    ds_read_b64_tr_b16 a[220:221], v3 offset:776
    v_mfma_f32_16x16x32_bf16 v[224:227], a[244:247], a[64:67], v[224:227]
    ds_read_b64_tr_b16 a[222:223], v3 offset:1800
    v_mfma_f32_16x16x32_bf16 v[228:231], a[244:247], a[68:71], v[228:231]
    s_add_u32 m0, s25, 42272
    v_mfma_f32_16x16x32_bf16 v[232:235], a[248:251], a[60:63], v[232:235]
    buffer_load_dwordx4 v4, s[12:15], s27 offen offset:1024 nt lds
    s_waitcnt vmcnt(6)
    ds_read_b128 a[72:75], v65 offset:0
    ds_read_b128 a[84:87], v65 offset:1024
    ds_read_b128 a[76:79], v65 offset:2048
    ds_read_b128 a[88:91], v65 offset:3072
    ds_read_b128 a[80:83], v65 offset:4096
    ds_read_b128 a[92:95], v65 offset:5120
    v_mfma_f32_16x16x32_bf16 v[236:239], a[248:251], a[64:67], v[236:239]
    v_mfma_f32_16x16x32_bf16 v[240:243], a[248:251], a[68:71], v[240:243]
    v_mfma_f32_16x16x32_bf16 v[244:247], a[252:255], a[60:63], v[244:247]
    v_mfma_f32_16x16x32_bf16 v[248:251], a[252:255], a[64:67], v[248:251]
    v_mfma_f32_16x16x32_bf16 v[252:255], a[252:255], a[68:71], v[252:255]
    s_waitcnt lgkmcnt(6)
    s_barrier
    s_waitcnt lgkmcnt(5)
    v_mfma_f32_16x16x32_bf16 v[160:163], a[192:195], a[72:75], v[160:163]
    s_waitcnt lgkmcnt(0)
    s_add_u32 m0, s59, 0
    s_mov_b32 s27, 512
    buffer_load_dwordx4 v64, s[4:7], s27 offen lds
    s_add_u32 m0, s59, 1024
    s_mov_b32 s27, 576
    buffer_load_dwordx4 v64, s[4:7], s27 offen lds
    s_add_u32 m0, s59, 2048
    s_mov_b32 s27, 16896
    buffer_load_dwordx4 v64, s[4:7], s27 offen lds
    s_add_u32 m0, s59, 3072
    s_mov_b32 s27, 16960
    buffer_load_dwordx4 v64, s[4:7], s27 offen lds
    s_add_u32 m0, s59, 4096
    s_mov_b32 s27, 33280
    buffer_load_dwordx4 v64, s[4:7], s27 offen lds
    s_add_u32 m0, s59, 5120
    s_mov_b32 s27, 33344
    buffer_load_dwordx4 v64, s[4:7], s27 offen lds
    v_add_u32 v3, 0x10800, v3
    v_mfma_f32_16x16x32_bf16 v[164:167], a[192:195], a[76:79], v[164:167]
    ds_read_b64_tr_b16 a[224:225], v3 offset:0
    v_mfma_f32_16x16x32_bf16 v[168:171], a[192:195], a[80:83], v[168:171]
    ds_read_b64_tr_b16 a[226:227], v3 offset:1024
    v_mfma_f32_16x16x32_bf16 v[172:175], a[196:199], a[72:75], v[172:175]
    ds_read_b64_tr_b16 a[228:229], v3 offset:8
    s_add_u32 m0, s26, 67584
    v_mfma_f32_16x16x32_bf16 v[176:179], a[196:199], a[76:79], v[176:179]
    ds_read_b64_tr_b16 a[230:231], v3 offset:1032
    s_add_u32 s27, s63, 3407872
    v_mfma_f32_16x16x32_bf16 v[180:183], a[196:199], a[80:83], v[180:183]
    ds_read_b64_tr_b16 a[232:233], v3 offset:256
    buffer_load_dwordx4 v5, s[8:11], s27 offen lds
    v_mfma_f32_16x16x32_bf16 v[184:187], a[200:203], a[72:75], v[184:187]
    ds_read_b64_tr_b16 a[234:235], v3 offset:1280
    v_mfma_f32_16x16x32_bf16 v[188:191], a[200:203], a[76:79], v[188:191]
    ds_read_b64_tr_b16 a[236:237], v3 offset:264
    v_mfma_f32_16x16x32_bf16 v[192:195], a[200:203], a[80:83], v[192:195]
    ds_read_b64_tr_b16 a[238:239], v3 offset:1288
    s_add_u32 m0, s26, 68608
    v_mfma_f32_16x16x32_bf16 v[196:199], a[204:207], a[72:75], v[196:199]
    ds_read_b64_tr_b16 a[240:241], v3 offset:512
    s_add_u32 s27, s63, 3440640
    v_mfma_f32_16x16x32_bf16 v[200:203], a[204:207], a[76:79], v[200:203]
    ds_read_b64_tr_b16 a[242:243], v3 offset:1536
    buffer_load_dwordx4 v5, s[8:11], s27 offen lds
    v_mfma_f32_16x16x32_bf16 v[204:207], a[204:207], a[80:83], v[204:207]
    ds_read_b64_tr_b16 a[244:245], v3 offset:520
    v_mfma_f32_16x16x32_bf16 v[208:211], a[208:211], a[72:75], v[208:211]
    ds_read_b64_tr_b16 a[246:247], v3 offset:1544
    v_mfma_f32_16x16x32_bf16 v[212:215], a[208:211], a[76:79], v[212:215]
    ds_read_b64_tr_b16 a[248:249], v3 offset:768
    s_add_u32 m0, s26, 59136
    v_mfma_f32_16x16x32_bf16 v[216:219], a[208:211], a[80:83], v[216:219]
    ds_read_b64_tr_b16 a[250:251], v3 offset:1792
    s_add_u32 s27, s63, 3670016
    v_mfma_f32_16x16x32_bf16 v[220:223], a[212:215], a[72:75], v[220:223]
    ds_read_b64_tr_b16 a[252:253], v3 offset:776
    buffer_load_dwordx4 v5, s[8:11], s27 offen lds
    v_mfma_f32_16x16x32_bf16 v[224:227], a[212:215], a[76:79], v[224:227]
    ds_read_b64_tr_b16 a[254:255], v3 offset:1800
    v_mfma_f32_16x16x32_bf16 v[228:231], a[212:215], a[80:83], v[228:231]
    v_mfma_f32_16x16x32_bf16 v[232:235], a[216:219], a[72:75], v[232:235]
    s_add_u32 m0, s26, 60160
    v_mfma_f32_16x16x32_bf16 v[236:239], a[216:219], a[76:79], v[236:239]
    s_add_u32 s27, s63, 3702784
    v_mfma_f32_16x16x32_bf16 v[240:243], a[216:219], a[80:83], v[240:243]
    buffer_load_dwordx4 v5, s[8:11], s27 offen lds
    v_mfma_f32_16x16x32_bf16 v[244:247], a[220:223], a[72:75], v[244:247]
    v_mfma_f32_16x16x32_bf16 v[248:251], a[220:223], a[76:79], v[248:251]
    v_mfma_f32_16x16x32_bf16 v[252:255], a[220:223], a[80:83], v[252:255]
    s_waitcnt lgkmcnt(0)
    v_mfma_f32_16x16x32_bf16 v[160:163], a[224:227], a[84:87], v[160:163]
    v_add_u32 v3, 0xfffed700, v3
    v_mfma_f32_16x16x32_bf16 v[164:167], a[224:227], a[88:91], v[164:167]
    ds_read_b64_tr_b16 a[192:193], v3 offset:0
    v_mfma_f32_16x16x32_bf16 v[168:171], a[224:227], a[92:95], v[168:171]
    ds_read_b64_tr_b16 a[194:195], v3 offset:1024
    v_mfma_f32_16x16x32_bf16 v[172:175], a[228:231], a[84:87], v[172:175]
    ds_read_b64_tr_b16 a[196:197], v3 offset:8
    v_mfma_f32_16x16x32_bf16 v[176:179], a[228:231], a[88:91], v[176:179]
    ds_read_b64_tr_b16 a[198:199], v3 offset:1032
    v_mfma_f32_16x16x32_bf16 v[180:183], a[228:231], a[92:95], v[180:183]
    ds_read_b64_tr_b16 a[200:201], v3 offset:256
    v_mfma_f32_16x16x32_bf16 v[184:187], a[232:235], a[84:87], v[184:187]
    ds_read_b64_tr_b16 a[202:203], v3 offset:1280
    s_add_u32 m0, s25, 33792
    v_mfma_f32_16x16x32_bf16 v[188:191], a[232:235], a[88:91], v[188:191]
    ds_read_b64_tr_b16 a[204:205], v3 offset:264
    s_add_u32 s27, s62, 0
    v_mfma_f32_16x16x32_bf16 v[192:195], a[232:235], a[92:95], v[192:195]
    ds_read_b64_tr_b16 a[206:207], v3 offset:1288
    buffer_load_dwordx4 v4, s[16:19], s27 offen nt lds
    v_mfma_f32_16x16x32_bf16 v[196:199], a[236:239], a[84:87], v[196:199]
    ds_read_b64_tr_b16 a[208:209], v3 offset:512
    v_mfma_f32_16x16x32_bf16 v[200:203], a[236:239], a[88:91], v[200:203]
    ds_read_b64_tr_b16 a[210:211], v3 offset:1536
    v_mfma_f32_16x16x32_bf16 v[204:207], a[236:239], a[92:95], v[204:207]
    ds_read_b64_tr_b16 a[212:213], v3 offset:520
    v_mfma_f32_16x16x32_bf16 v[208:211], a[240:243], a[84:87], v[208:211]
    ds_read_b64_tr_b16 a[214:215], v3 offset:1544
    v_mfma_f32_16x16x32_bf16 v[212:215], a[240:243], a[88:91], v[212:215]
    ds_read_b64_tr_b16 a[216:217], v3 offset:768
    v_mfma_f32_16x16x32_bf16 v[216:219], a[240:243], a[92:95], v[216:219]
    ds_read_b64_tr_b16 a[218:219], v3 offset:1792
    v_mfma_f32_16x16x32_bf16 v[220:223], a[244:247], a[84:87], v[220:223]
    ds_read_b64_tr_b16 a[220:221], v3 offset:776
    v_mfma_f32_16x16x32_bf16 v[224:227], a[244:247], a[88:91], v[224:227]
    ds_read_b64_tr_b16 a[222:223], v3 offset:1800
    v_mfma_f32_16x16x32_bf16 v[228:231], a[244:247], a[92:95], v[228:231]
    s_add_u32 m0, s25, 33824
    v_mfma_f32_16x16x32_bf16 v[232:235], a[248:251], a[84:87], v[232:235]
    buffer_load_dwordx4 v4, s[16:19], s27 offen offset:1024 nt lds
    s_waitcnt vmcnt(6)
    ds_read_b128 a[96:99], v65 offset:0
    ds_read_b128 a[108:111], v65 offset:1024
    ds_read_b128 a[100:103], v65 offset:2048
    ds_read_b128 a[112:115], v65 offset:3072
    ds_read_b128 a[104:107], v65 offset:4096
    ds_read_b128 a[116:119], v65 offset:5120
    v_mfma_f32_16x16x32_bf16 v[236:239], a[248:251], a[88:91], v[236:239]
    v_mfma_f32_16x16x32_bf16 v[240:243], a[248:251], a[92:95], v[240:243]
    v_mfma_f32_16x16x32_bf16 v[244:247], a[252:255], a[84:87], v[244:247]
    v_mfma_f32_16x16x32_bf16 v[248:251], a[252:255], a[88:91], v[248:251]
    v_mfma_f32_16x16x32_bf16 v[252:255], a[252:255], a[92:95], v[252:255]
    s_waitcnt lgkmcnt(6)
    s_barrier
    s_waitcnt lgkmcnt(5)
    v_mfma_f32_16x16x32_bf16 v[160:163], a[192:195], a[96:99], v[160:163]
    s_waitcnt lgkmcnt(0)
    s_add_u32 m0, s59, 0
    s_mov_b32 s27, 640
    buffer_load_dwordx4 v64, s[4:7], s27 offen lds
    s_add_u32 m0, s59, 1024
    s_mov_b32 s27, 704
    buffer_load_dwordx4 v64, s[4:7], s27 offen lds
    s_add_u32 m0, s59, 2048
    s_mov_b32 s27, 17024
    buffer_load_dwordx4 v64, s[4:7], s27 offen lds
    s_add_u32 m0, s59, 3072
    s_mov_b32 s27, 17088
    buffer_load_dwordx4 v64, s[4:7], s27 offen lds
    s_add_u32 m0, s59, 4096
    s_mov_b32 s27, 33408
    buffer_load_dwordx4 v64, s[4:7], s27 offen lds
    s_add_u32 m0, s59, 5120
    s_mov_b32 s27, 33472
    buffer_load_dwordx4 v64, s[4:7], s27 offen lds
    v_add_u32 v3, 0x10800, v3
    v_mfma_f32_16x16x32_bf16 v[164:167], a[192:195], a[100:103], v[164:167]
    ds_read_b64_tr_b16 a[224:225], v3 offset:0
    v_mfma_f32_16x16x32_bf16 v[168:171], a[192:195], a[104:107], v[168:171]
    ds_read_b64_tr_b16 a[226:227], v3 offset:1024
    v_mfma_f32_16x16x32_bf16 v[172:175], a[196:199], a[96:99], v[172:175]
    ds_read_b64_tr_b16 a[228:229], v3 offset:8
    v_mfma_f32_16x16x32_bf16 v[176:179], a[196:199], a[100:103], v[176:179]
    ds_read_b64_tr_b16 a[230:231], v3 offset:1032
    v_mfma_f32_16x16x32_bf16 v[180:183], a[196:199], a[104:107], v[180:183]
    ds_read_b64_tr_b16 a[232:233], v3 offset:256
    v_mfma_f32_16x16x32_bf16 v[184:187], a[200:203], a[96:99], v[184:187]
    ds_read_b64_tr_b16 a[234:235], v3 offset:1280
    s_add_u32 m0, s26, 126720
    v_mfma_f32_16x16x32_bf16 v[188:191], a[200:203], a[100:103], v[188:191]
    ds_read_b64_tr_b16 a[236:237], v3 offset:264
    s_add_u32 s27, s63, 3932160
    v_mfma_f32_16x16x32_bf16 v[192:195], a[200:203], a[104:107], v[192:195]
    ds_read_b64_tr_b16 a[238:239], v3 offset:1288
    buffer_load_dwordx4 v5, s[8:11], s27 offen lds
    v_mfma_f32_16x16x32_bf16 v[196:199], a[204:207], a[96:99], v[196:199]
    ds_read_b64_tr_b16 a[240:241], v3 offset:512
    v_mfma_f32_16x16x32_bf16 v[200:203], a[204:207], a[100:103], v[200:203]
    ds_read_b64_tr_b16 a[242:243], v3 offset:1536
    v_mfma_f32_16x16x32_bf16 v[204:207], a[204:207], a[104:107], v[204:207]
    ds_read_b64_tr_b16 a[244:245], v3 offset:520
    v_mfma_f32_16x16x32_bf16 v[208:211], a[208:211], a[96:99], v[208:211]
    ds_read_b64_tr_b16 a[246:247], v3 offset:1544
    v_mfma_f32_16x16x32_bf16 v[212:215], a[208:211], a[100:103], v[212:215]
    ds_read_b64_tr_b16 a[248:249], v3 offset:768
    v_mfma_f32_16x16x32_bf16 v[216:219], a[208:211], a[104:107], v[216:219]
    ds_read_b64_tr_b16 a[250:251], v3 offset:1792
    v_mfma_f32_16x16x32_bf16 v[220:223], a[212:215], a[96:99], v[220:223]
    ds_read_b64_tr_b16 a[252:253], v3 offset:776
    v_mfma_f32_16x16x32_bf16 v[224:227], a[212:215], a[100:103], v[224:227]
    ds_read_b64_tr_b16 a[254:255], v3 offset:1800
    s_add_u32 m0, s26, 127744
    v_mfma_f32_16x16x32_bf16 v[228:231], a[212:215], a[104:107], v[228:231]
    s_add_u32 s27, s63, 3964928
    v_mfma_f32_16x16x32_bf16 v[232:235], a[216:219], a[96:99], v[232:235]
    buffer_load_dwordx4 v5, s[8:11], s27 offen lds
    v_mfma_f32_16x16x32_bf16 v[236:239], a[216:219], a[100:103], v[236:239]
    v_mfma_f32_16x16x32_bf16 v[240:243], a[216:219], a[104:107], v[240:243]
    v_mfma_f32_16x16x32_bf16 v[244:247], a[220:223], a[96:99], v[244:247]
    v_mfma_f32_16x16x32_bf16 v[248:251], a[220:223], a[100:103], v[248:251]
    v_mfma_f32_16x16x32_bf16 v[252:255], a[220:223], a[104:107], v[252:255]
    s_waitcnt lgkmcnt(0)
    v_mfma_f32_16x16x32_bf16 v[160:163], a[224:227], a[108:111], v[160:163]
    v_add_u32 v3, 0xffffdf00, v3
    v_mfma_f32_16x16x32_bf16 v[164:167], a[224:227], a[112:115], v[164:167]
    ds_read_b64_tr_b16 a[192:193], v3 offset:0
    v_mfma_f32_16x16x32_bf16 v[168:171], a[224:227], a[116:119], v[168:171]
    ds_read_b64_tr_b16 a[194:195], v3 offset:1024
    v_mfma_f32_16x16x32_bf16 v[172:175], a[228:231], a[108:111], v[172:175]
    ds_read_b64_tr_b16 a[196:197], v3 offset:8
    v_mfma_f32_16x16x32_bf16 v[176:179], a[228:231], a[112:115], v[176:179]
    ds_read_b64_tr_b16 a[198:199], v3 offset:1032
    v_mfma_f32_16x16x32_bf16 v[180:183], a[228:231], a[116:119], v[180:183]
    ds_read_b64_tr_b16 a[200:201], v3 offset:256
    v_mfma_f32_16x16x32_bf16 v[184:187], a[232:235], a[108:111], v[184:187]
    ds_read_b64_tr_b16 a[202:203], v3 offset:1280
    s_add_u32 m0, s25, 50688
    v_mfma_f32_16x16x32_bf16 v[188:191], a[232:235], a[112:115], v[188:191]
    ds_read_b64_tr_b16 a[204:205], v3 offset:264
    s_add_u32 s27, s62, 24576
    v_mfma_f32_16x16x32_bf16 v[192:195], a[232:235], a[116:119], v[192:195]
    ds_read_b64_tr_b16 a[206:207], v3 offset:1288
    buffer_load_dwordx4 v4, s[12:15], s27 offen nt lds
    v_mfma_f32_16x16x32_bf16 v[196:199], a[236:239], a[108:111], v[196:199]
    ds_read_b64_tr_b16 a[208:209], v3 offset:512
    v_mfma_f32_16x16x32_bf16 v[200:203], a[236:239], a[112:115], v[200:203]
    ds_read_b64_tr_b16 a[210:211], v3 offset:1536
    v_mfma_f32_16x16x32_bf16 v[204:207], a[236:239], a[116:119], v[204:207]
    ds_read_b64_tr_b16 a[212:213], v3 offset:520
    v_mfma_f32_16x16x32_bf16 v[208:211], a[240:243], a[108:111], v[208:211]
    ds_read_b64_tr_b16 a[214:215], v3 offset:1544
    v_mfma_f32_16x16x32_bf16 v[212:215], a[240:243], a[112:115], v[212:215]
    ds_read_b64_tr_b16 a[216:217], v3 offset:768
    v_mfma_f32_16x16x32_bf16 v[216:219], a[240:243], a[116:119], v[216:219]
    ds_read_b64_tr_b16 a[218:219], v3 offset:1792
    v_mfma_f32_16x16x32_bf16 v[220:223], a[244:247], a[108:111], v[220:223]
    ds_read_b64_tr_b16 a[220:221], v3 offset:776
    v_mfma_f32_16x16x32_bf16 v[224:227], a[244:247], a[112:115], v[224:227]
    ds_read_b64_tr_b16 a[222:223], v3 offset:1800
    v_mfma_f32_16x16x32_bf16 v[228:231], a[244:247], a[116:119], v[228:231]
    s_add_u32 m0, s25, 50720
    v_mfma_f32_16x16x32_bf16 v[232:235], a[248:251], a[108:111], v[232:235]
    buffer_load_dwordx4 v4, s[12:15], s27 offen offset:1024 nt lds
    s_waitcnt vmcnt(4)
    ds_read_b128 a[120:123], v65 offset:0
    ds_read_b128 a[132:135], v65 offset:1024
    ds_read_b128 a[124:127], v65 offset:2048
    ds_read_b128 a[136:139], v65 offset:3072
    ds_read_b128 a[128:131], v65 offset:4096
    ds_read_b128 a[140:143], v65 offset:5120
    v_mfma_f32_16x16x32_bf16 v[236:239], a[248:251], a[112:115], v[236:239]
    v_mfma_f32_16x16x32_bf16 v[240:243], a[248:251], a[116:119], v[240:243]
    v_mfma_f32_16x16x32_bf16 v[244:247], a[252:255], a[108:111], v[244:247]
    v_mfma_f32_16x16x32_bf16 v[248:251], a[252:255], a[112:115], v[248:251]
    v_mfma_f32_16x16x32_bf16 v[252:255], a[252:255], a[116:119], v[252:255]
    s_waitcnt lgkmcnt(6)
    s_barrier
    s_waitcnt lgkmcnt(5)
    v_mfma_f32_16x16x32_bf16 v[160:163], a[192:195], a[120:123], v[160:163]
    s_waitcnt lgkmcnt(0)
    s_add_u32 m0, s59, 0
    s_mov_b32 s27, 768
    buffer_load_dwordx4 v64, s[4:7], s27 offen lds
    s_add_u32 m0, s59, 1024
    s_mov_b32 s27, 832
    buffer_load_dwordx4 v64, s[4:7], s27 offen lds
    s_add_u32 m0, s59, 2048
    s_mov_b32 s27, 17152
    buffer_load_dwordx4 v64, s[4:7], s27 offen lds
    s_add_u32 m0, s59, 3072
    s_mov_b32 s27, 17216
    buffer_load_dwordx4 v64, s[4:7], s27 offen lds
    s_add_u32 m0, s59, 4096
    s_mov_b32 s27, 33536
    buffer_load_dwordx4 v64, s[4:7], s27 offen lds
    s_add_u32 m0, s59, 5120
    s_mov_b32 s27, 33600
    buffer_load_dwordx4 v64, s[4:7], s27 offen lds
    v_add_u32 v3, 0xffffdf00, v3
    v_mfma_f32_16x16x32_bf16 v[164:167], a[192:195], a[124:127], v[164:167]
    ds_read_b64_tr_b16 a[224:225], v3 offset:0
    v_mfma_f32_16x16x32_bf16 v[168:171], a[192:195], a[128:131], v[168:171]
    ds_read_b64_tr_b16 a[226:227], v3 offset:1024
    v_mfma_f32_16x16x32_bf16 v[172:175], a[196:199], a[120:123], v[172:175]
    ds_read_b64_tr_b16 a[228:229], v3 offset:8
    v_mfma_f32_16x16x32_bf16 v[176:179], a[196:199], a[124:127], v[176:179]
    ds_read_b64_tr_b16 a[230:231], v3 offset:1032
    v_mfma_f32_16x16x32_bf16 v[180:183], a[196:199], a[128:131], v[180:183]
    ds_read_b64_tr_b16 a[232:233], v3 offset:256
    v_mfma_f32_16x16x32_bf16 v[184:187], a[200:203], a[120:123], v[184:187]
    ds_read_b64_tr_b16 a[234:235], v3 offset:1280
    s_add_u32 m0, s25, 118272
    v_mfma_f32_16x16x32_bf16 v[188:191], a[200:203], a[124:127], v[188:191]
    ds_read_b64_tr_b16 a[236:237], v3 offset:264
    s_add_u32 s27, s62, 8192
    v_mfma_f32_16x16x32_bf16 v[192:195], a[200:203], a[128:131], v[192:195]
    ds_read_b64_tr_b16 a[238:239], v3 offset:1288
    buffer_load_dwordx4 v4, s[16:19], s27 offen nt lds
    v_mfma_f32_16x16x32_bf16 v[196:199], a[204:207], a[120:123], v[196:199]
    ds_read_b64_tr_b16 a[240:241], v3 offset:512
    v_mfma_f32_16x16x32_bf16 v[200:203], a[204:207], a[124:127], v[200:203]
    ds_read_b64_tr_b16 a[242:243], v3 offset:1536
    v_mfma_f32_16x16x32_bf16 v[204:207], a[204:207], a[128:131], v[204:207]
    ds_read_b64_tr_b16 a[244:245], v3 offset:520
    v_mfma_f32_16x16x32_bf16 v[208:211], a[208:211], a[120:123], v[208:211]
    ds_read_b64_tr_b16 a[246:247], v3 offset:1544
    v_mfma_f32_16x16x32_bf16 v[212:215], a[208:211], a[124:127], v[212:215]
    ds_read_b64_tr_b16 a[248:249], v3 offset:768
    v_mfma_f32_16x16x32_bf16 v[216:219], a[208:211], a[128:131], v[216:219]
    ds_read_b64_tr_b16 a[250:251], v3 offset:1792
    v_mfma_f32_16x16x32_bf16 v[220:223], a[212:215], a[120:123], v[220:223]
    ds_read_b64_tr_b16 a[252:253], v3 offset:776
    v_mfma_f32_16x16x32_bf16 v[224:227], a[212:215], a[124:127], v[224:227]
    ds_read_b64_tr_b16 a[254:255], v3 offset:1800
    v_mfma_f32_16x16x32_bf16 v[228:231], a[212:215], a[128:131], v[228:231]
    s_add_u32 m0, s25, 118304
    v_mfma_f32_16x16x32_bf16 v[232:235], a[216:219], a[120:123], v[232:235]
    buffer_load_dwordx4 v4, s[16:19], s27 offen offset:1024 nt lds
    v_mfma_f32_16x16x32_bf16 v[236:239], a[216:219], a[124:127], v[236:239]
    v_mfma_f32_16x16x32_bf16 v[240:243], a[216:219], a[128:131], v[240:243]
    v_mfma_f32_16x16x32_bf16 v[244:247], a[220:223], a[120:123], v[244:247]
    v_mfma_f32_16x16x32_bf16 v[248:251], a[220:223], a[124:127], v[248:251]
    v_mfma_f32_16x16x32_bf16 v[252:255], a[220:223], a[128:131], v[252:255]
    s_waitcnt lgkmcnt(0)
    v_mfma_f32_16x16x32_bf16 v[160:163], a[224:227], a[132:135], v[160:163]
    v_add_u32 v3, 0xffffdf00, v3
    v_mfma_f32_16x16x32_bf16 v[164:167], a[224:227], a[136:139], v[164:167]
    ds_read_b64_tr_b16 a[192:193], v3 offset:0
    v_mfma_f32_16x16x32_bf16 v[168:171], a[224:227], a[140:143], v[168:171]
    ds_read_b64_tr_b16 a[194:195], v3 offset:1024
    v_mfma_f32_16x16x32_bf16 v[172:175], a[228:231], a[132:135], v[172:175]
    ds_read_b64_tr_b16 a[196:197], v3 offset:8
    v_mfma_f32_16x16x32_bf16 v[176:179], a[228:231], a[136:139], v[176:179]
    ds_read_b64_tr_b16 a[198:199], v3 offset:1032
    v_mfma_f32_16x16x32_bf16 v[180:183], a[228:231], a[140:143], v[180:183]
    ds_read_b64_tr_b16 a[200:201], v3 offset:256
    v_mfma_f32_16x16x32_bf16 v[184:187], a[232:235], a[132:135], v[184:187]
    ds_read_b64_tr_b16 a[202:203], v3 offset:1280
    s_add_u32 m0, s25, 109824
    v_mfma_f32_16x16x32_bf16 v[188:191], a[232:235], a[136:139], v[188:191]
    ds_read_b64_tr_b16 a[204:205], v3 offset:264
    s_add_u32 s27, s62, 32768
    v_mfma_f32_16x16x32_bf16 v[192:195], a[232:235], a[140:143], v[192:195]
    ds_read_b64_tr_b16 a[206:207], v3 offset:1288
    buffer_load_dwordx4 v4, s[12:15], s27 offen nt lds
    v_mfma_f32_16x16x32_bf16 v[196:199], a[236:239], a[132:135], v[196:199]
    ds_read_b64_tr_b16 a[208:209], v3 offset:512
    v_mfma_f32_16x16x32_bf16 v[200:203], a[236:239], a[136:139], v[200:203]
    ds_read_b64_tr_b16 a[210:211], v3 offset:1536
    v_mfma_f32_16x16x32_bf16 v[204:207], a[236:239], a[140:143], v[204:207]
    ds_read_b64_tr_b16 a[212:213], v3 offset:520
    v_mfma_f32_16x16x32_bf16 v[208:211], a[240:243], a[132:135], v[208:211]
    ds_read_b64_tr_b16 a[214:215], v3 offset:1544
    v_mfma_f32_16x16x32_bf16 v[212:215], a[240:243], a[136:139], v[212:215]
    ds_read_b64_tr_b16 a[216:217], v3 offset:768
    v_mfma_f32_16x16x32_bf16 v[216:219], a[240:243], a[140:143], v[216:219]
    ds_read_b64_tr_b16 a[218:219], v3 offset:1792
    v_mfma_f32_16x16x32_bf16 v[220:223], a[244:247], a[132:135], v[220:223]
    ds_read_b64_tr_b16 a[220:221], v3 offset:776
    v_mfma_f32_16x16x32_bf16 v[224:227], a[244:247], a[136:139], v[224:227]
    ds_read_b64_tr_b16 a[222:223], v3 offset:1800
    v_mfma_f32_16x16x32_bf16 v[228:231], a[244:247], a[140:143], v[228:231]
    s_add_u32 m0, s25, 109856
    v_mfma_f32_16x16x32_bf16 v[232:235], a[248:251], a[132:135], v[232:235]
    buffer_load_dwordx4 v4, s[12:15], s27 offen offset:1024 nt lds
    s_waitcnt vmcnt(4)
    ds_read_b128 a[144:147], v65 offset:0
    ds_read_b128 a[156:159], v65 offset:1024
    ds_read_b128 a[148:151], v65 offset:2048
    ds_read_b128 a[160:163], v65 offset:3072
    ds_read_b128 a[152:155], v65 offset:4096
    ds_read_b128 a[164:167], v65 offset:5120
    v_mfma_f32_16x16x32_bf16 v[236:239], a[248:251], a[136:139], v[236:239]
    v_mfma_f32_16x16x32_bf16 v[240:243], a[248:251], a[140:143], v[240:243]
    v_mfma_f32_16x16x32_bf16 v[244:247], a[252:255], a[132:135], v[244:247]
    v_mfma_f32_16x16x32_bf16 v[248:251], a[252:255], a[136:139], v[248:251]
    v_mfma_f32_16x16x32_bf16 v[252:255], a[252:255], a[140:143], v[252:255]
    s_waitcnt lgkmcnt(6)
    s_barrier
    s_waitcnt lgkmcnt(5)
    v_mfma_f32_16x16x32_bf16 v[160:163], a[192:195], a[144:147], v[160:163]
    s_waitcnt lgkmcnt(0)
    s_add_u32 m0, s59, 0
    s_mov_b32 s27, 896
    buffer_load_dwordx4 v64, s[4:7], s27 offen lds
    s_add_u32 m0, s59, 1024
    s_mov_b32 s27, 960
    buffer_load_dwordx4 v64, s[4:7], s27 offen lds
    s_add_u32 m0, s59, 2048
    s_mov_b32 s27, 17280
    buffer_load_dwordx4 v64, s[4:7], s27 offen lds
    s_add_u32 m0, s59, 3072
    s_mov_b32 s27, 17344
    buffer_load_dwordx4 v64, s[4:7], s27 offen lds
    s_add_u32 m0, s59, 4096
    s_mov_b32 s27, 33664
    buffer_load_dwordx4 v64, s[4:7], s27 offen lds
    s_add_u32 m0, s59, 5120
    s_mov_b32 s27, 33728
    buffer_load_dwordx4 v64, s[4:7], s27 offen lds
    v_add_u32 v3, 0xffff9d00, v3
    v_mfma_f32_16x16x32_bf16 v[164:167], a[192:195], a[148:151], v[164:167]
    ds_read_b64_tr_b16 a[224:225], v3 offset:0
    v_mfma_f32_16x16x32_bf16 v[168:171], a[192:195], a[152:155], v[168:171]
    ds_read_b64_tr_b16 a[226:227], v3 offset:1024
    v_mfma_f32_16x16x32_bf16 v[172:175], a[196:199], a[144:147], v[172:175]
    ds_read_b64_tr_b16 a[228:229], v3 offset:8
    v_mfma_f32_16x16x32_bf16 v[176:179], a[196:199], a[148:151], v[176:179]
    ds_read_b64_tr_b16 a[230:231], v3 offset:1032
    v_mfma_f32_16x16x32_bf16 v[180:183], a[196:199], a[152:155], v[180:183]
    ds_read_b64_tr_b16 a[232:233], v3 offset:256
    v_mfma_f32_16x16x32_bf16 v[184:187], a[200:203], a[144:147], v[184:187]
    ds_read_b64_tr_b16 a[234:235], v3 offset:1280
    s_add_u32 m0, s25, 101376
    v_mfma_f32_16x16x32_bf16 v[188:191], a[200:203], a[148:151], v[188:191]
    ds_read_b64_tr_b16 a[236:237], v3 offset:264
    s_add_u32 s27, s62, 16384
    v_mfma_f32_16x16x32_bf16 v[192:195], a[200:203], a[152:155], v[192:195]
    ds_read_b64_tr_b16 a[238:239], v3 offset:1288
    buffer_load_dwordx4 v4, s[16:19], s27 offen nt lds
    v_mfma_f32_16x16x32_bf16 v[196:199], a[204:207], a[144:147], v[196:199]
    ds_read_b64_tr_b16 a[240:241], v3 offset:512
    v_mfma_f32_16x16x32_bf16 v[200:203], a[204:207], a[148:151], v[200:203]
    ds_read_b64_tr_b16 a[242:243], v3 offset:1536
    v_mfma_f32_16x16x32_bf16 v[204:207], a[204:207], a[152:155], v[204:207]
    ds_read_b64_tr_b16 a[244:245], v3 offset:520
    v_mfma_f32_16x16x32_bf16 v[208:211], a[208:211], a[144:147], v[208:211]
    ds_read_b64_tr_b16 a[246:247], v3 offset:1544
    v_mfma_f32_16x16x32_bf16 v[212:215], a[208:211], a[148:151], v[212:215]
    ds_read_b64_tr_b16 a[248:249], v3 offset:768
    v_mfma_f32_16x16x32_bf16 v[216:219], a[208:211], a[152:155], v[216:219]
    ds_read_b64_tr_b16 a[250:251], v3 offset:1792
    v_mfma_f32_16x16x32_bf16 v[220:223], a[212:215], a[144:147], v[220:223]
    ds_read_b64_tr_b16 a[252:253], v3 offset:776
    v_mfma_f32_16x16x32_bf16 v[224:227], a[212:215], a[148:151], v[224:227]
    ds_read_b64_tr_b16 a[254:255], v3 offset:1800
    v_mfma_f32_16x16x32_bf16 v[228:231], a[212:215], a[152:155], v[228:231]
    s_add_u32 m0, s25, 101408
    v_mfma_f32_16x16x32_bf16 v[232:235], a[216:219], a[144:147], v[232:235]
    buffer_load_dwordx4 v4, s[16:19], s27 offen offset:1024 nt lds
    v_mfma_f32_16x16x32_bf16 v[236:239], a[216:219], a[148:151], v[236:239]
    v_mfma_f32_16x16x32_bf16 v[240:243], a[216:219], a[152:155], v[240:243]
    v_mfma_f32_16x16x32_bf16 v[244:247], a[220:223], a[144:147], v[244:247]
    v_mfma_f32_16x16x32_bf16 v[248:251], a[220:223], a[148:151], v[248:251]
    v_mfma_f32_16x16x32_bf16 v[252:255], a[220:223], a[152:155], v[252:255]
    s_waitcnt lgkmcnt(0)
    v_mfma_f32_16x16x32_bf16 v[160:163], a[224:227], a[156:159], v[160:163]
    v_add_u32 v3, 0xffffdf00, v3
    v_mfma_f32_16x16x32_bf16 v[164:167], a[224:227], a[160:163], v[164:167]
    ds_read_b64_tr_b16 a[192:193], v3 offset:0
    v_mfma_f32_16x16x32_bf16 v[168:171], a[224:227], a[164:167], v[168:171]
    ds_read_b64_tr_b16 a[194:195], v3 offset:1024
    v_mfma_f32_16x16x32_bf16 v[172:175], a[228:231], a[156:159], v[172:175]
    ds_read_b64_tr_b16 a[196:197], v3 offset:8
    v_mfma_f32_16x16x32_bf16 v[176:179], a[228:231], a[160:163], v[176:179]
    ds_read_b64_tr_b16 a[198:199], v3 offset:1032
    v_mfma_f32_16x16x32_bf16 v[180:183], a[228:231], a[164:167], v[180:183]
    ds_read_b64_tr_b16 a[200:201], v3 offset:256
    v_mfma_f32_16x16x32_bf16 v[184:187], a[232:235], a[156:159], v[184:187]
    ds_read_b64_tr_b16 a[202:203], v3 offset:1280
    s_add_u32 m0, s25, 92928
    v_mfma_f32_16x16x32_bf16 v[188:191], a[232:235], a[160:163], v[188:191]
    ds_read_b64_tr_b16 a[204:205], v3 offset:264
    s_add_u32 s27, s62, 40960
    v_mfma_f32_16x16x32_bf16 v[192:195], a[232:235], a[164:167], v[192:195]
    ds_read_b64_tr_b16 a[206:207], v3 offset:1288
    buffer_load_dwordx4 v4, s[12:15], s27 offen nt lds
    v_mfma_f32_16x16x32_bf16 v[196:199], a[236:239], a[156:159], v[196:199]
    ds_read_b64_tr_b16 a[208:209], v3 offset:512
    v_mfma_f32_16x16x32_bf16 v[200:203], a[236:239], a[160:163], v[200:203]
    ds_read_b64_tr_b16 a[210:211], v3 offset:1536
    v_mfma_f32_16x16x32_bf16 v[204:207], a[236:239], a[164:167], v[204:207]
    ds_read_b64_tr_b16 a[212:213], v3 offset:520
    v_mfma_f32_16x16x32_bf16 v[208:211], a[240:243], a[156:159], v[208:211]
    ds_read_b64_tr_b16 a[214:215], v3 offset:1544
    v_mfma_f32_16x16x32_bf16 v[212:215], a[240:243], a[160:163], v[212:215]
    ds_read_b64_tr_b16 a[216:217], v3 offset:768
    v_mfma_f32_16x16x32_bf16 v[216:219], a[240:243], a[164:167], v[216:219]
    ds_read_b64_tr_b16 a[218:219], v3 offset:1792
    v_mfma_f32_16x16x32_bf16 v[220:223], a[244:247], a[156:159], v[220:223]
    ds_read_b64_tr_b16 a[220:221], v3 offset:776
    v_mfma_f32_16x16x32_bf16 v[224:227], a[244:247], a[160:163], v[224:227]
    ds_read_b64_tr_b16 a[222:223], v3 offset:1800
    v_mfma_f32_16x16x32_bf16 v[228:231], a[244:247], a[164:167], v[228:231]
    s_add_u32 m0, s25, 92960
    v_mfma_f32_16x16x32_bf16 v[232:235], a[248:251], a[156:159], v[232:235]
    buffer_load_dwordx4 v4, s[12:15], s27 offen offset:1024 nt lds
    s_waitcnt vmcnt(4)
    ds_read_b128 a[168:171], v65 offset:0
    ds_read_b128 a[180:183], v65 offset:1024
    ds_read_b128 a[172:175], v65 offset:2048
    ds_read_b128 a[184:187], v65 offset:3072
    ds_read_b128 a[176:179], v65 offset:4096
    ds_read_b128 a[188:191], v65 offset:5120
    v_mfma_f32_16x16x32_bf16 v[236:239], a[248:251], a[160:163], v[236:239]
    v_mfma_f32_16x16x32_bf16 v[240:243], a[248:251], a[164:167], v[240:243]
    v_mfma_f32_16x16x32_bf16 v[244:247], a[252:255], a[156:159], v[244:247]
    v_mfma_f32_16x16x32_bf16 v[248:251], a[252:255], a[160:163], v[248:251]
    v_mfma_f32_16x16x32_bf16 v[252:255], a[252:255], a[164:167], v[252:255]
    s_waitcnt lgkmcnt(6)
    s_barrier
    s_waitcnt lgkmcnt(5)
    v_mfma_f32_16x16x32_bf16 v[160:163], a[192:195], a[168:171], v[160:163]
    v_add_u32 v3, 0x10800, v3
    s_waitcnt lgkmcnt(3)
    v_mfma_f32_16x16x32_bf16 v[164:167], a[192:195], a[172:175], v[164:167]
    ds_read_b64_tr_b16 a[224:225], v3 offset:0
    s_waitcnt lgkmcnt(2)
    v_mfma_f32_16x16x32_bf16 v[168:171], a[192:195], a[176:179], v[168:171]
    ds_read_b64_tr_b16 a[226:227], v3 offset:1024
    v_mfma_f32_16x16x32_bf16 v[172:175], a[196:199], a[168:171], v[172:175]
    ds_read_b64_tr_b16 a[228:229], v3 offset:8
    v_mfma_f32_16x16x32_bf16 v[176:179], a[196:199], a[172:175], v[176:179]
    ds_read_b64_tr_b16 a[230:231], v3 offset:1032
    v_mfma_f32_16x16x32_bf16 v[180:183], a[196:199], a[176:179], v[180:183]
    ds_read_b64_tr_b16 a[232:233], v3 offset:256
    v_mfma_f32_16x16x32_bf16 v[184:187], a[200:203], a[168:171], v[184:187]
    ds_read_b64_tr_b16 a[234:235], v3 offset:1280
    s_add_u32 m0, s25, 67584
    v_mfma_f32_16x16x32_bf16 v[188:191], a[200:203], a[172:175], v[188:191]
    ds_read_b64_tr_b16 a[236:237], v3 offset:264
    s_add_u32 s27, s62, 24576
    v_mfma_f32_16x16x32_bf16 v[192:195], a[200:203], a[176:179], v[192:195]
    ds_read_b64_tr_b16 a[238:239], v3 offset:1288
    buffer_load_dwordx4 v4, s[16:19], s27 offen nt lds
    v_mfma_f32_16x16x32_bf16 v[196:199], a[204:207], a[168:171], v[196:199]
    ds_read_b64_tr_b16 a[240:241], v3 offset:512
    v_mfma_f32_16x16x32_bf16 v[200:203], a[204:207], a[172:175], v[200:203]
    ds_read_b64_tr_b16 a[242:243], v3 offset:1536
    v_mfma_f32_16x16x32_bf16 v[204:207], a[204:207], a[176:179], v[204:207]
    ds_read_b64_tr_b16 a[244:245], v3 offset:520
    v_mfma_f32_16x16x32_bf16 v[208:211], a[208:211], a[168:171], v[208:211]
    ds_read_b64_tr_b16 a[246:247], v3 offset:1544
    v_mfma_f32_16x16x32_bf16 v[212:215], a[208:211], a[172:175], v[212:215]
    ds_read_b64_tr_b16 a[248:249], v3 offset:768
    v_mfma_f32_16x16x32_bf16 v[216:219], a[208:211], a[176:179], v[216:219]
    ds_read_b64_tr_b16 a[250:251], v3 offset:1792
    v_mfma_f32_16x16x32_bf16 v[220:223], a[212:215], a[168:171], v[220:223]
    ds_read_b64_tr_b16 a[252:253], v3 offset:776
    v_mfma_f32_16x16x32_bf16 v[224:227], a[212:215], a[172:175], v[224:227]
    ds_read_b64_tr_b16 a[254:255], v3 offset:1800
    v_mfma_f32_16x16x32_bf16 v[228:231], a[212:215], a[176:179], v[228:231]
    s_add_u32 m0, s25, 67616
    v_mfma_f32_16x16x32_bf16 v[232:235], a[216:219], a[168:171], v[232:235]
    buffer_load_dwordx4 v4, s[16:19], s27 offen offset:1024 nt lds
    v_mfma_f32_16x16x32_bf16 v[236:239], a[216:219], a[172:175], v[236:239]
    v_mfma_f32_16x16x32_bf16 v[240:243], a[216:219], a[176:179], v[240:243]
    v_mfma_f32_16x16x32_bf16 v[244:247], a[220:223], a[168:171], v[244:247]
    v_mfma_f32_16x16x32_bf16 v[248:251], a[220:223], a[172:175], v[248:251]
    v_mfma_f32_16x16x32_bf16 v[252:255], a[220:223], a[176:179], v[252:255]
    s_waitcnt lgkmcnt(0)
    v_mfma_f32_16x16x32_bf16 v[160:163], a[224:227], a[180:183], v[160:163]
    v_add_u32 v1, 0x14a00, v1
    v_mfma_f32_16x16x32_bf16 v[164:167], a[224:227], a[184:187], v[164:167]
    ds_read_b128 a[192:195], v1 offset:0
    v_mfma_f32_16x16x32_bf16 v[168:171], a[224:227], a[188:191], v[168:171]
    v_mfma_f32_16x16x32_bf16 v[172:175], a[228:231], a[180:183], v[172:175]
    ds_read_b128 a[196:199], v1 offset:256
    v_mfma_f32_16x16x32_bf16 v[176:179], a[228:231], a[184:187], v[176:179]
    v_mfma_f32_16x16x32_bf16 v[180:183], a[228:231], a[188:191], v[180:183]
    ds_read_b128 a[200:203], v1 offset:512
    v_mfma_f32_16x16x32_bf16 v[184:187], a[232:235], a[180:183], v[184:187]
    s_add_u32 m0, s25, 59136
    v_mfma_f32_16x16x32_bf16 v[188:191], a[232:235], a[184:187], v[188:191]
    ds_read_b128 a[204:207], v1 offset:768
    s_add_u32 s27, s62, 49152
    v_mfma_f32_16x16x32_bf16 v[192:195], a[232:235], a[188:191], v[192:195]
    buffer_load_dwordx4 v4, s[12:15], s27 offen nt lds
    v_pk_mul_f32 v[160:161], v[160:161], s[60:61]
    v_pk_mul_f32 v[162:163], v[162:163], s[60:61]
    v_pk_mul_f32 v[172:173], v[172:173], s[60:61]
    v_mfma_f32_16x16x32_bf16 v[196:199], a[236:239], a[180:183], v[196:199]
    ds_read_b128 a[208:211], v1 offset:4224
    v_pk_mul_f32 v[174:175], v[174:175], s[60:61]
    v_cvt_pk_bf16_f32 v100, v160, v161
    v_cvt_pk_bf16_f32 v101, v162, v163
    v_mfma_f32_16x16x32_bf16 v[200:203], a[236:239], a[184:187], v[200:203]
    v_cvt_pk_bf16_f32 v102, v172, v173
    v_cvt_pk_bf16_f32 v103, v174, v175
    v_pk_mul_f32 v[164:165], v[164:165], s[60:61]
    v_mfma_f32_16x16x32_bf16 v[204:207], a[236:239], a[188:191], v[204:207]
    ds_read_b128 a[212:215], v1 offset:4480
    v_pk_mul_f32 v[166:167], v[166:167], s[60:61]
    v_pk_mul_f32 v[176:177], v[176:177], s[60:61]
    v_pk_mul_f32 v[178:179], v[178:179], s[60:61]
    v_mfma_f32_16x16x32_bf16 v[208:211], a[240:243], a[180:183], v[208:211]
    v_cvt_pk_bf16_f32 v104, v164, v165
    v_cvt_pk_bf16_f32 v105, v166, v167
    v_cvt_pk_bf16_f32 v106, v176, v177
    v_mfma_f32_16x16x32_bf16 v[212:215], a[240:243], a[184:187], v[212:215]
    ds_read_b128 a[216:219], v1 offset:4736
    v_cvt_pk_bf16_f32 v107, v178, v179
    v_pk_mul_f32 v[168:169], v[168:169], s[60:61]
    v_pk_mul_f32 v[170:171], v[170:171], s[60:61]
    v_mfma_f32_16x16x32_bf16 v[216:219], a[240:243], a[188:191], v[216:219]
    v_pk_mul_f32 v[180:181], v[180:181], s[60:61]
    v_pk_mul_f32 v[182:183], v[182:183], s[60:61]
    v_cvt_pk_bf16_f32 v108, v168, v169
    v_pk_mul_f32 v[184:185], v[184:185], s[60:61]
    v_pk_mul_f32 v[186:187], v[186:187], s[60:61]
    v_pk_mul_f32 v[196:197], v[196:197], s[60:61]
    v_mfma_f32_16x16x32_bf16 v[220:223], a[244:247], a[180:183], v[220:223]
    ds_read_b128 a[220:223], v1 offset:4992
    v_cvt_pk_bf16_f32 v109, v170, v171
    v_cvt_pk_bf16_f32 v110, v180, v181
    v_cvt_pk_bf16_f32 v111, v182, v183
    v_pk_mul_f32 v[198:199], v[198:199], s[60:61]
    v_cvt_pk_bf16_f32 v112, v184, v185
    v_cvt_pk_bf16_f32 v113, v186, v187
    v_mfma_f32_16x16x32_bf16 v[224:227], a[244:247], a[184:187], v[224:227]
    v_cvt_pk_bf16_f32 v114, v196, v197
    v_cvt_pk_bf16_f32 v115, v198, v199
    v_pk_mul_f32 v[188:189], v[188:189], s[60:61]
    v_mfma_f32_16x16x32_bf16 v[228:231], a[244:247], a[188:191], v[228:231]
    s_add_u32 m0, s25, 59168
    v_pk_mul_f32 v[190:191], v[190:191], s[60:61]
    v_pk_mul_f32 v[200:201], v[200:201], s[60:61]
    v_pk_mul_f32 v[202:203], v[202:203], s[60:61]
    v_mfma_f32_16x16x32_bf16 v[232:235], a[248:251], a[180:183], v[232:235]
    buffer_load_dwordx4 v4, s[12:15], s27 offen offset:1024 nt lds
    v_cvt_pk_bf16_f32 v116, v188, v189
    v_cvt_pk_bf16_f32 v117, v190, v191
    v_cvt_pk_bf16_f32 v118, v200, v201
    v_mfma_f32_16x16x32_bf16 v[236:239], a[248:251], a[184:187], v[236:239]
    v_cvt_pk_bf16_f32 v119, v202, v203
    v_pk_mul_f32 v[192:193], v[192:193], s[60:61]
    v_pk_mul_f32 v[194:195], v[194:195], s[60:61]
    v_mfma_f32_16x16x32_bf16 v[240:243], a[248:251], a[188:191], v[240:243]
    v_pk_mul_f32 v[204:205], v[204:205], s[60:61]
    v_pk_mul_f32 v[206:207], v[206:207], s[60:61]
    v_cvt_pk_bf16_f32 v120, v192, v193
    v_pk_mul_f32 v[208:209], v[208:209], s[60:61]
    v_pk_mul_f32 v[210:211], v[210:211], s[60:61]
    v_pk_mul_f32 v[220:221], v[220:221], s[60:61]
    v_pk_mul_f32 v[222:223], v[222:223], s[60:61]
    v_cvt_pk_bf16_f32 v124, v208, v209
    v_cvt_pk_bf16_f32 v125, v210, v211
    v_mfma_f32_16x16x32_bf16 v[244:247], a[252:255], a[180:183], v[244:247]
    v_cvt_pk_bf16_f32 v121, v194, v195
    v_cvt_pk_bf16_f32 v122, v204, v205
    v_cvt_pk_bf16_f32 v123, v206, v207
    v_cvt_pk_bf16_f32 v126, v220, v221
    v_cvt_pk_bf16_f32 v127, v222, v223
    v_pk_mul_f32 v[212:213], v[212:213], s[60:61]
    v_pk_mul_f32 v[214:215], v[214:215], s[60:61]
    v_pk_mul_f32 v[224:225], v[224:225], s[60:61]
    v_pk_mul_f32 v[226:227], v[226:227], s[60:61]
    v_mfma_f32_16x16x32_bf16 v[248:251], a[252:255], a[184:187], v[248:251]
    v_cvt_pk_bf16_f32 v128, v212, v213
    v_cvt_pk_bf16_f32 v129, v214, v215
    v_cvt_pk_bf16_f32 v130, v224, v225
    v_cvt_pk_bf16_f32 v131, v226, v227
    v_pk_mul_f32 v[216:217], v[216:217], s[60:61]
    v_pk_mul_f32 v[218:219], v[218:219], s[60:61]
    v_mfma_f32_16x16x32_bf16 v[252:255], a[252:255], a[188:191], v[252:255]
    v_pk_mul_f32 v[228:229], v[228:229], s[60:61]
    v_pk_mul_f32 v[230:231], v[230:231], s[60:61]
    v_cvt_pk_bf16_f32 v132, v216, v217
    v_cvt_pk_bf16_f32 v133, v218, v219
    v_cvt_pk_bf16_f32 v134, v228, v229
    v_cvt_pk_bf16_f32 v135, v230, v231
    s_waitcnt lgkmcnt(0)
A_LOOP:
    s_nop 1
    s_barrier
    v_mfma_f32_16x16x32_bf16 v[40:43], a[192:195], v[100:103], 0
    v_pk_mul_f32 v[232:233], v[232:233], s[60:61]
    v_pk_mul_f32 v[234:235], v[234:235], s[60:61]
    v_pk_mul_f32 v[244:245], v[244:245], s[60:61]
    v_add_u32 v1, 0xffffdf00, v1
    v_mfma_f32_16x16x32_bf16 v[48:51], a[192:195], v[104:107], 0
    ds_read_b128 a[224:227], v1 offset:0
    v_pk_mul_f32 v[246:247], v[246:247], s[60:61]
    v_cvt_pk_bf16_f32 v136, v232, v233
    v_cvt_pk_bf16_f32 v137, v234, v235
    v_mfma_f32_16x16x32_bf16 v[56:59], a[192:195], v[108:111], 0
    v_cvt_pk_bf16_f32 v138, v244, v245
    v_cvt_pk_bf16_f32 v139, v246, v247
    v_pk_mul_f32 v[236:237], v[236:237], s[60:61]
    v_mfma_f32_16x16x32_bf16 v[40:43], a[196:199], v[112:115], v[40:43]
    ds_read_b128 a[228:231], v1 offset:256
    s_add_u32 m0, s25, 143616
    v_pk_mul_f32 v[238:239], v[238:239], s[60:61]
    v_pk_mul_f32 v[248:249], v[248:249], s[60:61]
    v_pk_mul_f32 v[250:251], v[250:251], s[60:61]
    v_mfma_f32_16x16x32_bf16 v[48:51], a[196:199], v[116:119], v[48:51]
    s_add_u32 s27, s62, 32768
    v_cvt_pk_bf16_f32 v140, v236, v237
    v_cvt_pk_bf16_f32 v141, v238, v239
    v_cvt_pk_bf16_f32 v142, v248, v249
    v_mfma_f32_16x16x32_bf16 v[56:59], a[196:199], v[120:123], v[56:59]
    ds_read_b128 a[232:235], v1 offset:512
    buffer_load_dwordx4 v4, s[16:19], s27 offen nt lds
    v_cvt_pk_bf16_f32 v143, v250, v251
    v_pk_mul_f32 v[240:241], v[240:241], s[60:61]
    v_pk_mul_f32 v[242:243], v[242:243], s[60:61]
    v_mfma_f32_16x16x32_bf16 v[40:43], a[200:203], v[124:127], v[40:43]
    v_pk_mul_f32 v[252:253], v[252:253], s[60:61]
    v_pk_mul_f32 v[254:255], v[254:255], s[60:61]
    v_cvt_pk_bf16_f32 v144, v240, v241
    v_mfma_f32_16x16x32_bf16 v[48:51], a[200:203], v[128:131], v[48:51]
    ds_read_b128 a[236:239], v1 offset:768
    v_cvt_pk_bf16_f32 v145, v242, v243
    v_cvt_pk_bf16_f32 v146, v252, v253
    v_cvt_pk_bf16_f32 v147, v254, v255
    v_mfma_f32_16x16x32_bf16 v[56:59], a[200:203], v[132:135], v[56:59]
    v_mfma_f32_16x16x32_bf16 v[40:43], a[204:207], v[136:139], v[40:43]
    ds_read_b128 a[240:243], v1 offset:4224
    s_add_u32 m0, s25, 143648
    v_mfma_f32_16x16x32_bf16 v[48:51], a[204:207], v[140:143], v[48:51]
    buffer_load_dwordx4 v4, s[16:19], s27 offen offset:1024 nt lds
    v_mfma_f32_16x16x32_bf16 v[56:59], a[204:207], v[144:147], v[56:59]
    ds_read_b128 a[244:247], v1 offset:4480
    v_mfma_f32_16x16x32_bf16 v[44:47], a[208:211], v[100:103], 0
    v_mfma_f32_16x16x32_bf16 v[52:55], a[208:211], v[104:107], 0
    ds_read_b128 a[248:251], v1 offset:4736
    s_add_u32 m0, s25, 135168
    v_mfma_f32_16x16x32_bf16 v[60:63], a[208:211], v[108:111], 0
    s_add_u32 s27, s62, 57344
    v_mfma_f32_16x16x32_bf16 v[44:47], a[212:215], v[112:115], v[44:47]
    ds_read_b128 a[252:255], v1 offset:4992
    buffer_load_dwordx4 v4, s[12:15], s27 offen nt lds
    v_mfma_f32_16x16x32_bf16 v[52:55], a[212:215], v[116:119], v[52:55]
    v_mfma_f32_16x16x32_bf16 v[60:63], a[212:215], v[120:123], v[60:63]
    v_mfma_f32_16x16x32_bf16 v[44:47], a[216:219], v[124:127], v[44:47]
    v_mfma_f32_16x16x32_bf16 v[52:55], a[216:219], v[128:131], v[52:55]
    s_add_u32 m0, s25, 135200
    v_mfma_f32_16x16x32_bf16 v[60:63], a[216:219], v[132:135], v[60:63]
    buffer_load_dwordx4 v4, s[12:15], s27 offen offset:1024 nt lds
    v_mfma_f32_16x16x32_bf16 v[44:47], a[220:223], v[136:139], v[44:47]
    v_mfma_f32_16x16x32_bf16 v[52:55], a[220:223], v[140:143], v[52:55]
    v_mfma_f32_16x16x32_bf16 v[60:63], a[220:223], v[144:147], v[60:63]
    s_waitcnt lgkmcnt(0)
    v_mfma_f32_16x16x32_bf16 v[64:67], a[224:227], v[100:103], 0
    v_add_u32 v1, 0xffff7c00, v1
    v_mfma_f32_16x16x32_bf16 v[72:75], a[224:227], v[104:107], 0
    ds_read_b128 a[192:195], v1 offset:0
    v_max3_f32 v7, v40, v41, v42
    v_max3_f32 v8, v48, v49, v50
    v_max3_f32 v9, v56, v57, v58
    v_max3_f32 v7, v7, v43, v44
    v_max3_f32 v8, v8, v51, v52
    v_mfma_f32_16x16x32_bf16 v[80:83], a[224:227], v[108:111], 0
    v_max3_f32 v9, v9, v59, v60
    v_max3_f32 v7, v7, v45, v46
    v_max3_f32 v8, v8, v53, v54
    v_max3_f32 v9, v9, v61, v62
    v_mfma_f32_16x16x32_bf16 v[64:67], a[228:231], v[112:115], v[64:67]
    ds_read_b128 a[196:199], v1 offset:256
    v_max_f32 v7, v7, v47
    v_max_f32 v8, v8, v55
    v_max_f32 v9, v9, v63
    v_mov_b32 v10, v7
    v_mov_b32 v11, v8
    v_mfma_f32_16x16x32_bf16 v[72:75], a[228:231], v[116:119], v[72:75]
    v_mov_b32 v0, v9
    v_permlane32_swap_b32 v7, v10
    v_permlane32_swap_b32 v8, v11
    v_permlane32_swap_b32 v9, v0
    v_mfma_f32_16x16x32_bf16 v[80:83], a[228:231], v[120:123], v[80:83]
    ds_read_b128 a[200:203], v1 offset:512
    v_max_f32 v7, v7, v10
    v_max_f32 v8, v8, v11
    v_max_f32 v9, v9, v0
    v_mov_b32 v10, v7
    v_mov_b32 v11, v8
    v_mfma_f32_16x16x32_bf16 v[64:67], a[232:235], v[124:127], v[64:67]
    s_add_u32 m0, s25, 126720
    v_mov_b32 v0, v9
    v_permlane16_swap_b32 v7, v10
    v_permlane16_swap_b32 v8, v11
    v_permlane16_swap_b32 v9, v0
    v_mfma_f32_16x16x32_bf16 v[72:75], a[232:235], v[128:131], v[72:75]
    ds_read_b128 a[204:207], v1 offset:768
    s_add_u32 s27, s62, 40960
    v_max_f32 v7, v7, v10
    v_max_f32 v8, v8, v11
    v_max_f32 v9, v9, v0
    v_sub_f32 v88, 0, v7
    v_sub_f32 v89, 0, v7
    v_mfma_f32_16x16x32_bf16 v[80:83], a[232:235], v[132:135], v[80:83]
    buffer_load_dwordx4 v4, s[16:19], s27 offen nt lds
    v_sub_f32 v90, 0, v7
    v_sub_f32 v91, 0, v7
    v_sub_f32 v92, 0, v8
    v_sub_f32 v93, 0, v8
    v_mfma_f32_16x16x32_bf16 v[64:67], a[236:239], v[136:139], v[64:67]
    ds_read_b128 a[208:211], v1 offset:4224
    v_sub_f32 v94, 0, v8
    v_sub_f32 v95, 0, v8
    v_sub_f32 v96, 0, v9
    v_sub_f32 v97, 0, v9
    v_mfma_f32_16x16x32_bf16 v[72:75], a[236:239], v[140:143], v[72:75]
    v_sub_f32 v98, 0, v9
    v_sub_f32 v99, 0, v9
    v_add_f32 v40, v40, v88
    v_add_f32 v41, v41, v89
    v_add_f32 v42, v42, v90
    v_mfma_f32_16x16x32_bf16 v[80:83], a[236:239], v[144:147], v[80:83]
    ds_read_b128 a[212:215], v1 offset:4480
    v_add_f32 v43, v43, v91
    v_add_f32 v44, v44, v88
    v_add_f32 v45, v45, v89
    v_add_f32 v46, v46, v90
    v_mfma_f32_16x16x32_bf16 v[68:71], a[240:243], v[100:103], 0
    v_add_f32 v47, v47, v91
    v_add_f32 v48, v48, v92
    v_add_f32 v49, v49, v93
    v_add_f32 v50, v50, v94
    v_add_f32 v51, v51, v95
    v_mfma_f32_16x16x32_bf16 v[76:79], a[240:243], v[104:107], 0
    ds_read_b128 a[216:219], v1 offset:4736
    v_add_f32 v52, v52, v92
    v_add_f32 v53, v53, v93
    v_add_f32 v54, v54, v94
    v_add_f32 v55, v55, v95
    v_mfma_f32_16x16x32_bf16 v[84:87], a[240:243], v[108:111], 0
    v_add_f32 v56, v56, v96
    v_add_f32 v57, v57, v97
    v_add_f32 v58, v58, v98
    v_add_f32 v59, v59, v99
    v_add_f32 v60, v60, v96
    v_mfma_f32_16x16x32_bf16 v[68:71], a[244:247], v[112:115], v[68:71]
    ds_read_b128 a[220:223], v1 offset:4992
    v_add_f32 v61, v61, v97
    v_add_f32 v62, v62, v98
    v_add_f32 v63, v63, v99
    v_exp_f32 v40, v40
    v_mfma_f32_16x16x32_bf16 v[76:79], a[244:247], v[116:119], v[76:79]
    v_exp_f32 v41, v41
    v_exp_f32 v42, v42
    v_exp_f32 v43, v43
    v_exp_f32 v44, v44
    v_mfma_f32_16x16x32_bf16 v[84:87], a[244:247], v[120:123], v[84:87]
    s_add_u32 m0, s25, 126752
    v_exp_f32 v45, v45
    v_cvt_pk_bf16_f32 v16, v40, v41
    v_cvt_pk_bf16_f32 v17, v42, v43
    v_exp_f32 v46, v46
    v_exp_f32 v47, v47
    v_mfma_f32_16x16x32_bf16 v[68:71], a[248:251], v[124:127], v[68:71]
    buffer_load_dwordx4 v4, s[16:19], s27 offen offset:1024 nt lds
    v_exp_f32 v48, v48
    v_exp_f32 v49, v49
    v_cvt_pk_bf16_f32 v18, v44, v45
    v_exp_f32 v50, v50
    v_mfma_f32_16x16x32_bf16 v[76:79], a[248:251], v[128:131], v[76:79]
    v_cvt_pk_bf16_f32 v19, v46, v47
    v_exp_f32 v51, v51
    v_exp_f32 v52, v52
    v_exp_f32 v53, v53
    v_cvt_pk_bf16_f32 v20, v48, v49
    v_mfma_f32_16x16x32_bf16 v[84:87], a[248:251], v[132:135], v[84:87]
    v_cvt_pk_bf16_f32 v21, v50, v51
    v_exp_f32 v54, v54
    v_exp_f32 v55, v55
    v_exp_f32 v56, v56
    v_mfma_f32_16x16x32_bf16 v[68:71], a[252:255], v[136:139], v[68:71]
    v_exp_f32 v57, v57
    v_cvt_pk_bf16_f32 v22, v52, v53
    v_exp_f32 v58, v58
    v_cvt_pk_bf16_f32 v23, v54, v55
    v_exp_f32 v59, v59
    v_mfma_f32_16x16x32_bf16 v[76:79], a[252:255], v[140:143], v[76:79]
    v_exp_f32 v60, v60
    v_exp_f32 v61, v61
    v_cvt_pk_bf16_f32 v24, v56, v57
    v_cvt_pk_bf16_f32 v25, v58, v59
    v_mfma_f32_16x16x32_bf16 v[84:87], a[252:255], v[144:147], v[84:87]
    v_exp_f32 v62, v62
    v_exp_f32 v63, v63
    v_cvt_pk_bf16_f32 v26, v60, v61
    v_cvt_pk_bf16_f32 v27, v62, v63
    s_waitcnt lgkmcnt(0)
    s_barrier
    v_add_u32 v2, 0xffffbe00, v2
    v_mfma_f32_16x16x32_bf16 v[40:43], a[192:195], v[100:103], v[88:91]
    ds_read_b64_tr_b16 a[224:225], v2 offset:0
    v_add_f32 v64, v64, v88
    v_add_f32 v65, v65, v89
    v_mfma_f32_16x16x32_bf16 v[48:51], a[192:195], v[104:107], v[92:95]
    ds_read_b64_tr_b16 a[226:227], v2 offset:4224
    v_add_f32 v66, v66, v90
    v_mfma_f32_16x16x32_bf16 v[56:59], a[192:195], v[108:111], v[96:99]
    ds_read_b64_tr_b16 a[228:229], v2 offset:32
    v_add_f32 v67, v67, v91
    v_mfma_f32_16x16x32_bf16 v[40:43], a[196:199], v[112:115], v[40:43]
    ds_read_b64_tr_b16 a[230:231], v2 offset:4256
    v_add_f32 v68, v68, v88
    v_mfma_f32_16x16x32_bf16 v[48:51], a[196:199], v[116:119], v[48:51]
    ds_read_b64_tr_b16 a[232:233], v2 offset:256
    v_add_f32 v69, v69, v89
    v_mfma_f32_16x16x32_bf16 v[56:59], a[196:199], v[120:123], v[56:59]
    ds_read_b64_tr_b16 a[234:235], v2 offset:4480
    v_add_f32 v70, v70, v90
    v_add_f32 v71, v71, v91
    v_mfma_f32_16x16x32_bf16 v[40:43], a[200:203], v[124:127], v[40:43]
    ds_read_b64_tr_b16 a[236:237], v2 offset:288
    s_add_u32 m0, s25, 84480
    v_add_f32 v72, v72, v92
    v_mfma_f32_16x16x32_bf16 v[48:51], a[200:203], v[128:131], v[48:51]
    ds_read_b64_tr_b16 a[238:239], v2 offset:4512
    s_add_u32 s27, s62, 65536
    v_add_f32 v73, v73, v93
    v_mfma_f32_16x16x32_bf16 v[56:59], a[200:203], v[132:135], v[56:59]
    ds_read_b64_tr_b16 a[240:241], v2 offset:512
    buffer_load_dwordx4 v4, s[12:15], s27 offen nt lds
    v_add_f32 v74, v74, v94
    v_mfma_f32_16x16x32_bf16 v[40:43], a[204:207], v[136:139], v[40:43]
    ds_read_b64_tr_b16 a[242:243], v2 offset:4736
    v_add_f32 v75, v75, v95
    v_mfma_f32_16x16x32_bf16 v[48:51], a[204:207], v[140:143], v[48:51]
    ds_read_b64_tr_b16 a[244:245], v2 offset:544
    v_add_f32 v76, v76, v92
    v_mfma_f32_16x16x32_bf16 v[56:59], a[204:207], v[144:147], v[56:59]
    ds_read_b64_tr_b16 a[246:247], v2 offset:4768
    v_add_f32 v77, v77, v93
    v_add_f32 v78, v78, v94
    v_mfma_f32_16x16x32_bf16 v[44:47], a[208:211], v[100:103], v[88:91]
    ds_read_b64_tr_b16 a[248:249], v2 offset:768
    v_add_f32 v79, v79, v95
    v_mfma_f32_16x16x32_bf16 v[52:55], a[208:211], v[104:107], v[92:95]
    ds_read_b64_tr_b16 a[250:251], v2 offset:4992
    v_add_f32 v80, v80, v96
    v_mfma_f32_16x16x32_bf16 v[60:63], a[208:211], v[108:111], v[96:99]
    ds_read_b64_tr_b16 a[252:253], v2 offset:800
    v_add_f32 v81, v81, v97
    v_mfma_f32_16x16x32_bf16 v[44:47], a[212:215], v[112:115], v[44:47]
    ds_read_b64_tr_b16 a[254:255], v2 offset:5024
    v_add_f32 v82, v82, v98
    v_mfma_f32_16x16x32_bf16 v[52:55], a[212:215], v[116:119], v[52:55]
    v_add_f32 v83, v83, v99
    v_mfma_f32_16x16x32_bf16 v[60:63], a[212:215], v[120:123], v[60:63]
    v_add_f32 v84, v84, v96
    v_add_f32 v85, v85, v97
    v_mfma_f32_16x16x32_bf16 v[44:47], a[216:219], v[124:127], v[44:47]
    v_add_f32 v86, v86, v98
    v_mfma_f32_16x16x32_bf16 v[52:55], a[216:219], v[128:131], v[52:55]
    s_add_u32 m0, s25, 84512
    v_add_f32 v87, v87, v99
    v_mfma_f32_16x16x32_bf16 v[60:63], a[216:219], v[132:135], v[60:63]
    buffer_load_dwordx4 v4, s[12:15], s27 offen offset:1024 nt lds
    v_exp_f32 v64, v64
    v_mfma_f32_16x16x32_bf16 v[44:47], a[220:223], v[136:139], v[44:47]
    v_exp_f32 v65, v65
    v_mfma_f32_16x16x32_bf16 v[52:55], a[220:223], v[140:143], v[52:55]
    v_exp_f32 v66, v66
    v_exp_f32 v67, v67
    v_mfma_f32_16x16x32_bf16 v[60:63], a[220:223], v[144:147], v[60:63]
    v_exp_f32 v68, v68
    s_waitcnt lgkmcnt(0)
    v_mfma_f32_16x16x32_bf16 v[160:163], a[224:227], v[16:19], 0
    v_exp_f32 v69, v69
    v_mfma_f32_16x16x32_bf16 v[164:167], a[224:227], v[20:23], 0
    v_add_u32 v1, 0x2100, v1
    v_cvt_pk_bf16_f32 v28, v64, v65
    v_mfma_f32_16x16x32_bf16 v[168:171], a[224:227], v[24:27], 0
    ds_read_b128 a[192:195], v1 offset:0
    v_cvt_pk_bf16_f32 v29, v66, v67
    v_mfma_f32_16x16x32_bf16 v[172:175], a[228:231], v[16:19], 0
    v_exp_f32 v70, v70
    v_mfma_f32_16x16x32_bf16 v[176:179], a[228:231], v[20:23], 0
    ds_read_b128 a[196:199], v1 offset:256
    v_exp_f32 v71, v71
    v_exp_f32 v72, v72
    v_mfma_f32_16x16x32_bf16 v[180:183], a[228:231], v[24:27], 0
    v_exp_f32 v73, v73
    v_mfma_f32_16x16x32_bf16 v[184:187], a[232:235], v[16:19], 0
    ds_read_b128 a[200:203], v1 offset:512
    s_add_u32 m0, s25, 76032
    v_cvt_pk_bf16_f32 v30, v68, v69
    v_mfma_f32_16x16x32_bf16 v[188:191], a[232:235], v[20:23], 0
    s_add_u32 s27, s62, 49152
    v_exp_f32 v74, v74
    v_mfma_f32_16x16x32_bf16 v[192:195], a[232:235], v[24:27], 0
    ds_read_b128 a[204:207], v1 offset:768
    buffer_load_dwordx4 v4, s[16:19], s27 offen nt lds
    v_cvt_pk_bf16_f32 v31, v70, v71
    v_mfma_f32_16x16x32_bf16 v[196:199], a[236:239], v[16:19], 0
    v_exp_f32 v75, v75
    v_mfma_f32_16x16x32_bf16 v[200:203], a[236:239], v[20:23], 0
    ds_read_b128 a[208:211], v1 offset:4224
    v_exp_f32 v76, v76
    v_exp_f32 v77, v77
    v_mfma_f32_16x16x32_bf16 v[204:207], a[236:239], v[24:27], 0
    v_cvt_pk_bf16_f32 v32, v72, v73
    v_mfma_f32_16x16x32_bf16 v[208:211], a[240:243], v[16:19], 0
    ds_read_b128 a[212:215], v1 offset:4480
    v_cvt_pk_bf16_f32 v33, v74, v75
    v_mfma_f32_16x16x32_bf16 v[212:215], a[240:243], v[20:23], 0
    v_exp_f32 v78, v78
    v_mfma_f32_16x16x32_bf16 v[216:219], a[240:243], v[24:27], 0
    ds_read_b128 a[216:219], v1 offset:4736
    v_exp_f32 v79, v79
    v_mfma_f32_16x16x32_bf16 v[220:223], a[244:247], v[16:19], 0
    v_exp_f32 v80, v80
    v_exp_f32 v81, v81
    v_mfma_f32_16x16x32_bf16 v[224:227], a[244:247], v[20:23], 0
    ds_read_b128 a[220:223], v1 offset:4992
    v_cvt_pk_bf16_f32 v34, v76, v77
    v_mfma_f32_16x16x32_bf16 v[228:231], a[244:247], v[24:27], 0
    v_exp_f32 v82, v82
    v_mfma_f32_16x16x32_bf16 v[232:235], a[248:251], v[16:19], 0
    v_cvt_pk_bf16_f32 v35, v78, v79
    v_mfma_f32_16x16x32_bf16 v[236:239], a[248:251], v[20:23], 0
    s_add_u32 m0, s25, 76064
    v_exp_f32 v83, v83
    v_mfma_f32_16x16x32_bf16 v[240:243], a[248:251], v[24:27], 0
    buffer_load_dwordx4 v4, s[16:19], s27 offen offset:1024 nt lds
    v_exp_f32 v84, v84
    v_mfma_f32_16x16x32_bf16 v[244:247], a[252:255], v[16:19], 0
    v_exp_f32 v85, v85
    v_cvt_pk_bf16_f32 v36, v80, v81
    v_mfma_f32_16x16x32_bf16 v[248:251], a[252:255], v[20:23], 0
    v_cvt_pk_bf16_f32 v37, v82, v83
    v_mfma_f32_16x16x32_bf16 v[252:255], a[252:255], v[24:27], 0
    v_exp_f32 v86, v86
    v_mfma_f32_16x16x32_bf16 v[148:151], v[12:15], v[16:19], 0
    v_exp_f32 v87, v87
    v_mfma_f32_16x16x32_bf16 v[152:155], v[12:15], v[20:23], 0
    v_cvt_pk_bf16_f32 v38, v84, v85
    v_mfma_f32_16x16x32_bf16 v[156:159], v[12:15], v[24:27], 0
    v_cvt_pk_bf16_f32 v39, v86, v87
    s_waitcnt lgkmcnt(0)
    v_add_u32 v2, 0x14a00, v2
    v_mfma_f32_16x16x32_bf16 v[64:67], a[192:195], v[100:103], v[88:91]
    ds_read_b64_tr_b16 a[224:225], v2 offset:0
    v_exp_f32 v40, v40
    v_mfma_f32_16x16x32_bf16 v[72:75], a[192:195], v[104:107], v[92:95]
    ds_read_b64_tr_b16 a[226:227], v2 offset:4224
    v_exp_f32 v41, v41
    v_mfma_f32_16x16x32_bf16 v[80:83], a[192:195], v[108:111], v[96:99]
    ds_read_b64_tr_b16 a[228:229], v2 offset:32
    v_exp_f32 v42, v42
    v_mfma_f32_16x16x32_bf16 v[64:67], a[196:199], v[112:115], v[64:67]
    ds_read_b64_tr_b16 a[230:231], v2 offset:4256
    v_mfma_f32_16x16x32_bf16 v[72:75], a[196:199], v[116:119], v[72:75]
    ds_read_b64_tr_b16 a[232:233], v2 offset:256
    v_exp_f32 v43, v43
    v_mfma_f32_16x16x32_bf16 v[80:83], a[196:199], v[120:123], v[80:83]
    ds_read_b64_tr_b16 a[234:235], v2 offset:4480
    v_exp_f32 v44, v44
    v_mfma_f32_16x16x32_bf16 v[64:67], a[200:203], v[124:127], v[64:67]
    ds_read_b64_tr_b16 a[236:237], v2 offset:288
    v_mfma_f32_16x16x32_bf16 v[72:75], a[200:203], v[128:131], v[72:75]
    ds_read_b64_tr_b16 a[238:239], v2 offset:4512
    v_exp_f32 v45, v45
    v_mfma_f32_16x16x32_bf16 v[80:83], a[200:203], v[132:135], v[80:83]
    ds_read_b64_tr_b16 a[240:241], v2 offset:512
    v_cvt_pk_bf16_f32 v16, v40, v41
    v_mfma_f32_16x16x32_bf16 v[64:67], a[204:207], v[136:139], v[64:67]
    ds_read_b64_tr_b16 a[242:243], v2 offset:4736
    v_cvt_pk_bf16_f32 v17, v42, v43
    v_mfma_f32_16x16x32_bf16 v[72:75], a[204:207], v[140:143], v[72:75]
    ds_read_b64_tr_b16 a[244:245], v2 offset:544
    v_mfma_f32_16x16x32_bf16 v[80:83], a[204:207], v[144:147], v[80:83]
    ds_read_b64_tr_b16 a[246:247], v2 offset:4768
    v_exp_f32 v46, v46
    v_mfma_f32_16x16x32_bf16 v[68:71], a[208:211], v[100:103], v[88:91]
    ds_read_b64_tr_b16 a[248:249], v2 offset:768
    s_add_u32 m0, s25, 42240
    v_exp_f32 v47, v47
    v_mfma_f32_16x16x32_bf16 v[76:79], a[208:211], v[104:107], v[92:95]
    ds_read_b64_tr_b16 a[250:251], v2 offset:4992
    s_add_u32 s27, s62, 73728
    v_mfma_f32_16x16x32_bf16 v[84:87], a[208:211], v[108:111], v[96:99]
    ds_read_b64_tr_b16 a[252:253], v2 offset:800
    buffer_load_dwordx4 v4, s[12:15], s27 offen nt lds
    v_exp_f32 v48, v48
    v_mfma_f32_16x16x32_bf16 v[68:71], a[212:215], v[112:115], v[68:71]
    ds_read_b64_tr_b16 a[254:255], v2 offset:5024
    v_exp_f32 v49, v49
    v_mfma_f32_16x16x32_bf16 v[76:79], a[212:215], v[116:119], v[76:79]
    v_mfma_f32_16x16x32_bf16 v[84:87], a[212:215], v[120:123], v[84:87]
    v_cvt_pk_bf16_f32 v18, v44, v45
    v_mfma_f32_16x16x32_bf16 v[68:71], a[216:219], v[124:127], v[68:71]
    v_exp_f32 v50, v50
    v_mfma_f32_16x16x32_bf16 v[76:79], a[216:219], v[128:131], v[76:79]
    v_cvt_pk_bf16_f32 v19, v46, v47
    v_mfma_f32_16x16x32_bf16 v[84:87], a[216:219], v[132:135], v[84:87]
    v_mfma_f32_16x16x32_bf16 v[68:71], a[220:223], v[136:139], v[68:71]
    v_exp_f32 v51, v51
    v_mfma_f32_16x16x32_bf16 v[76:79], a[220:223], v[140:143], v[76:79]
    v_exp_f32 v52, v52
    v_mfma_f32_16x16x32_bf16 v[84:87], a[220:223], v[144:147], v[84:87]
    s_waitcnt lgkmcnt(0)
    v_mfma_f32_16x16x32_bf16 v[160:163], a[224:227], v[28:31], v[160:163]
    v_exp_f32 v53, v53
    v_mfma_f32_16x16x32_bf16 v[164:167], a[224:227], v[32:35], v[164:167]
    v_add_u32 v1, 0xe700, v1
    v_cvt_pk_bf16_f32 v20, v48, v49
    v_mfma_f32_16x16x32_bf16 v[168:171], a[224:227], v[36:39], v[168:171]
    ds_read_b128 a[192:195], v1 offset:0
    v_cvt_pk_bf16_f32 v21, v50, v51
    v_mfma_f32_16x16x32_bf16 v[172:175], a[228:231], v[28:31], v[172:175]
    v_mfma_f32_16x16x32_bf16 v[176:179], a[228:231], v[32:35], v[176:179]
    ds_read_b128 a[196:199], v1 offset:256
    v_exp_f32 v54, v54
    v_mfma_f32_16x16x32_bf16 v[180:183], a[228:231], v[36:39], v[180:183]
    v_exp_f32 v55, v55
    v_mfma_f32_16x16x32_bf16 v[184:187], a[232:235], v[28:31], v[184:187]
    ds_read_b128 a[200:203], v1 offset:512
    v_mfma_f32_16x16x32_bf16 v[188:191], a[232:235], v[32:35], v[188:191]
    v_exp_f32 v56, v56
    v_mfma_f32_16x16x32_bf16 v[192:195], a[232:235], v[36:39], v[192:195]
    ds_read_b128 a[204:207], v1 offset:768
    v_exp_f32 v57, v57
    v_mfma_f32_16x16x32_bf16 v[196:199], a[236:239], v[28:31], v[196:199]
    v_mfma_f32_16x16x32_bf16 v[200:203], a[236:239], v[32:35], v[200:203]
    ds_read_b128 a[208:211], v1 offset:4224
    v_cvt_pk_bf16_f32 v22, v52, v53
    v_mfma_f32_16x16x32_bf16 v[204:207], a[236:239], v[36:39], v[204:207]
    v_exp_f32 v58, v58
    v_mfma_f32_16x16x32_bf16 v[208:211], a[240:243], v[28:31], v[208:211]
    ds_read_b128 a[212:215], v1 offset:4480
    v_cvt_pk_bf16_f32 v23, v54, v55
    v_mfma_f32_16x16x32_bf16 v[212:215], a[240:243], v[32:35], v[212:215]
    s_add_u32 m0, s25, 42272
    v_mfma_f32_16x16x32_bf16 v[216:219], a[240:243], v[36:39], v[216:219]
    ds_read_b128 a[216:219], v1 offset:4736
    buffer_load_dwordx4 v4, s[12:15], s27 offen offset:1024 nt lds
    v_exp_f32 v59, v59
    v_mfma_f32_16x16x32_bf16 v[220:223], a[244:247], v[28:31], v[220:223]
    v_exp_f32 v60, v60
    v_mfma_f32_16x16x32_bf16 v[224:227], a[244:247], v[32:35], v[224:227]
    ds_read_b128 a[220:223], v1 offset:4992
    v_mfma_f32_16x16x32_bf16 v[228:231], a[244:247], v[36:39], v[228:231]
    v_exp_f32 v61, v61
    v_mfma_f32_16x16x32_bf16 v[232:235], a[248:251], v[28:31], v[232:235]
    v_cvt_pk_bf16_f32 v24, v56, v57
    v_mfma_f32_16x16x32_bf16 v[236:239], a[248:251], v[32:35], v[236:239]
    v_cvt_pk_bf16_f32 v25, v58, v59
    v_mfma_f32_16x16x32_bf16 v[240:243], a[248:251], v[36:39], v[240:243]
    v_mfma_f32_16x16x32_bf16 v[244:247], a[252:255], v[28:31], v[244:247]
    v_exp_f32 v62, v62
    v_mfma_f32_16x16x32_bf16 v[248:251], a[252:255], v[32:35], v[248:251]
    v_exp_f32 v63, v63
    v_mfma_f32_16x16x32_bf16 v[252:255], a[252:255], v[36:39], v[252:255]
    v_mfma_f32_16x16x32_bf16 v[148:151], v[12:15], v[28:31], v[148:151]
    v_cvt_pk_bf16_f32 v26, v60, v61
    v_mfma_f32_16x16x32_bf16 v[152:155], v[12:15], v[32:35], v[152:155]
    v_cvt_pk_bf16_f32 v27, v62, v63
    v_mfma_f32_16x16x32_bf16 v[156:159], v[12:15], v[36:39], v[156:159]
    s_waitcnt lgkmcnt(0)
    s_waitcnt vmcnt(12)
    s_barrier
    v_add_u32 v2, 0xffffbe00, v2
    v_mfma_f32_16x16x32_bf16 v[40:43], a[192:195], v[100:103], v[88:91]
    ds_read_b64_tr_b16 a[224:225], v2 offset:0
    v_exp_f32 v64, v64
    v_mfma_f32_16x16x32_bf16 v[48:51], a[192:195], v[104:107], v[92:95]
    ds_read_b64_tr_b16 a[226:227], v2 offset:4224
    v_exp_f32 v65, v65
    v_mfma_f32_16x16x32_bf16 v[56:59], a[192:195], v[108:111], v[96:99]
    ds_read_b64_tr_b16 a[228:229], v2 offset:32
    v_exp_f32 v66, v66
    v_mfma_f32_16x16x32_bf16 v[40:43], a[196:199], v[112:115], v[40:43]
    ds_read_b64_tr_b16 a[230:231], v2 offset:4256
    v_mfma_f32_16x16x32_bf16 v[48:51], a[196:199], v[116:119], v[48:51]
    ds_read_b64_tr_b16 a[232:233], v2 offset:256
    v_exp_f32 v67, v67
    v_mfma_f32_16x16x32_bf16 v[56:59], a[196:199], v[120:123], v[56:59]
    ds_read_b64_tr_b16 a[234:235], v2 offset:4480
    v_exp_f32 v68, v68
    v_mfma_f32_16x16x32_bf16 v[40:43], a[200:203], v[124:127], v[40:43]
    ds_read_b64_tr_b16 a[236:237], v2 offset:288
    s_add_u32 m0, s25, 118272
    v_mfma_f32_16x16x32_bf16 v[48:51], a[200:203], v[128:131], v[48:51]
    ds_read_b64_tr_b16 a[238:239], v2 offset:4512
    s_add_u32 s27, s62, 57344
    v_exp_f32 v69, v69
    v_mfma_f32_16x16x32_bf16 v[56:59], a[200:203], v[132:135], v[56:59]
    ds_read_b64_tr_b16 a[240:241], v2 offset:512
    buffer_load_dwordx4 v4, s[16:19], s27 offen nt lds
    v_cvt_pk_bf16_f32 v28, v64, v65
    v_mfma_f32_16x16x32_bf16 v[40:43], a[204:207], v[136:139], v[40:43]
    ds_read_b64_tr_b16 a[242:243], v2 offset:4736
    v_cvt_pk_bf16_f32 v29, v66, v67
    v_mfma_f32_16x16x32_bf16 v[48:51], a[204:207], v[140:143], v[48:51]
    ds_read_b64_tr_b16 a[244:245], v2 offset:544
    v_mfma_f32_16x16x32_bf16 v[56:59], a[204:207], v[144:147], v[56:59]
    ds_read_b64_tr_b16 a[246:247], v2 offset:4768
    v_exp_f32 v70, v70
    v_mfma_f32_16x16x32_bf16 v[44:47], a[208:211], v[100:103], v[88:91]
    ds_read_b64_tr_b16 a[248:249], v2 offset:768
    v_exp_f32 v71, v71
    v_mfma_f32_16x16x32_bf16 v[52:55], a[208:211], v[104:107], v[92:95]
    ds_read_b64_tr_b16 a[250:251], v2 offset:4992
    v_mfma_f32_16x16x32_bf16 v[60:63], a[208:211], v[108:111], v[96:99]
    ds_read_b64_tr_b16 a[252:253], v2 offset:800
    v_exp_f32 v72, v72
    v_mfma_f32_16x16x32_bf16 v[44:47], a[212:215], v[112:115], v[44:47]
    ds_read_b64_tr_b16 a[254:255], v2 offset:5024
    v_exp_f32 v73, v73
    v_mfma_f32_16x16x32_bf16 v[52:55], a[212:215], v[116:119], v[52:55]
    v_mfma_f32_16x16x32_bf16 v[60:63], a[212:215], v[120:123], v[60:63]
    v_cvt_pk_bf16_f32 v30, v68, v69
    v_mfma_f32_16x16x32_bf16 v[44:47], a[216:219], v[124:127], v[44:47]
    v_exp_f32 v74, v74
    v_mfma_f32_16x16x32_bf16 v[52:55], a[216:219], v[128:131], v[52:55]
    s_add_u32 m0, s25, 118304
    v_cvt_pk_bf16_f32 v31, v70, v71
    v_mfma_f32_16x16x32_bf16 v[60:63], a[216:219], v[132:135], v[60:63]
    buffer_load_dwordx4 v4, s[16:19], s27 offen offset:1024 nt lds
    v_mfma_f32_16x16x32_bf16 v[44:47], a[220:223], v[136:139], v[44:47]
    v_exp_f32 v75, v75
    v_mfma_f32_16x16x32_bf16 v[52:55], a[220:223], v[140:143], v[52:55]
    v_exp_f32 v76, v76
    v_mfma_f32_16x16x32_bf16 v[60:63], a[220:223], v[144:147], v[60:63]
    s_waitcnt lgkmcnt(0)
    v_mfma_f32_16x16x32_bf16 v[160:163], a[224:227], v[16:19], v[160:163]
    v_exp_f32 v77, v77
    v_mfma_f32_16x16x32_bf16 v[164:167], a[224:227], v[20:23], v[164:167]
    v_add_u32 v1, 0xffffbe00, v1
    v_cvt_pk_bf16_f32 v32, v72, v73
    v_mfma_f32_16x16x32_bf16 v[168:171], a[224:227], v[24:27], v[168:171]
    ds_read_b128 a[192:195], v1 offset:0
    v_cvt_pk_bf16_f32 v33, v74, v75
    v_mfma_f32_16x16x32_bf16 v[172:175], a[228:231], v[16:19], v[172:175]
    v_mfma_f32_16x16x32_bf16 v[176:179], a[228:231], v[20:23], v[176:179]
    ds_read_b128 a[196:199], v1 offset:256
    v_exp_f32 v78, v78
    v_mfma_f32_16x16x32_bf16 v[180:183], a[228:231], v[24:27], v[180:183]
    v_exp_f32 v79, v79
    v_mfma_f32_16x16x32_bf16 v[184:187], a[232:235], v[16:19], v[184:187]
    ds_read_b128 a[200:203], v1 offset:512
    s_add_u32 m0, s25, 109824
    v_mfma_f32_16x16x32_bf16 v[188:191], a[232:235], v[20:23], v[188:191]
    s_add_u32 s27, s62, 81920
    v_exp_f32 v80, v80
    v_mfma_f32_16x16x32_bf16 v[192:195], a[232:235], v[24:27], v[192:195]
    ds_read_b128 a[204:207], v1 offset:768
    buffer_load_dwordx4 v4, s[12:15], s27 offen nt lds
    v_exp_f32 v81, v81
    v_mfma_f32_16x16x32_bf16 v[196:199], a[236:239], v[16:19], v[196:199]
    v_mfma_f32_16x16x32_bf16 v[200:203], a[236:239], v[20:23], v[200:203]
    ds_read_b128 a[208:211], v1 offset:4224
    v_cvt_pk_bf16_f32 v34, v76, v77
    v_mfma_f32_16x16x32_bf16 v[204:207], a[236:239], v[24:27], v[204:207]
    v_exp_f32 v82, v82
    v_mfma_f32_16x16x32_bf16 v[208:211], a[240:243], v[16:19], v[208:211]
    ds_read_b128 a[212:215], v1 offset:4480
    v_cvt_pk_bf16_f32 v35, v78, v79
    v_mfma_f32_16x16x32_bf16 v[212:215], a[240:243], v[20:23], v[212:215]
    v_mfma_f32_16x16x32_bf16 v[216:219], a[240:243], v[24:27], v[216:219]
    ds_read_b128 a[216:219], v1 offset:4736
    v_exp_f32 v83, v83
    v_mfma_f32_16x16x32_bf16 v[220:223], a[244:247], v[16:19], v[220:223]
    v_exp_f32 v84, v84
    v_mfma_f32_16x16x32_bf16 v[224:227], a[244:247], v[20:23], v[224:227]
    ds_read_b128 a[220:223], v1 offset:4992
    v_mfma_f32_16x16x32_bf16 v[228:231], a[244:247], v[24:27], v[228:231]
    v_exp_f32 v85, v85
    v_mfma_f32_16x16x32_bf16 v[232:235], a[248:251], v[16:19], v[232:235]
    v_cvt_pk_bf16_f32 v36, v80, v81
    v_mfma_f32_16x16x32_bf16 v[236:239], a[248:251], v[20:23], v[236:239]
    s_add_u32 m0, s25, 109856
    v_cvt_pk_bf16_f32 v37, v82, v83
    v_mfma_f32_16x16x32_bf16 v[240:243], a[248:251], v[24:27], v[240:243]
    buffer_load_dwordx4 v4, s[12:15], s27 offen offset:1024 nt lds
    v_mfma_f32_16x16x32_bf16 v[244:247], a[252:255], v[16:19], v[244:247]
    v_exp_f32 v86, v86
    v_mfma_f32_16x16x32_bf16 v[248:251], a[252:255], v[20:23], v[248:251]
    v_exp_f32 v87, v87
    v_mfma_f32_16x16x32_bf16 v[252:255], a[252:255], v[24:27], v[252:255]
    v_mfma_f32_16x16x32_bf16 v[148:151], v[12:15], v[16:19], v[148:151]
    v_cvt_pk_bf16_f32 v38, v84, v85
    v_mfma_f32_16x16x32_bf16 v[152:155], v[12:15], v[20:23], v[152:155]
    v_cvt_pk_bf16_f32 v39, v86, v87
    v_mfma_f32_16x16x32_bf16 v[156:159], v[12:15], v[24:27], v[156:159]
    s_waitcnt lgkmcnt(0)
    v_add_u32 v2, 0xffff7c00, v2
    v_mfma_f32_16x16x32_bf16 v[64:67], a[192:195], v[100:103], v[88:91]
    ds_read_b64_tr_b16 a[224:225], v2 offset:0
    v_exp_f32 v40, v40
    v_mfma_f32_16x16x32_bf16 v[72:75], a[192:195], v[104:107], v[92:95]
    ds_read_b64_tr_b16 a[226:227], v2 offset:4224
    v_exp_f32 v41, v41
    v_mfma_f32_16x16x32_bf16 v[80:83], a[192:195], v[108:111], v[96:99]
    ds_read_b64_tr_b16 a[228:229], v2 offset:32
    v_exp_f32 v42, v42
    v_mfma_f32_16x16x32_bf16 v[64:67], a[196:199], v[112:115], v[64:67]
    ds_read_b64_tr_b16 a[230:231], v2 offset:4256
    v_mfma_f32_16x16x32_bf16 v[72:75], a[196:199], v[116:119], v[72:75]
    ds_read_b64_tr_b16 a[232:233], v2 offset:256
    v_exp_f32 v43, v43
    v_mfma_f32_16x16x32_bf16 v[80:83], a[196:199], v[120:123], v[80:83]
    ds_read_b64_tr_b16 a[234:235], v2 offset:4480
    v_exp_f32 v44, v44
    v_mfma_f32_16x16x32_bf16 v[64:67], a[200:203], v[124:127], v[64:67]
    ds_read_b64_tr_b16 a[236:237], v2 offset:288
    v_mfma_f32_16x16x32_bf16 v[72:75], a[200:203], v[128:131], v[72:75]
    ds_read_b64_tr_b16 a[238:239], v2 offset:4512
    v_exp_f32 v45, v45
    v_mfma_f32_16x16x32_bf16 v[80:83], a[200:203], v[132:135], v[80:83]
    ds_read_b64_tr_b16 a[240:241], v2 offset:512
    v_cvt_pk_bf16_f32 v16, v40, v41
    v_mfma_f32_16x16x32_bf16 v[64:67], a[204:207], v[136:139], v[64:67]
    ds_read_b64_tr_b16 a[242:243], v2 offset:4736
    v_cvt_pk_bf16_f32 v17, v42, v43
    v_mfma_f32_16x16x32_bf16 v[72:75], a[204:207], v[140:143], v[72:75]
    ds_read_b64_tr_b16 a[244:245], v2 offset:544
    v_mfma_f32_16x16x32_bf16 v[80:83], a[204:207], v[144:147], v[80:83]
    ds_read_b64_tr_b16 a[246:247], v2 offset:4768
    v_exp_f32 v46, v46
    v_mfma_f32_16x16x32_bf16 v[68:71], a[208:211], v[100:103], v[88:91]
    ds_read_b64_tr_b16 a[248:249], v2 offset:768
    s_add_u32 m0, s25, 50688
    v_exp_f32 v47, v47
    v_mfma_f32_16x16x32_bf16 v[76:79], a[208:211], v[104:107], v[92:95]
    ds_read_b64_tr_b16 a[250:251], v2 offset:4992
    s_add_u32 s27, s62, 65536
    v_mfma_f32_16x16x32_bf16 v[84:87], a[208:211], v[108:111], v[96:99]
    ds_read_b64_tr_b16 a[252:253], v2 offset:800
    buffer_load_dwordx4 v4, s[16:19], s27 offen nt lds
    v_exp_f32 v48, v48
    v_mfma_f32_16x16x32_bf16 v[68:71], a[212:215], v[112:115], v[68:71]
    ds_read_b64_tr_b16 a[254:255], v2 offset:5024
    v_exp_f32 v49, v49
    v_mfma_f32_16x16x32_bf16 v[76:79], a[212:215], v[116:119], v[76:79]
    v_mfma_f32_16x16x32_bf16 v[84:87], a[212:215], v[120:123], v[84:87]
    v_cvt_pk_bf16_f32 v18, v44, v45
    v_mfma_f32_16x16x32_bf16 v[68:71], a[216:219], v[124:127], v[68:71]
    v_exp_f32 v50, v50
    v_mfma_f32_16x16x32_bf16 v[76:79], a[216:219], v[128:131], v[76:79]
    v_cvt_pk_bf16_f32 v19, v46, v47
    v_mfma_f32_16x16x32_bf16 v[84:87], a[216:219], v[132:135], v[84:87]
    v_mfma_f32_16x16x32_bf16 v[68:71], a[220:223], v[136:139], v[68:71]
    v_exp_f32 v51, v51
    v_mfma_f32_16x16x32_bf16 v[76:79], a[220:223], v[140:143], v[76:79]
    v_exp_f32 v52, v52
    v_mfma_f32_16x16x32_bf16 v[84:87], a[220:223], v[144:147], v[84:87]
    s_waitcnt lgkmcnt(0)
    v_mfma_f32_16x16x32_bf16 v[160:163], a[224:227], v[28:31], v[160:163]
    v_exp_f32 v53, v53
    v_mfma_f32_16x16x32_bf16 v[164:167], a[224:227], v[32:35], v[164:167]
    v_add_u32 v1, 0xffff7c00, v1
    v_cvt_pk_bf16_f32 v20, v48, v49
    v_mfma_f32_16x16x32_bf16 v[168:171], a[224:227], v[36:39], v[168:171]
    ds_read_b128 a[192:195], v1 offset:0
    v_cvt_pk_bf16_f32 v21, v50, v51
    v_mfma_f32_16x16x32_bf16 v[172:175], a[228:231], v[28:31], v[172:175]
    v_mfma_f32_16x16x32_bf16 v[176:179], a[228:231], v[32:35], v[176:179]
    ds_read_b128 a[196:199], v1 offset:256
    v_exp_f32 v54, v54
    v_mfma_f32_16x16x32_bf16 v[180:183], a[228:231], v[36:39], v[180:183]
    v_exp_f32 v55, v55
    v_mfma_f32_16x16x32_bf16 v[184:187], a[232:235], v[28:31], v[184:187]
    ds_read_b128 a[200:203], v1 offset:512
    v_mfma_f32_16x16x32_bf16 v[188:191], a[232:235], v[32:35], v[188:191]
    v_exp_f32 v56, v56
    v_mfma_f32_16x16x32_bf16 v[192:195], a[232:235], v[36:39], v[192:195]
    ds_read_b128 a[204:207], v1 offset:768
    v_exp_f32 v57, v57
    v_mfma_f32_16x16x32_bf16 v[196:199], a[236:239], v[28:31], v[196:199]
    v_mfma_f32_16x16x32_bf16 v[200:203], a[236:239], v[32:35], v[200:203]
    ds_read_b128 a[208:211], v1 offset:4224
    v_cvt_pk_bf16_f32 v22, v52, v53
    v_mfma_f32_16x16x32_bf16 v[204:207], a[236:239], v[36:39], v[204:207]
    v_exp_f32 v58, v58
    v_mfma_f32_16x16x32_bf16 v[208:211], a[240:243], v[28:31], v[208:211]
    ds_read_b128 a[212:215], v1 offset:4480
    v_cvt_pk_bf16_f32 v23, v54, v55
    v_mfma_f32_16x16x32_bf16 v[212:215], a[240:243], v[32:35], v[212:215]
    s_add_u32 m0, s25, 50720
    v_mfma_f32_16x16x32_bf16 v[216:219], a[240:243], v[36:39], v[216:219]
    ds_read_b128 a[216:219], v1 offset:4736
    buffer_load_dwordx4 v4, s[16:19], s27 offen offset:1024 nt lds
    v_exp_f32 v59, v59
    v_mfma_f32_16x16x32_bf16 v[220:223], a[244:247], v[28:31], v[220:223]
    v_exp_f32 v60, v60
    v_mfma_f32_16x16x32_bf16 v[224:227], a[244:247], v[32:35], v[224:227]
    ds_read_b128 a[220:223], v1 offset:4992
    v_mfma_f32_16x16x32_bf16 v[228:231], a[244:247], v[36:39], v[228:231]
    v_exp_f32 v61, v61
    v_mfma_f32_16x16x32_bf16 v[232:235], a[248:251], v[28:31], v[232:235]
    v_cvt_pk_bf16_f32 v24, v56, v57
    v_mfma_f32_16x16x32_bf16 v[236:239], a[248:251], v[32:35], v[236:239]
    v_cvt_pk_bf16_f32 v25, v58, v59
    v_mfma_f32_16x16x32_bf16 v[240:243], a[248:251], v[36:39], v[240:243]
    v_mfma_f32_16x16x32_bf16 v[244:247], a[252:255], v[28:31], v[244:247]
    v_exp_f32 v62, v62
    v_mfma_f32_16x16x32_bf16 v[248:251], a[252:255], v[32:35], v[248:251]
    v_exp_f32 v63, v63
    v_mfma_f32_16x16x32_bf16 v[252:255], a[252:255], v[36:39], v[252:255]
    v_mfma_f32_16x16x32_bf16 v[148:151], v[12:15], v[28:31], v[148:151]
    v_cvt_pk_bf16_f32 v26, v60, v61
    v_mfma_f32_16x16x32_bf16 v[152:155], v[12:15], v[32:35], v[152:155]
    v_cvt_pk_bf16_f32 v27, v62, v63
    v_mfma_f32_16x16x32_bf16 v[156:159], v[12:15], v[36:39], v[156:159]
    s_waitcnt lgkmcnt(0)
    s_waitcnt vmcnt(10)
    s_barrier
    v_add_u32 v2, 0x12900, v2
    v_mfma_f32_16x16x32_bf16 v[40:43], a[192:195], v[100:103], v[88:91]
    ds_read_b64_tr_b16 a[224:225], v2 offset:0
    v_exp_f32 v64, v64
    v_mfma_f32_16x16x32_bf16 v[48:51], a[192:195], v[104:107], v[92:95]
    ds_read_b64_tr_b16 a[226:227], v2 offset:4224
    v_exp_f32 v65, v65
    v_mfma_f32_16x16x32_bf16 v[56:59], a[192:195], v[108:111], v[96:99]
    ds_read_b64_tr_b16 a[228:229], v2 offset:32
    v_exp_f32 v66, v66
    v_mfma_f32_16x16x32_bf16 v[40:43], a[196:199], v[112:115], v[40:43]
    ds_read_b64_tr_b16 a[230:231], v2 offset:4256
    v_mfma_f32_16x16x32_bf16 v[48:51], a[196:199], v[116:119], v[48:51]
    ds_read_b64_tr_b16 a[232:233], v2 offset:256
    v_exp_f32 v67, v67
    v_mfma_f32_16x16x32_bf16 v[56:59], a[196:199], v[120:123], v[56:59]
    ds_read_b64_tr_b16 a[234:235], v2 offset:4480
    v_exp_f32 v68, v68
    v_mfma_f32_16x16x32_bf16 v[40:43], a[200:203], v[124:127], v[40:43]
    ds_read_b64_tr_b16 a[236:237], v2 offset:288
    s_add_u32 m0, s25, 101376
    v_mfma_f32_16x16x32_bf16 v[48:51], a[200:203], v[128:131], v[48:51]
    ds_read_b64_tr_b16 a[238:239], v2 offset:4512
    s_add_u32 s27, s62, 90112
    v_exp_f32 v69, v69
    v_mfma_f32_16x16x32_bf16 v[56:59], a[200:203], v[132:135], v[56:59]
    ds_read_b64_tr_b16 a[240:241], v2 offset:512
    buffer_load_dwordx4 v4, s[12:15], s27 offen nt lds
    v_cvt_pk_bf16_f32 v28, v64, v65
    v_mfma_f32_16x16x32_bf16 v[40:43], a[204:207], v[136:139], v[40:43]
    ds_read_b64_tr_b16 a[242:243], v2 offset:4736
    v_cvt_pk_bf16_f32 v29, v66, v67
    v_mfma_f32_16x16x32_bf16 v[48:51], a[204:207], v[140:143], v[48:51]
    ds_read_b64_tr_b16 a[244:245], v2 offset:544
    v_mfma_f32_16x16x32_bf16 v[56:59], a[204:207], v[144:147], v[56:59]
    ds_read_b64_tr_b16 a[246:247], v2 offset:4768
    v_exp_f32 v70, v70
    v_mfma_f32_16x16x32_bf16 v[44:47], a[208:211], v[100:103], v[88:91]
    ds_read_b64_tr_b16 a[248:249], v2 offset:768
    v_exp_f32 v71, v71
    v_mfma_f32_16x16x32_bf16 v[52:55], a[208:211], v[104:107], v[92:95]
    ds_read_b64_tr_b16 a[250:251], v2 offset:4992
    v_mfma_f32_16x16x32_bf16 v[60:63], a[208:211], v[108:111], v[96:99]
    ds_read_b64_tr_b16 a[252:253], v2 offset:800
    v_exp_f32 v72, v72
    v_mfma_f32_16x16x32_bf16 v[44:47], a[212:215], v[112:115], v[44:47]
    ds_read_b64_tr_b16 a[254:255], v2 offset:5024
    v_exp_f32 v73, v73
    v_mfma_f32_16x16x32_bf16 v[52:55], a[212:215], v[116:119], v[52:55]
    v_mfma_f32_16x16x32_bf16 v[60:63], a[212:215], v[120:123], v[60:63]
    v_cvt_pk_bf16_f32 v30, v68, v69
    v_mfma_f32_16x16x32_bf16 v[44:47], a[216:219], v[124:127], v[44:47]
    v_exp_f32 v74, v74
    v_mfma_f32_16x16x32_bf16 v[52:55], a[216:219], v[128:131], v[52:55]
    s_add_u32 m0, s25, 101408
    v_cvt_pk_bf16_f32 v31, v70, v71
    v_mfma_f32_16x16x32_bf16 v[60:63], a[216:219], v[132:135], v[60:63]
    buffer_load_dwordx4 v4, s[12:15], s27 offen offset:1024 nt lds
    v_mfma_f32_16x16x32_bf16 v[44:47], a[220:223], v[136:139], v[44:47]
    v_exp_f32 v75, v75
    v_mfma_f32_16x16x32_bf16 v[52:55], a[220:223], v[140:143], v[52:55]
    v_exp_f32 v76, v76
    v_mfma_f32_16x16x32_bf16 v[60:63], a[220:223], v[144:147], v[60:63]
    s_waitcnt lgkmcnt(0)
    v_mfma_f32_16x16x32_bf16 v[160:163], a[224:227], v[16:19], v[160:163]
    v_exp_f32 v77, v77
    v_mfma_f32_16x16x32_bf16 v[164:167], a[224:227], v[20:23], v[164:167]
    v_add_u32 v1, 0x12900, v1
    v_cvt_pk_bf16_f32 v32, v72, v73
    v_mfma_f32_16x16x32_bf16 v[168:171], a[224:227], v[24:27], v[168:171]
    ds_read_b128 a[192:195], v1 offset:0
    v_cvt_pk_bf16_f32 v33, v74, v75
    v_mfma_f32_16x16x32_bf16 v[172:175], a[228:231], v[16:19], v[172:175]
    v_mfma_f32_16x16x32_bf16 v[176:179], a[228:231], v[20:23], v[176:179]
    ds_read_b128 a[196:199], v1 offset:256
    v_exp_f32 v78, v78
    v_mfma_f32_16x16x32_bf16 v[180:183], a[228:231], v[24:27], v[180:183]
    v_exp_f32 v79, v79
    v_mfma_f32_16x16x32_bf16 v[184:187], a[232:235], v[16:19], v[184:187]
    ds_read_b128 a[200:203], v1 offset:512
    s_add_u32 m0, s25, 92928
    v_mfma_f32_16x16x32_bf16 v[188:191], a[232:235], v[20:23], v[188:191]
    s_add_u32 s27, s62, 73728
    v_exp_f32 v80, v80
    v_mfma_f32_16x16x32_bf16 v[192:195], a[232:235], v[24:27], v[192:195]
    ds_read_b128 a[204:207], v1 offset:768
    buffer_load_dwordx4 v4, s[16:19], s27 offen nt lds
    v_exp_f32 v81, v81
    v_mfma_f32_16x16x32_bf16 v[196:199], a[236:239], v[16:19], v[196:199]
    v_mfma_f32_16x16x32_bf16 v[200:203], a[236:239], v[20:23], v[200:203]
    ds_read_b128 a[208:211], v1 offset:4224
    v_cvt_pk_bf16_f32 v34, v76, v77
    v_mfma_f32_16x16x32_bf16 v[204:207], a[236:239], v[24:27], v[204:207]
    v_exp_f32 v82, v82
    v_mfma_f32_16x16x32_bf16 v[208:211], a[240:243], v[16:19], v[208:211]
    ds_read_b128 a[212:215], v1 offset:4480
    v_cvt_pk_bf16_f32 v35, v78, v79
    v_mfma_f32_16x16x32_bf16 v[212:215], a[240:243], v[20:23], v[212:215]
    v_mfma_f32_16x16x32_bf16 v[216:219], a[240:243], v[24:27], v[216:219]
    ds_read_b128 a[216:219], v1 offset:4736
    v_exp_f32 v83, v83
    v_mfma_f32_16x16x32_bf16 v[220:223], a[244:247], v[16:19], v[220:223]
    v_exp_f32 v84, v84
    v_mfma_f32_16x16x32_bf16 v[224:227], a[244:247], v[20:23], v[224:227]
    ds_read_b128 a[220:223], v1 offset:4992
    v_mfma_f32_16x16x32_bf16 v[228:231], a[244:247], v[24:27], v[228:231]
    v_exp_f32 v85, v85
    v_mfma_f32_16x16x32_bf16 v[232:235], a[248:251], v[16:19], v[232:235]
    v_cvt_pk_bf16_f32 v36, v80, v81
    v_mfma_f32_16x16x32_bf16 v[236:239], a[248:251], v[20:23], v[236:239]
    s_add_u32 m0, s25, 92960
    v_cvt_pk_bf16_f32 v37, v82, v83
    v_mfma_f32_16x16x32_bf16 v[240:243], a[248:251], v[24:27], v[240:243]
    buffer_load_dwordx4 v4, s[16:19], s27 offen offset:1024 nt lds
    v_mfma_f32_16x16x32_bf16 v[244:247], a[252:255], v[16:19], v[244:247]
    v_exp_f32 v86, v86
    v_mfma_f32_16x16x32_bf16 v[248:251], a[252:255], v[20:23], v[248:251]
    v_exp_f32 v87, v87
    v_mfma_f32_16x16x32_bf16 v[252:255], a[252:255], v[24:27], v[252:255]
    v_mfma_f32_16x16x32_bf16 v[148:151], v[12:15], v[16:19], v[148:151]
    v_cvt_pk_bf16_f32 v38, v84, v85
    v_mfma_f32_16x16x32_bf16 v[152:155], v[12:15], v[20:23], v[152:155]
    v_cvt_pk_bf16_f32 v39, v86, v87
    v_mfma_f32_16x16x32_bf16 v[156:159], v[12:15], v[24:27], v[156:159]
    s_and_b32 s42, s65, 3
    s_xor_b32 s42, s42, s30
    s_or_b32 s42, s42, s24
    s_cmp_lg_u32 s42, 0
    s_cbranch_scc1 A_NOSYNC
    s_mov_b32 s44, s100
    s_mov_b32 s45, s101
    s_add_u32 s40, s48, 0x5000000
    s_addc_u32 s41, s49, 0
    s_and_b32 s41, s41, 0xffff
    s_mov_b32 s42, 65536
    s_mov_b32 s43, 0x20000
    s_lshl_b32 s46, s2, 7
    v_mbcnt_lo_u32_b32 v0, -1, 0
    v_mbcnt_hi_u32_b32 v0, -1, v0
    v_lshlrev_b32 v8, 2, v0
    v_and_b32 v8, 127, v8
    v_mov_b32 v7, 0
    buffer_store_dword v7, v8, s[40:43], s46 offen sc0 sc1
    s_lshl_b32 s46, s64, 4
    s_add_u32 s46, s46, s67
    s_cmp_lg_u32 s65, 0
    s_cbranch_scc1 A_NOGZ
    s_lshl_b32 s47, s46, 7
    s_add_u32 s47, s47, 32768
    buffer_store_dword v7, v8, s[40:43], s47 offen sc0 sc1
A_NOGZ:
    s_getreg_b32 s42, hwreg(HW_REG_XCC_ID)
    s_and_b32 s42, s42, 7
    s_lshl_b32 s42, s42, 2
    s_lshl_b32 s43, 1, s42
    s_lshl_b32 s46, s46, 3
    v_mov_b32 v7, s43
    v_mov_b32 v8, s46
    s_waitcnt vmcnt(0)
    s_mov_b32 s40, s44
    s_and_b32 s41, s45, 0xffff
    s_mov_b32 s42, 256
    s_mov_b32 s43, 0x20000
    v_cmp_eq_u32 vcc, 0, v0
    s_nop 3
    s_and_saveexec_b64 s[46:47], vcc
    buffer_atomic_add v7, v8, s[40:43], 0 offen
    s_mov_b64 exec, s[46:47]
A_NOSYNC:
    s_and_b32 s41, s85, 0xffff
    s_mov_b32 s40, s84
    s_mov_b32 s42, 0x400000
    s_mov_b32 s43, 0x20000
    s_and_b32 s44, s2, 3
    s_lshl_b32 s44, s44, 5
    s_lshr_b32 s45, s2, 3
    s_add_u32 s44, s44, s45
    s_lshl_b32 s44, s44, 2
    s_add_u32 s44, s44, s24
    s_lshl_b32 s44, s44, 13
    v_mbcnt_lo_u32_b32 v0, -1, 0
    v_mbcnt_hi_u32_b32 v0, -1, v0
    v_lshlrev_b32 v8, 7, v0
    buffer_load_dword v9, v8, s[40:43], s44 offen
    s_waitcnt lgkmcnt(0)
    v_add_u32 v2, 0xffffbe00, v2
    v_mfma_f32_16x16x32_bf16 v[64:67], a[192:195], v[100:103], v[88:91]
    ds_read_b64_tr_b16 a[224:225], v2 offset:0
    v_exp_f32 v40, v40
    v_mfma_f32_16x16x32_bf16 v[72:75], a[192:195], v[104:107], v[92:95]
    ds_read_b64_tr_b16 a[226:227], v2 offset:4224
    v_exp_f32 v41, v41
    v_mfma_f32_16x16x32_bf16 v[80:83], a[192:195], v[108:111], v[96:99]
    ds_read_b64_tr_b16 a[228:229], v2 offset:32
    v_exp_f32 v42, v42
    v_mfma_f32_16x16x32_bf16 v[64:67], a[196:199], v[112:115], v[64:67]
    ds_read_b64_tr_b16 a[230:231], v2 offset:4256
    v_mfma_f32_16x16x32_bf16 v[72:75], a[196:199], v[116:119], v[72:75]
    ds_read_b64_tr_b16 a[232:233], v2 offset:256
    v_exp_f32 v43, v43
    v_mfma_f32_16x16x32_bf16 v[80:83], a[196:199], v[120:123], v[80:83]
    ds_read_b64_tr_b16 a[234:235], v2 offset:4480
    v_exp_f32 v44, v44
    v_mfma_f32_16x16x32_bf16 v[64:67], a[200:203], v[124:127], v[64:67]
    ds_read_b64_tr_b16 a[236:237], v2 offset:288
    v_mfma_f32_16x16x32_bf16 v[72:75], a[200:203], v[128:131], v[72:75]
    ds_read_b64_tr_b16 a[238:239], v2 offset:4512
    v_exp_f32 v45, v45
    v_mfma_f32_16x16x32_bf16 v[80:83], a[200:203], v[132:135], v[80:83]
    ds_read_b64_tr_b16 a[240:241], v2 offset:512
    v_cvt_pk_bf16_f32 v16, v40, v41
    v_mfma_f32_16x16x32_bf16 v[64:67], a[204:207], v[136:139], v[64:67]
    ds_read_b64_tr_b16 a[242:243], v2 offset:4736
    v_cvt_pk_bf16_f32 v17, v42, v43
    v_mfma_f32_16x16x32_bf16 v[72:75], a[204:207], v[140:143], v[72:75]
    ds_read_b64_tr_b16 a[244:245], v2 offset:544
    v_mfma_f32_16x16x32_bf16 v[80:83], a[204:207], v[144:147], v[80:83]
    ds_read_b64_tr_b16 a[246:247], v2 offset:4768
    v_exp_f32 v46, v46
    v_mfma_f32_16x16x32_bf16 v[68:71], a[208:211], v[100:103], v[88:91]
    ds_read_b64_tr_b16 a[248:249], v2 offset:768
    s_add_u32 m0, s25, 67584
    v_exp_f32 v47, v47
    v_mfma_f32_16x16x32_bf16 v[76:79], a[208:211], v[104:107], v[92:95]
    ds_read_b64_tr_b16 a[250:251], v2 offset:4992
    s_add_u32 s27, s62, 98304
    v_mfma_f32_16x16x32_bf16 v[84:87], a[208:211], v[108:111], v[96:99]
    ds_read_b64_tr_b16 a[252:253], v2 offset:800
    buffer_load_dwordx4 v4, s[12:15], s27 offen nt lds
    v_exp_f32 v48, v48
    v_mfma_f32_16x16x32_bf16 v[68:71], a[212:215], v[112:115], v[68:71]
    ds_read_b64_tr_b16 a[254:255], v2 offset:5024
    v_exp_f32 v49, v49
    v_mfma_f32_16x16x32_bf16 v[76:79], a[212:215], v[116:119], v[76:79]
    v_mfma_f32_16x16x32_bf16 v[84:87], a[212:215], v[120:123], v[84:87]
    v_cvt_pk_bf16_f32 v18, v44, v45
    v_mfma_f32_16x16x32_bf16 v[68:71], a[216:219], v[124:127], v[68:71]
    v_exp_f32 v50, v50
    v_mfma_f32_16x16x32_bf16 v[76:79], a[216:219], v[128:131], v[76:79]
    v_cvt_pk_bf16_f32 v19, v46, v47
    v_mfma_f32_16x16x32_bf16 v[84:87], a[216:219], v[132:135], v[84:87]
    v_mfma_f32_16x16x32_bf16 v[68:71], a[220:223], v[136:139], v[68:71]
    v_exp_f32 v51, v51
    v_mfma_f32_16x16x32_bf16 v[76:79], a[220:223], v[140:143], v[76:79]
    v_exp_f32 v52, v52
    v_mfma_f32_16x16x32_bf16 v[84:87], a[220:223], v[144:147], v[84:87]
    s_waitcnt lgkmcnt(0)
    v_mfma_f32_16x16x32_bf16 v[160:163], a[224:227], v[28:31], v[160:163]
    v_exp_f32 v53, v53
    v_mfma_f32_16x16x32_bf16 v[164:167], a[224:227], v[32:35], v[164:167]
    v_add_u32 v1, 0xffff3a00, v1
    v_cvt_pk_bf16_f32 v20, v48, v49
    v_mfma_f32_16x16x32_bf16 v[168:171], a[224:227], v[36:39], v[168:171]
    ds_read_b128 a[192:195], v1 offset:0
    v_cvt_pk_bf16_f32 v21, v50, v51
    v_mfma_f32_16x16x32_bf16 v[172:175], a[228:231], v[28:31], v[172:175]
    v_mfma_f32_16x16x32_bf16 v[176:179], a[228:231], v[32:35], v[176:179]
    ds_read_b128 a[196:199], v1 offset:256
    v_exp_f32 v54, v54
    v_mfma_f32_16x16x32_bf16 v[180:183], a[228:231], v[36:39], v[180:183]
    v_exp_f32 v55, v55
    v_mfma_f32_16x16x32_bf16 v[184:187], a[232:235], v[28:31], v[184:187]
    ds_read_b128 a[200:203], v1 offset:512
    v_mfma_f32_16x16x32_bf16 v[188:191], a[232:235], v[32:35], v[188:191]
    v_exp_f32 v56, v56
    v_mfma_f32_16x16x32_bf16 v[192:195], a[232:235], v[36:39], v[192:195]
    ds_read_b128 a[204:207], v1 offset:768
    v_exp_f32 v57, v57
    v_mfma_f32_16x16x32_bf16 v[196:199], a[236:239], v[28:31], v[196:199]
    v_mfma_f32_16x16x32_bf16 v[200:203], a[236:239], v[32:35], v[200:203]
    ds_read_b128 a[208:211], v1 offset:4224
    v_cvt_pk_bf16_f32 v22, v52, v53
    v_mfma_f32_16x16x32_bf16 v[204:207], a[236:239], v[36:39], v[204:207]
    v_exp_f32 v58, v58
    v_mfma_f32_16x16x32_bf16 v[208:211], a[240:243], v[28:31], v[208:211]
    ds_read_b128 a[212:215], v1 offset:4480
    v_cvt_pk_bf16_f32 v23, v54, v55
    v_mfma_f32_16x16x32_bf16 v[212:215], a[240:243], v[32:35], v[212:215]
    s_add_u32 m0, s25, 67616
    v_mfma_f32_16x16x32_bf16 v[216:219], a[240:243], v[36:39], v[216:219]
    ds_read_b128 a[216:219], v1 offset:4736
    buffer_load_dwordx4 v4, s[12:15], s27 offen offset:1024 nt lds
    v_exp_f32 v59, v59
    v_mfma_f32_16x16x32_bf16 v[220:223], a[244:247], v[28:31], v[220:223]
    v_exp_f32 v60, v60
    v_mfma_f32_16x16x32_bf16 v[224:227], a[244:247], v[32:35], v[224:227]
    ds_read_b128 a[220:223], v1 offset:4992
    v_mfma_f32_16x16x32_bf16 v[228:231], a[244:247], v[36:39], v[228:231]
    v_exp_f32 v61, v61
    v_mfma_f32_16x16x32_bf16 v[232:235], a[248:251], v[28:31], v[232:235]
    v_cvt_pk_bf16_f32 v24, v56, v57
    v_mfma_f32_16x16x32_bf16 v[236:239], a[248:251], v[32:35], v[236:239]
    v_cvt_pk_bf16_f32 v25, v58, v59
    v_mfma_f32_16x16x32_bf16 v[240:243], a[248:251], v[36:39], v[240:243]
    v_mfma_f32_16x16x32_bf16 v[244:247], a[252:255], v[28:31], v[244:247]
    v_exp_f32 v62, v62
    v_mfma_f32_16x16x32_bf16 v[248:251], a[252:255], v[32:35], v[248:251]
    v_exp_f32 v63, v63
    v_mfma_f32_16x16x32_bf16 v[252:255], a[252:255], v[36:39], v[252:255]
    v_mfma_f32_16x16x32_bf16 v[148:151], v[12:15], v[28:31], v[148:151]
    v_cvt_pk_bf16_f32 v26, v60, v61
    v_mfma_f32_16x16x32_bf16 v[152:155], v[12:15], v[32:35], v[152:155]
    v_cvt_pk_bf16_f32 v27, v62, v63
    v_mfma_f32_16x16x32_bf16 v[156:159], v[12:15], v[36:39], v[156:159]
    s_waitcnt lgkmcnt(0)
    s_waitcnt vmcnt(9)
    s_barrier
    v_add_u32 v2, 0xffff3a00, v2
    v_mfma_f32_16x16x32_bf16 v[40:43], a[192:195], v[100:103], v[88:91]
    ds_read_b64_tr_b16 a[224:225], v2 offset:0
    v_exp_f32 v64, v64
    v_mfma_f32_16x16x32_bf16 v[48:51], a[192:195], v[104:107], v[92:95]
    ds_read_b64_tr_b16 a[226:227], v2 offset:4224
    v_exp_f32 v65, v65
    v_mfma_f32_16x16x32_bf16 v[56:59], a[192:195], v[108:111], v[96:99]
    ds_read_b64_tr_b16 a[228:229], v2 offset:32
    v_exp_f32 v66, v66
    v_mfma_f32_16x16x32_bf16 v[40:43], a[196:199], v[112:115], v[40:43]
    ds_read_b64_tr_b16 a[230:231], v2 offset:4256
    v_mfma_f32_16x16x32_bf16 v[48:51], a[196:199], v[116:119], v[48:51]
    ds_read_b64_tr_b16 a[232:233], v2 offset:256
    v_exp_f32 v67, v67
    v_mfma_f32_16x16x32_bf16 v[56:59], a[196:199], v[120:123], v[56:59]
    ds_read_b64_tr_b16 a[234:235], v2 offset:4480
    v_exp_f32 v68, v68
    v_mfma_f32_16x16x32_bf16 v[40:43], a[200:203], v[124:127], v[40:43]
    ds_read_b64_tr_b16 a[236:237], v2 offset:288
    s_add_u32 m0, s25, 126720
    v_mfma_f32_16x16x32_bf16 v[48:51], a[200:203], v[128:131], v[48:51]
    ds_read_b64_tr_b16 a[238:239], v2 offset:4512
    s_add_u32 s27, s62, 81920
    v_exp_f32 v69, v69
    v_mfma_f32_16x16x32_bf16 v[56:59], a[200:203], v[132:135], v[56:59]
    ds_read_b64_tr_b16 a[240:241], v2 offset:512
    buffer_load_dwordx4 v4, s[16:19], s27 offen nt lds
    v_cvt_pk_bf16_f32 v28, v64, v65
    v_mfma_f32_16x16x32_bf16 v[40:43], a[204:207], v[136:139], v[40:43]
    ds_read_b64_tr_b16 a[242:243], v2 offset:4736
    v_cvt_pk_bf16_f32 v29, v66, v67
    v_mfma_f32_16x16x32_bf16 v[48:51], a[204:207], v[140:143], v[48:51]
    ds_read_b64_tr_b16 a[244:245], v2 offset:544
    v_mfma_f32_16x16x32_bf16 v[56:59], a[204:207], v[144:147], v[56:59]
    ds_read_b64_tr_b16 a[246:247], v2 offset:4768
    v_exp_f32 v70, v70
    v_mfma_f32_16x16x32_bf16 v[44:47], a[208:211], v[100:103], v[88:91]
    ds_read_b64_tr_b16 a[248:249], v2 offset:768
    v_exp_f32 v71, v71
    v_mfma_f32_16x16x32_bf16 v[52:55], a[208:211], v[104:107], v[92:95]
    ds_read_b64_tr_b16 a[250:251], v2 offset:4992
    v_mfma_f32_16x16x32_bf16 v[60:63], a[208:211], v[108:111], v[96:99]
    ds_read_b64_tr_b16 a[252:253], v2 offset:800
    v_exp_f32 v72, v72
    v_mfma_f32_16x16x32_bf16 v[44:47], a[212:215], v[112:115], v[44:47]
    ds_read_b64_tr_b16 a[254:255], v2 offset:5024
    v_exp_f32 v73, v73
    v_mfma_f32_16x16x32_bf16 v[52:55], a[212:215], v[116:119], v[52:55]
    v_mfma_f32_16x16x32_bf16 v[60:63], a[212:215], v[120:123], v[60:63]
    v_cvt_pk_bf16_f32 v30, v68, v69
    v_mfma_f32_16x16x32_bf16 v[44:47], a[216:219], v[124:127], v[44:47]
    v_exp_f32 v74, v74
    v_mfma_f32_16x16x32_bf16 v[52:55], a[216:219], v[128:131], v[52:55]
    s_add_u32 m0, s25, 126752
    v_cvt_pk_bf16_f32 v31, v70, v71
    v_mfma_f32_16x16x32_bf16 v[60:63], a[216:219], v[132:135], v[60:63]
    buffer_load_dwordx4 v4, s[16:19], s27 offen offset:1024 nt lds
    v_mfma_f32_16x16x32_bf16 v[44:47], a[220:223], v[136:139], v[44:47]
    v_exp_f32 v75, v75
    v_mfma_f32_16x16x32_bf16 v[52:55], a[220:223], v[140:143], v[52:55]
    v_exp_f32 v76, v76
    v_mfma_f32_16x16x32_bf16 v[60:63], a[220:223], v[144:147], v[60:63]
    s_waitcnt lgkmcnt(0)
    v_mfma_f32_16x16x32_bf16 v[160:163], a[224:227], v[16:19], v[160:163]
    v_exp_f32 v77, v77
    v_mfma_f32_16x16x32_bf16 v[164:167], a[224:227], v[20:23], v[164:167]
    v_add_u32 v1, 0xffff5b00, v1
    v_cvt_pk_bf16_f32 v32, v72, v73
    v_mfma_f32_16x16x32_bf16 v[168:171], a[224:227], v[24:27], v[168:171]
    ds_read_b128 a[192:195], v1 offset:0
    v_cvt_pk_bf16_f32 v33, v74, v75
    v_mfma_f32_16x16x32_bf16 v[172:175], a[228:231], v[16:19], v[172:175]
    v_mfma_f32_16x16x32_bf16 v[176:179], a[228:231], v[20:23], v[176:179]
    ds_read_b128 a[196:199], v1 offset:256
    v_exp_f32 v78, v78
    v_mfma_f32_16x16x32_bf16 v[180:183], a[228:231], v[24:27], v[180:183]
    v_exp_f32 v79, v79
    v_mfma_f32_16x16x32_bf16 v[184:187], a[232:235], v[16:19], v[184:187]
    ds_read_b128 a[200:203], v1 offset:512
    s_add_u32 m0, s25, 84480
    v_mfma_f32_16x16x32_bf16 v[188:191], a[232:235], v[20:23], v[188:191]
    s_add_u32 s27, s62, 106496
    v_exp_f32 v80, v80
    v_mfma_f32_16x16x32_bf16 v[192:195], a[232:235], v[24:27], v[192:195]
    ds_read_b128 a[204:207], v1 offset:768
    buffer_load_dwordx4 v4, s[12:15], s27 offen nt lds
    v_exp_f32 v81, v81
    v_mfma_f32_16x16x32_bf16 v[196:199], a[236:239], v[16:19], v[196:199]
    v_mfma_f32_16x16x32_bf16 v[200:203], a[236:239], v[20:23], v[200:203]
    ds_read_b128 a[208:211], v1 offset:4224
    v_cvt_pk_bf16_f32 v34, v76, v77
    v_mfma_f32_16x16x32_bf16 v[204:207], a[236:239], v[24:27], v[204:207]
    v_exp_f32 v82, v82
    v_mfma_f32_16x16x32_bf16 v[208:211], a[240:243], v[16:19], v[208:211]
    ds_read_b128 a[212:215], v1 offset:4480
    v_cvt_pk_bf16_f32 v35, v78, v79
    v_mfma_f32_16x16x32_bf16 v[212:215], a[240:243], v[20:23], v[212:215]
    v_mfma_f32_16x16x32_bf16 v[216:219], a[240:243], v[24:27], v[216:219]
    ds_read_b128 a[216:219], v1 offset:4736
    v_exp_f32 v83, v83
    v_mfma_f32_16x16x32_bf16 v[220:223], a[244:247], v[16:19], v[220:223]
    v_exp_f32 v84, v84
    v_mfma_f32_16x16x32_bf16 v[224:227], a[244:247], v[20:23], v[224:227]
    ds_read_b128 a[220:223], v1 offset:4992
    v_mfma_f32_16x16x32_bf16 v[228:231], a[244:247], v[24:27], v[228:231]
    v_exp_f32 v85, v85
    v_mfma_f32_16x16x32_bf16 v[232:235], a[248:251], v[16:19], v[232:235]
    v_cvt_pk_bf16_f32 v36, v80, v81
    v_mfma_f32_16x16x32_bf16 v[236:239], a[248:251], v[20:23], v[236:239]
    s_add_u32 m0, s25, 84512
    v_cvt_pk_bf16_f32 v37, v82, v83
    v_mfma_f32_16x16x32_bf16 v[240:243], a[248:251], v[24:27], v[240:243]
    buffer_load_dwordx4 v4, s[12:15], s27 offen offset:1024 nt lds
    v_mfma_f32_16x16x32_bf16 v[244:247], a[252:255], v[16:19], v[244:247]
    v_exp_f32 v86, v86
    v_mfma_f32_16x16x32_bf16 v[248:251], a[252:255], v[20:23], v[248:251]
    v_exp_f32 v87, v87
    v_mfma_f32_16x16x32_bf16 v[252:255], a[252:255], v[24:27], v[252:255]
    v_mfma_f32_16x16x32_bf16 v[148:151], v[12:15], v[16:19], v[148:151]
    v_cvt_pk_bf16_f32 v38, v84, v85
    v_mfma_f32_16x16x32_bf16 v[152:155], v[12:15], v[20:23], v[152:155]
    v_cvt_pk_bf16_f32 v39, v86, v87
    v_mfma_f32_16x16x32_bf16 v[156:159], v[12:15], v[24:27], v[156:159]
    s_waitcnt lgkmcnt(0)
    v_add_u32 v2, 0xa500, v2
    v_mfma_f32_16x16x32_bf16 v[64:67], a[192:195], v[100:103], v[88:91]
    ds_read_b64_tr_b16 a[224:225], v2 offset:0
    v_exp_f32 v40, v40
    v_mfma_f32_16x16x32_bf16 v[72:75], a[192:195], v[104:107], v[92:95]
    ds_read_b64_tr_b16 a[226:227], v2 offset:4224
    v_exp_f32 v41, v41
    v_mfma_f32_16x16x32_bf16 v[80:83], a[192:195], v[108:111], v[96:99]
    ds_read_b64_tr_b16 a[228:229], v2 offset:32
    v_exp_f32 v42, v42
    v_mfma_f32_16x16x32_bf16 v[64:67], a[196:199], v[112:115], v[64:67]
    ds_read_b64_tr_b16 a[230:231], v2 offset:4256
    v_mfma_f32_16x16x32_bf16 v[72:75], a[196:199], v[116:119], v[72:75]
    ds_read_b64_tr_b16 a[232:233], v2 offset:256
    v_exp_f32 v43, v43
    v_mfma_f32_16x16x32_bf16 v[80:83], a[196:199], v[120:123], v[80:83]
    ds_read_b64_tr_b16 a[234:235], v2 offset:4480
    v_exp_f32 v44, v44
    v_mfma_f32_16x16x32_bf16 v[64:67], a[200:203], v[124:127], v[64:67]
    ds_read_b64_tr_b16 a[236:237], v2 offset:288
    v_mfma_f32_16x16x32_bf16 v[72:75], a[200:203], v[128:131], v[72:75]
    ds_read_b64_tr_b16 a[238:239], v2 offset:4512
    v_exp_f32 v45, v45
    v_mfma_f32_16x16x32_bf16 v[80:83], a[200:203], v[132:135], v[80:83]
    ds_read_b64_tr_b16 a[240:241], v2 offset:512
    v_cvt_pk_bf16_f32 v16, v40, v41
    v_mfma_f32_16x16x32_bf16 v[64:67], a[204:207], v[136:139], v[64:67]
    ds_read_b64_tr_b16 a[242:243], v2 offset:4736
    v_cvt_pk_bf16_f32 v17, v42, v43
    v_mfma_f32_16x16x32_bf16 v[72:75], a[204:207], v[140:143], v[72:75]
    ds_read_b64_tr_b16 a[244:245], v2 offset:544
    v_mfma_f32_16x16x32_bf16 v[80:83], a[204:207], v[144:147], v[80:83]
    ds_read_b64_tr_b16 a[246:247], v2 offset:4768
    v_exp_f32 v46, v46
    v_mfma_f32_16x16x32_bf16 v[68:71], a[208:211], v[100:103], v[88:91]
    ds_read_b64_tr_b16 a[248:249], v2 offset:768
    s_add_u32 m0, s25, 33792
    v_exp_f32 v47, v47
    v_mfma_f32_16x16x32_bf16 v[76:79], a[208:211], v[104:107], v[92:95]
    ds_read_b64_tr_b16 a[250:251], v2 offset:4992
    s_add_u32 s27, s62, 90112
    v_mfma_f32_16x16x32_bf16 v[84:87], a[208:211], v[108:111], v[96:99]
    ds_read_b64_tr_b16 a[252:253], v2 offset:800
    buffer_load_dwordx4 v4, s[16:19], s27 offen nt lds
    v_exp_f32 v48, v48
    v_mfma_f32_16x16x32_bf16 v[68:71], a[212:215], v[112:115], v[68:71]
    ds_read_b64_tr_b16 a[254:255], v2 offset:5024
    v_exp_f32 v49, v49
    v_mfma_f32_16x16x32_bf16 v[76:79], a[212:215], v[116:119], v[76:79]
    v_mfma_f32_16x16x32_bf16 v[84:87], a[212:215], v[120:123], v[84:87]
    v_cvt_pk_bf16_f32 v18, v44, v45
    v_mfma_f32_16x16x32_bf16 v[68:71], a[216:219], v[124:127], v[68:71]
    v_exp_f32 v50, v50
    v_mfma_f32_16x16x32_bf16 v[76:79], a[216:219], v[128:131], v[76:79]
    v_cvt_pk_bf16_f32 v19, v46, v47
    v_mfma_f32_16x16x32_bf16 v[84:87], a[216:219], v[132:135], v[84:87]
    v_mfma_f32_16x16x32_bf16 v[68:71], a[220:223], v[136:139], v[68:71]
    v_exp_f32 v51, v51
    v_mfma_f32_16x16x32_bf16 v[76:79], a[220:223], v[140:143], v[76:79]
    v_exp_f32 v52, v52
    v_mfma_f32_16x16x32_bf16 v[84:87], a[220:223], v[144:147], v[84:87]
    s_waitcnt lgkmcnt(0)
    v_mfma_f32_16x16x32_bf16 v[160:163], a[224:227], v[28:31], v[160:163]
    v_exp_f32 v53, v53
    v_mfma_f32_16x16x32_bf16 v[164:167], a[224:227], v[32:35], v[164:167]
    v_add_u32 v1, 0x10800, v1
    v_cvt_pk_bf16_f32 v20, v48, v49
    v_mfma_f32_16x16x32_bf16 v[168:171], a[224:227], v[36:39], v[168:171]
    ds_read_b128 a[192:195], v1 offset:0
    v_cvt_pk_bf16_f32 v21, v50, v51
    v_mfma_f32_16x16x32_bf16 v[172:175], a[228:231], v[28:31], v[172:175]
    v_mfma_f32_16x16x32_bf16 v[176:179], a[228:231], v[32:35], v[176:179]
    ds_read_b128 a[196:199], v1 offset:256
    v_exp_f32 v54, v54
    v_mfma_f32_16x16x32_bf16 v[180:183], a[228:231], v[36:39], v[180:183]
    v_exp_f32 v55, v55
    v_mfma_f32_16x16x32_bf16 v[184:187], a[232:235], v[28:31], v[184:187]
    ds_read_b128 a[200:203], v1 offset:512
    v_mfma_f32_16x16x32_bf16 v[188:191], a[232:235], v[32:35], v[188:191]
    v_exp_f32 v56, v56
    v_mfma_f32_16x16x32_bf16 v[192:195], a[232:235], v[36:39], v[192:195]
    ds_read_b128 a[204:207], v1 offset:768
    v_exp_f32 v57, v57
    v_mfma_f32_16x16x32_bf16 v[196:199], a[236:239], v[28:31], v[196:199]
    v_mfma_f32_16x16x32_bf16 v[200:203], a[236:239], v[32:35], v[200:203]
    ds_read_b128 a[208:211], v1 offset:4224
    v_cvt_pk_bf16_f32 v22, v52, v53
    v_mfma_f32_16x16x32_bf16 v[204:207], a[236:239], v[36:39], v[204:207]
    v_exp_f32 v58, v58
    v_mfma_f32_16x16x32_bf16 v[208:211], a[240:243], v[28:31], v[208:211]
    ds_read_b128 a[212:215], v1 offset:4480
    v_cvt_pk_bf16_f32 v23, v54, v55
    v_mfma_f32_16x16x32_bf16 v[212:215], a[240:243], v[32:35], v[212:215]
    s_add_u32 m0, s25, 33824
    v_mfma_f32_16x16x32_bf16 v[216:219], a[240:243], v[36:39], v[216:219]
    ds_read_b128 a[216:219], v1 offset:4736
    buffer_load_dwordx4 v4, s[16:19], s27 offen offset:1024 nt lds
    v_exp_f32 v59, v59
    v_mfma_f32_16x16x32_bf16 v[220:223], a[244:247], v[28:31], v[220:223]
    v_exp_f32 v60, v60
    v_mfma_f32_16x16x32_bf16 v[224:227], a[244:247], v[32:35], v[224:227]
    ds_read_b128 a[220:223], v1 offset:4992
    v_mfma_f32_16x16x32_bf16 v[228:231], a[244:247], v[36:39], v[228:231]
    v_exp_f32 v61, v61
    v_mfma_f32_16x16x32_bf16 v[232:235], a[248:251], v[28:31], v[232:235]
    v_cvt_pk_bf16_f32 v24, v56, v57
    v_mfma_f32_16x16x32_bf16 v[236:239], a[248:251], v[32:35], v[236:239]
    v_cvt_pk_bf16_f32 v25, v58, v59
    v_mfma_f32_16x16x32_bf16 v[240:243], a[248:251], v[36:39], v[240:243]
    v_mfma_f32_16x16x32_bf16 v[244:247], a[252:255], v[28:31], v[244:247]
    v_exp_f32 v62, v62
    v_mfma_f32_16x16x32_bf16 v[248:251], a[252:255], v[32:35], v[248:251]
    v_exp_f32 v63, v63
    v_mfma_f32_16x16x32_bf16 v[252:255], a[252:255], v[36:39], v[252:255]
    v_mfma_f32_16x16x32_bf16 v[148:151], v[12:15], v[28:31], v[148:151]
    v_cvt_pk_bf16_f32 v26, v60, v61
    v_mfma_f32_16x16x32_bf16 v[152:155], v[12:15], v[32:35], v[152:155]
    v_cvt_pk_bf16_f32 v27, v62, v63
    v_mfma_f32_16x16x32_bf16 v[156:159], v[12:15], v[36:39], v[156:159]
    s_waitcnt lgkmcnt(0)
    s_waitcnt vmcnt(6)
    s_barrier
    v_add_u32 v2, 0xfffef800, v2
    v_mfma_f32_16x16x32_bf16 v[40:43], a[192:195], v[100:103], v[88:91]
    ds_read_b64_tr_b16 a[224:225], v2 offset:0
    v_exp_f32 v64, v64
    v_mfma_f32_16x16x32_bf16 v[48:51], a[192:195], v[104:107], v[92:95]
    ds_read_b64_tr_b16 a[226:227], v2 offset:4224
    v_exp_f32 v65, v65
    v_mfma_f32_16x16x32_bf16 v[56:59], a[192:195], v[108:111], v[96:99]
    ds_read_b64_tr_b16 a[228:229], v2 offset:32
    v_exp_f32 v66, v66
    v_mfma_f32_16x16x32_bf16 v[40:43], a[196:199], v[112:115], v[40:43]
    ds_read_b64_tr_b16 a[230:231], v2 offset:4256
    v_mfma_f32_16x16x32_bf16 v[48:51], a[196:199], v[116:119], v[48:51]
    ds_read_b64_tr_b16 a[232:233], v2 offset:256
    v_exp_f32 v67, v67
    v_mfma_f32_16x16x32_bf16 v[56:59], a[196:199], v[120:123], v[56:59]
    ds_read_b64_tr_b16 a[234:235], v2 offset:4480
    v_exp_f32 v68, v68
    v_mfma_f32_16x16x32_bf16 v[40:43], a[200:203], v[124:127], v[40:43]
    ds_read_b64_tr_b16 a[236:237], v2 offset:288
    s_add_u32 m0, s25, 118272
    v_mfma_f32_16x16x32_bf16 v[48:51], a[200:203], v[128:131], v[48:51]
    ds_read_b64_tr_b16 a[238:239], v2 offset:4512
    s_add_u32 s27, s62, 114688
    v_exp_f32 v69, v69
    v_mfma_f32_16x16x32_bf16 v[56:59], a[200:203], v[132:135], v[56:59]
    ds_read_b64_tr_b16 a[240:241], v2 offset:512
    buffer_load_dwordx4 v4, s[12:15], s27 offen nt lds
    v_cvt_pk_bf16_f32 v28, v64, v65
    v_mfma_f32_16x16x32_bf16 v[40:43], a[204:207], v[136:139], v[40:43]
    ds_read_b64_tr_b16 a[242:243], v2 offset:4736
    v_cvt_pk_bf16_f32 v29, v66, v67
    v_mfma_f32_16x16x32_bf16 v[48:51], a[204:207], v[140:143], v[48:51]
    ds_read_b64_tr_b16 a[244:245], v2 offset:544
    v_mfma_f32_16x16x32_bf16 v[56:59], a[204:207], v[144:147], v[56:59]
    ds_read_b64_tr_b16 a[246:247], v2 offset:4768
    v_exp_f32 v70, v70
    v_mfma_f32_16x16x32_bf16 v[44:47], a[208:211], v[100:103], v[88:91]
    ds_read_b64_tr_b16 a[248:249], v2 offset:768
    v_exp_f32 v71, v71
    v_mfma_f32_16x16x32_bf16 v[52:55], a[208:211], v[104:107], v[92:95]
    ds_read_b64_tr_b16 a[250:251], v2 offset:4992
    v_mfma_f32_16x16x32_bf16 v[60:63], a[208:211], v[108:111], v[96:99]
    ds_read_b64_tr_b16 a[252:253], v2 offset:800
    v_exp_f32 v72, v72
    v_mfma_f32_16x16x32_bf16 v[44:47], a[212:215], v[112:115], v[44:47]
    ds_read_b64_tr_b16 a[254:255], v2 offset:5024
    v_exp_f32 v73, v73
    v_mfma_f32_16x16x32_bf16 v[52:55], a[212:215], v[116:119], v[52:55]
    v_mfma_f32_16x16x32_bf16 v[60:63], a[212:215], v[120:123], v[60:63]
    v_cvt_pk_bf16_f32 v30, v68, v69
    v_mfma_f32_16x16x32_bf16 v[44:47], a[216:219], v[124:127], v[44:47]
    v_exp_f32 v74, v74
    v_mfma_f32_16x16x32_bf16 v[52:55], a[216:219], v[128:131], v[52:55]
    s_add_u32 m0, s25, 118304
    v_cvt_pk_bf16_f32 v31, v70, v71
    v_mfma_f32_16x16x32_bf16 v[60:63], a[216:219], v[132:135], v[60:63]
    buffer_load_dwordx4 v4, s[12:15], s27 offen offset:1024 nt lds
    v_mfma_f32_16x16x32_bf16 v[44:47], a[220:223], v[136:139], v[44:47]
    v_exp_f32 v75, v75
    v_mfma_f32_16x16x32_bf16 v[52:55], a[220:223], v[140:143], v[52:55]
    v_exp_f32 v76, v76
    v_mfma_f32_16x16x32_bf16 v[60:63], a[220:223], v[144:147], v[60:63]
    s_waitcnt lgkmcnt(0)
    v_mfma_f32_16x16x32_bf16 v[160:163], a[224:227], v[16:19], v[160:163]
    v_exp_f32 v77, v77
    v_mfma_f32_16x16x32_bf16 v[164:167], a[224:227], v[20:23], v[164:167]
    v_add_u32 v1, 0xffffdf00, v1
    v_cvt_pk_bf16_f32 v32, v72, v73
    v_mfma_f32_16x16x32_bf16 v[168:171], a[224:227], v[24:27], v[168:171]
    ds_read_b128 a[192:195], v1 offset:0
    v_cvt_pk_bf16_f32 v33, v74, v75
    v_mfma_f32_16x16x32_bf16 v[172:175], a[228:231], v[16:19], v[172:175]
    v_mfma_f32_16x16x32_bf16 v[176:179], a[228:231], v[20:23], v[176:179]
    ds_read_b128 a[196:199], v1 offset:256
    v_exp_f32 v78, v78
    v_mfma_f32_16x16x32_bf16 v[180:183], a[228:231], v[24:27], v[180:183]
    v_exp_f32 v79, v79
    v_mfma_f32_16x16x32_bf16 v[184:187], a[232:235], v[16:19], v[184:187]
    ds_read_b128 a[200:203], v1 offset:512
    s_add_u32 m0, s25, 143616
    v_mfma_f32_16x16x32_bf16 v[188:191], a[232:235], v[20:23], v[188:191]
    s_add_u32 s27, s62, 98304
    v_exp_f32 v80, v80
    v_mfma_f32_16x16x32_bf16 v[192:195], a[232:235], v[24:27], v[192:195]
    ds_read_b128 a[204:207], v1 offset:768
    buffer_load_dwordx4 v4, s[16:19], s27 offen nt lds
    v_exp_f32 v81, v81
    v_mfma_f32_16x16x32_bf16 v[196:199], a[236:239], v[16:19], v[196:199]
    v_mfma_f32_16x16x32_bf16 v[200:203], a[236:239], v[20:23], v[200:203]
    ds_read_b128 a[208:211], v1 offset:4224
    v_cvt_pk_bf16_f32 v34, v76, v77
    v_mfma_f32_16x16x32_bf16 v[204:207], a[236:239], v[24:27], v[204:207]
    v_exp_f32 v82, v82
    v_mfma_f32_16x16x32_bf16 v[208:211], a[240:243], v[16:19], v[208:211]
    ds_read_b128 a[212:215], v1 offset:4480
    v_cvt_pk_bf16_f32 v35, v78, v79
    v_mfma_f32_16x16x32_bf16 v[212:215], a[240:243], v[20:23], v[212:215]
    v_mfma_f32_16x16x32_bf16 v[216:219], a[240:243], v[24:27], v[216:219]
    ds_read_b128 a[216:219], v1 offset:4736
    v_exp_f32 v83, v83
    v_mfma_f32_16x16x32_bf16 v[220:223], a[244:247], v[16:19], v[220:223]
    v_exp_f32 v84, v84
    v_mfma_f32_16x16x32_bf16 v[224:227], a[244:247], v[20:23], v[224:227]
    ds_read_b128 a[220:223], v1 offset:4992
    v_mfma_f32_16x16x32_bf16 v[228:231], a[244:247], v[24:27], v[228:231]
    v_exp_f32 v85, v85
    v_mfma_f32_16x16x32_bf16 v[232:235], a[248:251], v[16:19], v[232:235]
    v_cvt_pk_bf16_f32 v36, v80, v81
    v_mfma_f32_16x16x32_bf16 v[236:239], a[248:251], v[20:23], v[236:239]
    s_add_u32 m0, s25, 143648
    v_cvt_pk_bf16_f32 v37, v82, v83
    v_mfma_f32_16x16x32_bf16 v[240:243], a[248:251], v[24:27], v[240:243]
    buffer_load_dwordx4 v4, s[16:19], s27 offen offset:1024 nt lds
    v_mfma_f32_16x16x32_bf16 v[244:247], a[252:255], v[16:19], v[244:247]
    v_exp_f32 v86, v86
    v_mfma_f32_16x16x32_bf16 v[248:251], a[252:255], v[20:23], v[248:251]
    v_exp_f32 v87, v87
    v_mfma_f32_16x16x32_bf16 v[252:255], a[252:255], v[24:27], v[252:255]
    v_mfma_f32_16x16x32_bf16 v[148:151], v[12:15], v[16:19], v[148:151]
    v_cvt_pk_bf16_f32 v38, v84, v85
    v_mfma_f32_16x16x32_bf16 v[152:155], v[12:15], v[20:23], v[152:155]
    v_cvt_pk_bf16_f32 v39, v86, v87
    v_mfma_f32_16x16x32_bf16 v[156:159], v[12:15], v[24:27], v[156:159]
    s_waitcnt lgkmcnt(0)
    v_add_u32 v2, 0xa500, v2
    v_mfma_f32_16x16x32_bf16 v[64:67], a[192:195], v[100:103], v[88:91]
    ds_read_b64_tr_b16 a[224:225], v2 offset:0
    v_exp_f32 v40, v40
    v_mfma_f32_16x16x32_bf16 v[72:75], a[192:195], v[104:107], v[92:95]
    ds_read_b64_tr_b16 a[226:227], v2 offset:4224
    v_exp_f32 v41, v41
    v_mfma_f32_16x16x32_bf16 v[80:83], a[192:195], v[108:111], v[96:99]
    ds_read_b64_tr_b16 a[228:229], v2 offset:32
    v_exp_f32 v42, v42
    v_mfma_f32_16x16x32_bf16 v[64:67], a[196:199], v[112:115], v[64:67]
    ds_read_b64_tr_b16 a[230:231], v2 offset:4256
    v_mfma_f32_16x16x32_bf16 v[72:75], a[196:199], v[116:119], v[72:75]
    ds_read_b64_tr_b16 a[232:233], v2 offset:256
    v_exp_f32 v43, v43
    v_mfma_f32_16x16x32_bf16 v[80:83], a[196:199], v[120:123], v[80:83]
    ds_read_b64_tr_b16 a[234:235], v2 offset:4480
    v_exp_f32 v44, v44
    v_mfma_f32_16x16x32_bf16 v[64:67], a[200:203], v[124:127], v[64:67]
    ds_read_b64_tr_b16 a[236:237], v2 offset:288
    s_add_u32 m0, s25, 135168
    v_mfma_f32_16x16x32_bf16 v[72:75], a[200:203], v[128:131], v[72:75]
    ds_read_b64_tr_b16 a[238:239], v2 offset:4512
    s_add_u32 s27, s62, 122880
    v_exp_f32 v45, v45
    v_mfma_f32_16x16x32_bf16 v[80:83], a[200:203], v[132:135], v[80:83]
    ds_read_b64_tr_b16 a[240:241], v2 offset:512
    buffer_load_dwordx4 v4, s[12:15], s27 offen nt lds
    v_cvt_pk_bf16_f32 v16, v40, v41
    v_mfma_f32_16x16x32_bf16 v[64:67], a[204:207], v[136:139], v[64:67]
    ds_read_b64_tr_b16 a[242:243], v2 offset:4736
    v_cvt_pk_bf16_f32 v17, v42, v43
    v_mfma_f32_16x16x32_bf16 v[72:75], a[204:207], v[140:143], v[72:75]
    ds_read_b64_tr_b16 a[244:245], v2 offset:544
    v_mfma_f32_16x16x32_bf16 v[80:83], a[204:207], v[144:147], v[80:83]
    ds_read_b64_tr_b16 a[246:247], v2 offset:4768
    v_exp_f32 v46, v46
    v_mfma_f32_16x16x32_bf16 v[68:71], a[208:211], v[100:103], v[88:91]
    ds_read_b64_tr_b16 a[248:249], v2 offset:768
    v_exp_f32 v47, v47
    v_mfma_f32_16x16x32_bf16 v[76:79], a[208:211], v[104:107], v[92:95]
    ds_read_b64_tr_b16 a[250:251], v2 offset:4992
    v_mfma_f32_16x16x32_bf16 v[84:87], a[208:211], v[108:111], v[96:99]
    ds_read_b64_tr_b16 a[252:253], v2 offset:800
    v_exp_f32 v48, v48
    v_mfma_f32_16x16x32_bf16 v[68:71], a[212:215], v[112:115], v[68:71]
    ds_read_b64_tr_b16 a[254:255], v2 offset:5024
    v_exp_f32 v49, v49
    v_mfma_f32_16x16x32_bf16 v[76:79], a[212:215], v[116:119], v[76:79]
    v_mfma_f32_16x16x32_bf16 v[84:87], a[212:215], v[120:123], v[84:87]
    v_cvt_pk_bf16_f32 v18, v44, v45
    v_mfma_f32_16x16x32_bf16 v[68:71], a[216:219], v[124:127], v[68:71]
    v_exp_f32 v50, v50
    v_mfma_f32_16x16x32_bf16 v[76:79], a[216:219], v[128:131], v[76:79]
    s_add_u32 m0, s25, 135200
    v_cvt_pk_bf16_f32 v19, v46, v47
    v_mfma_f32_16x16x32_bf16 v[84:87], a[216:219], v[132:135], v[84:87]
    buffer_load_dwordx4 v4, s[12:15], s27 offen offset:1024 nt lds
    v_mfma_f32_16x16x32_bf16 v[68:71], a[220:223], v[136:139], v[68:71]
    v_exp_f32 v51, v51
    v_mfma_f32_16x16x32_bf16 v[76:79], a[220:223], v[140:143], v[76:79]
    v_exp_f32 v52, v52
    v_mfma_f32_16x16x32_bf16 v[84:87], a[220:223], v[144:147], v[84:87]
    s_waitcnt lgkmcnt(0)
    v_mfma_f32_16x16x32_bf16 v[160:163], a[224:227], v[28:31], v[160:163]
    v_exp_f32 v53, v53
    v_mfma_f32_16x16x32_bf16 v[164:167], a[224:227], v[32:35], v[164:167]
    v_add_u32 v1, 0xffff7c00, v1
    v_cvt_pk_bf16_f32 v20, v48, v49
    v_mfma_f32_16x16x32_bf16 v[168:171], a[224:227], v[36:39], v[168:171]
    ds_read_b128 a[192:195], v1 offset:0
    v_cvt_pk_bf16_f32 v21, v50, v51
    v_mfma_f32_16x16x32_bf16 v[172:175], a[228:231], v[28:31], v[172:175]
    v_mfma_f32_16x16x32_bf16 v[176:179], a[228:231], v[32:35], v[176:179]
    ds_read_b128 a[196:199], v1 offset:256
    v_exp_f32 v54, v54
    v_mfma_f32_16x16x32_bf16 v[180:183], a[228:231], v[36:39], v[180:183]
    v_exp_f32 v55, v55
    v_mfma_f32_16x16x32_bf16 v[184:187], a[232:235], v[28:31], v[184:187]
    ds_read_b128 a[200:203], v1 offset:512
    s_add_u32 m0, s25, 59136
    v_mfma_f32_16x16x32_bf16 v[188:191], a[232:235], v[32:35], v[188:191]
    s_add_u32 s27, s62, 106496
    v_exp_f32 v56, v56
    v_mfma_f32_16x16x32_bf16 v[192:195], a[232:235], v[36:39], v[192:195]
    ds_read_b128 a[204:207], v1 offset:768
    buffer_load_dwordx4 v4, s[16:19], s27 offen nt lds
    v_exp_f32 v57, v57
    v_mfma_f32_16x16x32_bf16 v[196:199], a[236:239], v[28:31], v[196:199]
    v_mfma_f32_16x16x32_bf16 v[200:203], a[236:239], v[32:35], v[200:203]
    ds_read_b128 a[208:211], v1 offset:4224
    v_cvt_pk_bf16_f32 v22, v52, v53
    v_mfma_f32_16x16x32_bf16 v[204:207], a[236:239], v[36:39], v[204:207]
    v_exp_f32 v58, v58
    v_mfma_f32_16x16x32_bf16 v[208:211], a[240:243], v[28:31], v[208:211]
    ds_read_b128 a[212:215], v1 offset:4480
    v_cvt_pk_bf16_f32 v23, v54, v55
    v_mfma_f32_16x16x32_bf16 v[212:215], a[240:243], v[32:35], v[212:215]
    v_mfma_f32_16x16x32_bf16 v[216:219], a[240:243], v[36:39], v[216:219]
    ds_read_b128 a[216:219], v1 offset:4736
    v_exp_f32 v59, v59
    v_mfma_f32_16x16x32_bf16 v[220:223], a[244:247], v[28:31], v[220:223]
    v_exp_f32 v60, v60
    v_mfma_f32_16x16x32_bf16 v[224:227], a[244:247], v[32:35], v[224:227]
    ds_read_b128 a[220:223], v1 offset:4992
    v_mfma_f32_16x16x32_bf16 v[228:231], a[244:247], v[36:39], v[228:231]
    v_exp_f32 v61, v61
    v_mfma_f32_16x16x32_bf16 v[232:235], a[248:251], v[28:31], v[232:235]
    v_cvt_pk_bf16_f32 v24, v56, v57
    v_mfma_f32_16x16x32_bf16 v[236:239], a[248:251], v[32:35], v[236:239]
    s_add_u32 m0, s25, 59168
    v_cvt_pk_bf16_f32 v25, v58, v59
    v_mfma_f32_16x16x32_bf16 v[240:243], a[248:251], v[36:39], v[240:243]
    buffer_load_dwordx4 v4, s[16:19], s27 offen offset:1024 nt lds
    v_mfma_f32_16x16x32_bf16 v[244:247], a[252:255], v[28:31], v[244:247]
    v_exp_f32 v62, v62
    v_mfma_f32_16x16x32_bf16 v[248:251], a[252:255], v[32:35], v[248:251]
    v_exp_f32 v63, v63
    v_mfma_f32_16x16x32_bf16 v[252:255], a[252:255], v[36:39], v[252:255]
    v_mfma_f32_16x16x32_bf16 v[148:151], v[12:15], v[28:31], v[148:151]
    v_cvt_pk_bf16_f32 v26, v60, v61
    v_mfma_f32_16x16x32_bf16 v[152:155], v[12:15], v[32:35], v[152:155]
    v_cvt_pk_bf16_f32 v27, v62, v63
    v_mfma_f32_16x16x32_bf16 v[156:159], v[12:15], v[36:39], v[156:159]
    s_waitcnt lgkmcnt(0)
    s_waitcnt vmcnt(6)
    s_barrier
    v_add_u32 v2, 0x8400, v2
    v_mfma_f32_16x16x32_bf16 v[40:43], a[192:195], v[100:103], v[88:91]
    ds_read_b64_tr_b16 a[224:225], v2 offset:0
    v_exp_f32 v64, v64
    v_mfma_f32_16x16x32_bf16 v[48:51], a[192:195], v[104:107], v[92:95]
    ds_read_b64_tr_b16 a[226:227], v2 offset:4224
    v_exp_f32 v65, v65
    v_mfma_f32_16x16x32_bf16 v[56:59], a[192:195], v[108:111], v[96:99]
    ds_read_b64_tr_b16 a[228:229], v2 offset:32
    v_exp_f32 v66, v66
    v_mfma_f32_16x16x32_bf16 v[40:43], a[196:199], v[112:115], v[40:43]
    ds_read_b64_tr_b16 a[230:231], v2 offset:4256
    v_mfma_f32_16x16x32_bf16 v[48:51], a[196:199], v[116:119], v[48:51]
    ds_read_b64_tr_b16 a[232:233], v2 offset:256
    v_exp_f32 v67, v67
    v_mfma_f32_16x16x32_bf16 v[56:59], a[196:199], v[120:123], v[56:59]
    ds_read_b64_tr_b16 a[234:235], v2 offset:4480
    v_exp_f32 v68, v68
    v_mfma_f32_16x16x32_bf16 v[40:43], a[200:203], v[124:127], v[40:43]
    ds_read_b64_tr_b16 a[236:237], v2 offset:288
    v_mfma_f32_16x16x32_bf16 v[48:51], a[200:203], v[128:131], v[48:51]
    ds_read_b64_tr_b16 a[238:239], v2 offset:4512
    v_exp_f32 v69, v69
    v_mfma_f32_16x16x32_bf16 v[56:59], a[200:203], v[132:135], v[56:59]
    ds_read_b64_tr_b16 a[240:241], v2 offset:512
    v_cvt_pk_bf16_f32 v28, v64, v65
    v_mfma_f32_16x16x32_bf16 v[40:43], a[204:207], v[136:139], v[40:43]
    ds_read_b64_tr_b16 a[242:243], v2 offset:4736
    v_cvt_pk_bf16_f32 v29, v66, v67
    v_mfma_f32_16x16x32_bf16 v[48:51], a[204:207], v[140:143], v[48:51]
    ds_read_b64_tr_b16 a[244:245], v2 offset:544
    v_mfma_f32_16x16x32_bf16 v[56:59], a[204:207], v[144:147], v[56:59]
    ds_read_b64_tr_b16 a[246:247], v2 offset:4768
    v_exp_f32 v70, v70
    v_mfma_f32_16x16x32_bf16 v[44:47], a[208:211], v[100:103], v[88:91]
    ds_read_b64_tr_b16 a[248:249], v2 offset:768
    s_add_u32 m0, s25, 67584
    v_exp_f32 v71, v71
    v_mfma_f32_16x16x32_bf16 v[52:55], a[208:211], v[104:107], v[92:95]
    ds_read_b64_tr_b16 a[250:251], v2 offset:4992
    s_add_u32 s27, s62, 114688
    v_mfma_f32_16x16x32_bf16 v[60:63], a[208:211], v[108:111], v[96:99]
    ds_read_b64_tr_b16 a[252:253], v2 offset:800
    buffer_load_dwordx4 v4, s[16:19], s27 offen nt lds
    v_exp_f32 v72, v72
    v_mfma_f32_16x16x32_bf16 v[44:47], a[212:215], v[112:115], v[44:47]
    ds_read_b64_tr_b16 a[254:255], v2 offset:5024
    v_exp_f32 v73, v73
    v_mfma_f32_16x16x32_bf16 v[52:55], a[212:215], v[116:119], v[52:55]
    v_mfma_f32_16x16x32_bf16 v[60:63], a[212:215], v[120:123], v[60:63]
    v_cvt_pk_bf16_f32 v30, v68, v69
    v_mfma_f32_16x16x32_bf16 v[44:47], a[216:219], v[124:127], v[44:47]
    v_exp_f32 v74, v74
    v_mfma_f32_16x16x32_bf16 v[52:55], a[216:219], v[128:131], v[52:55]
    v_cvt_pk_bf16_f32 v31, v70, v71
    v_mfma_f32_16x16x32_bf16 v[60:63], a[216:219], v[132:135], v[60:63]
    v_mfma_f32_16x16x32_bf16 v[44:47], a[220:223], v[136:139], v[44:47]
    v_exp_f32 v75, v75
    v_mfma_f32_16x16x32_bf16 v[52:55], a[220:223], v[140:143], v[52:55]
    v_exp_f32 v76, v76
    v_mfma_f32_16x16x32_bf16 v[60:63], a[220:223], v[144:147], v[60:63]
    s_waitcnt lgkmcnt(0)
    v_mfma_f32_16x16x32_bf16 v[160:163], a[224:227], v[16:19], v[160:163]
    v_exp_f32 v77, v77
    v_mfma_f32_16x16x32_bf16 v[164:167], a[224:227], v[20:23], v[164:167]
    v_add_u32 v1, 0x4200, v1
    v_cvt_pk_bf16_f32 v32, v72, v73
    v_mfma_f32_16x16x32_bf16 v[168:171], a[224:227], v[24:27], v[168:171]
    ds_read_b128 a[192:195], v1 offset:0
    v_cvt_pk_bf16_f32 v33, v74, v75
    v_mfma_f32_16x16x32_bf16 v[172:175], a[228:231], v[16:19], v[172:175]
    v_mfma_f32_16x16x32_bf16 v[176:179], a[228:231], v[20:23], v[176:179]
    ds_read_b128 a[196:199], v1 offset:256
    v_exp_f32 v78, v78
    v_mfma_f32_16x16x32_bf16 v[180:183], a[228:231], v[24:27], v[180:183]
    v_exp_f32 v79, v79
    v_mfma_f32_16x16x32_bf16 v[184:187], a[232:235], v[16:19], v[184:187]
    ds_read_b128 a[200:203], v1 offset:512
    v_mfma_f32_16x16x32_bf16 v[188:191], a[232:235], v[20:23], v[188:191]
    v_exp_f32 v80, v80
    v_mfma_f32_16x16x32_bf16 v[192:195], a[232:235], v[24:27], v[192:195]
    ds_read_b128 a[204:207], v1 offset:768
    v_exp_f32 v81, v81
    v_mfma_f32_16x16x32_bf16 v[196:199], a[236:239], v[16:19], v[196:199]
    v_mfma_f32_16x16x32_bf16 v[200:203], a[236:239], v[20:23], v[200:203]
    ds_read_b128 a[208:211], v1 offset:4224
    v_cvt_pk_bf16_f32 v34, v76, v77
    v_mfma_f32_16x16x32_bf16 v[204:207], a[236:239], v[24:27], v[204:207]
    v_exp_f32 v82, v82
    v_mfma_f32_16x16x32_bf16 v[208:211], a[240:243], v[16:19], v[208:211]
    ds_read_b128 a[212:215], v1 offset:4480
    v_cvt_pk_bf16_f32 v35, v78, v79
    v_mfma_f32_16x16x32_bf16 v[212:215], a[240:243], v[20:23], v[212:215]
    s_add_u32 m0, s25, 67616
    v_mfma_f32_16x16x32_bf16 v[216:219], a[240:243], v[24:27], v[216:219]
    ds_read_b128 a[216:219], v1 offset:4736
    buffer_load_dwordx4 v4, s[16:19], s27 offen offset:1024 nt lds
    v_exp_f32 v83, v83
    v_mfma_f32_16x16x32_bf16 v[220:223], a[244:247], v[16:19], v[220:223]
    v_exp_f32 v84, v84
    v_mfma_f32_16x16x32_bf16 v[224:227], a[244:247], v[20:23], v[224:227]
    ds_read_b128 a[220:223], v1 offset:4992
    v_mfma_f32_16x16x32_bf16 v[228:231], a[244:247], v[24:27], v[228:231]
    v_exp_f32 v85, v85
    v_mfma_f32_16x16x32_bf16 v[232:235], a[248:251], v[16:19], v[232:235]
    v_cvt_pk_bf16_f32 v36, v80, v81
    v_mfma_f32_16x16x32_bf16 v[236:239], a[248:251], v[20:23], v[236:239]
    v_cvt_pk_bf16_f32 v37, v82, v83
    v_mfma_f32_16x16x32_bf16 v[240:243], a[248:251], v[24:27], v[240:243]
    v_mfma_f32_16x16x32_bf16 v[244:247], a[252:255], v[16:19], v[244:247]
    v_exp_f32 v86, v86
    v_mfma_f32_16x16x32_bf16 v[248:251], a[252:255], v[20:23], v[248:251]
    v_exp_f32 v87, v87
    v_mfma_f32_16x16x32_bf16 v[252:255], a[252:255], v[24:27], v[252:255]
    v_mfma_f32_16x16x32_bf16 v[148:151], v[12:15], v[16:19], v[148:151]
    v_cvt_pk_bf16_f32 v38, v84, v85
    v_mfma_f32_16x16x32_bf16 v[152:155], v[12:15], v[20:23], v[152:155]
    v_cvt_pk_bf16_f32 v39, v86, v87
    v_mfma_f32_16x16x32_bf16 v[156:159], v[12:15], v[24:27], v[156:159]
    s_waitcnt lgkmcnt(0)
    v_add_u32 v2, 0xfffe9500, v2
    v_mfma_f32_16x16x32_bf16 v[64:67], a[192:195], v[100:103], v[88:91]
    ds_read_b64_tr_b16 a[224:225], v2 offset:0
    v_exp_f32 v40, v40
    v_mfma_f32_16x16x32_bf16 v[72:75], a[192:195], v[104:107], v[92:95]
    ds_read_b64_tr_b16 a[226:227], v2 offset:4224
    v_exp_f32 v41, v41
    v_mfma_f32_16x16x32_bf16 v[80:83], a[192:195], v[108:111], v[96:99]
    ds_read_b64_tr_b16 a[228:229], v2 offset:32
    v_exp_f32 v42, v42
    v_mfma_f32_16x16x32_bf16 v[64:67], a[196:199], v[112:115], v[64:67]
    ds_read_b64_tr_b16 a[230:231], v2 offset:4256
    v_mfma_f32_16x16x32_bf16 v[72:75], a[196:199], v[116:119], v[72:75]
    ds_read_b64_tr_b16 a[232:233], v2 offset:256
    v_exp_f32 v43, v43
    v_mfma_f32_16x16x32_bf16 v[80:83], a[196:199], v[120:123], v[80:83]
    ds_read_b64_tr_b16 a[234:235], v2 offset:4480
    v_exp_f32 v44, v44
    v_mfma_f32_16x16x32_bf16 v[64:67], a[200:203], v[124:127], v[64:67]
    ds_read_b64_tr_b16 a[236:237], v2 offset:288
    v_mfma_f32_16x16x32_bf16 v[72:75], a[200:203], v[128:131], v[72:75]
    ds_read_b64_tr_b16 a[238:239], v2 offset:4512
    v_exp_f32 v45, v45
    v_mfma_f32_16x16x32_bf16 v[80:83], a[200:203], v[132:135], v[80:83]
    ds_read_b64_tr_b16 a[240:241], v2 offset:512
    v_cvt_pk_bf16_f32 v16, v40, v41
    v_mfma_f32_16x16x32_bf16 v[64:67], a[204:207], v[136:139], v[64:67]
    ds_read_b64_tr_b16 a[242:243], v2 offset:4736
    v_cvt_pk_bf16_f32 v17, v42, v43
    v_mfma_f32_16x16x32_bf16 v[72:75], a[204:207], v[140:143], v[72:75]
    ds_read_b64_tr_b16 a[244:245], v2 offset:544
    v_mfma_f32_16x16x32_bf16 v[80:83], a[204:207], v[144:147], v[80:83]
    ds_read_b64_tr_b16 a[246:247], v2 offset:4768
    v_exp_f32 v46, v46
    v_mfma_f32_16x16x32_bf16 v[68:71], a[208:211], v[100:103], v[88:91]
    ds_read_b64_tr_b16 a[248:249], v2 offset:768
    s_add_u32 m0, s25, 50688
    v_exp_f32 v47, v47
    v_mfma_f32_16x16x32_bf16 v[76:79], a[208:211], v[104:107], v[92:95]
    ds_read_b64_tr_b16 a[250:251], v2 offset:4992
    s_add_u32 s27, s62, 122880
    v_mfma_f32_16x16x32_bf16 v[84:87], a[208:211], v[108:111], v[96:99]
    ds_read_b64_tr_b16 a[252:253], v2 offset:800
    buffer_load_dwordx4 v4, s[16:19], s27 offen nt lds
    v_exp_f32 v48, v48
    v_mfma_f32_16x16x32_bf16 v[68:71], a[212:215], v[112:115], v[68:71]
    ds_read_b64_tr_b16 a[254:255], v2 offset:5024
    v_exp_f32 v49, v49
    v_mfma_f32_16x16x32_bf16 v[76:79], a[212:215], v[116:119], v[76:79]
    v_mfma_f32_16x16x32_bf16 v[84:87], a[212:215], v[120:123], v[84:87]
    v_cvt_pk_bf16_f32 v18, v44, v45
    v_mfma_f32_16x16x32_bf16 v[68:71], a[216:219], v[124:127], v[68:71]
    v_exp_f32 v50, v50
    v_mfma_f32_16x16x32_bf16 v[76:79], a[216:219], v[128:131], v[76:79]
    v_cvt_pk_bf16_f32 v19, v46, v47
    v_mfma_f32_16x16x32_bf16 v[84:87], a[216:219], v[132:135], v[84:87]
    v_mfma_f32_16x16x32_bf16 v[68:71], a[220:223], v[136:139], v[68:71]
    v_exp_f32 v51, v51
    v_mfma_f32_16x16x32_bf16 v[76:79], a[220:223], v[140:143], v[76:79]
    v_exp_f32 v52, v52
    v_mfma_f32_16x16x32_bf16 v[84:87], a[220:223], v[144:147], v[84:87]
    s_waitcnt lgkmcnt(0)
    v_mfma_f32_16x16x32_bf16 v[160:163], a[224:227], v[28:31], v[160:163]
    v_exp_f32 v53, v53
    v_mfma_f32_16x16x32_bf16 v[164:167], a[224:227], v[32:35], v[164:167]
    v_add_u32 v1, 0x8400, v1
    v_cvt_pk_bf16_f32 v20, v48, v49
    v_mfma_f32_16x16x32_bf16 v[168:171], a[224:227], v[36:39], v[168:171]
    ds_read_b128 a[192:195], v1 offset:0
    v_cvt_pk_bf16_f32 v21, v50, v51
    v_mfma_f32_16x16x32_bf16 v[172:175], a[228:231], v[28:31], v[172:175]
    v_mfma_f32_16x16x32_bf16 v[176:179], a[228:231], v[32:35], v[176:179]
    ds_read_b128 a[196:199], v1 offset:256
    v_exp_f32 v54, v54
    v_mfma_f32_16x16x32_bf16 v[180:183], a[228:231], v[36:39], v[180:183]
    v_exp_f32 v55, v55
    v_mfma_f32_16x16x32_bf16 v[184:187], a[232:235], v[28:31], v[184:187]
    ds_read_b128 a[200:203], v1 offset:512
    v_mfma_f32_16x16x32_bf16 v[188:191], a[232:235], v[32:35], v[188:191]
    v_exp_f32 v56, v56
    v_mfma_f32_16x16x32_bf16 v[192:195], a[232:235], v[36:39], v[192:195]
    ds_read_b128 a[204:207], v1 offset:768
    v_exp_f32 v57, v57
    v_mfma_f32_16x16x32_bf16 v[196:199], a[236:239], v[28:31], v[196:199]
    v_mfma_f32_16x16x32_bf16 v[200:203], a[236:239], v[32:35], v[200:203]
    ds_read_b128 a[208:211], v1 offset:4224
    v_cvt_pk_bf16_f32 v22, v52, v53
    v_mfma_f32_16x16x32_bf16 v[204:207], a[236:239], v[36:39], v[204:207]
    v_exp_f32 v58, v58
    v_mfma_f32_16x16x32_bf16 v[208:211], a[240:243], v[28:31], v[208:211]
    ds_read_b128 a[212:215], v1 offset:4480
    v_cvt_pk_bf16_f32 v23, v54, v55
    v_mfma_f32_16x16x32_bf16 v[212:215], a[240:243], v[32:35], v[212:215]
    s_add_u32 m0, s25, 50720
    v_mfma_f32_16x16x32_bf16 v[216:219], a[240:243], v[36:39], v[216:219]
    ds_read_b128 a[216:219], v1 offset:4736
    buffer_load_dwordx4 v4, s[16:19], s27 offen offset:1024 nt lds
    v_exp_f32 v59, v59
    v_mfma_f32_16x16x32_bf16 v[220:223], a[244:247], v[28:31], v[220:223]
    v_exp_f32 v60, v60
    v_mfma_f32_16x16x32_bf16 v[224:227], a[244:247], v[32:35], v[224:227]
    ds_read_b128 a[220:223], v1 offset:4992
    v_mfma_f32_16x16x32_bf16 v[228:231], a[244:247], v[36:39], v[228:231]
    v_exp_f32 v61, v61
    v_mfma_f32_16x16x32_bf16 v[232:235], a[248:251], v[28:31], v[232:235]
    v_cvt_pk_bf16_f32 v24, v56, v57
    v_mfma_f32_16x16x32_bf16 v[236:239], a[248:251], v[32:35], v[236:239]
    v_cvt_pk_bf16_f32 v25, v58, v59
    v_mfma_f32_16x16x32_bf16 v[240:243], a[248:251], v[36:39], v[240:243]
    v_mfma_f32_16x16x32_bf16 v[244:247], a[252:255], v[28:31], v[244:247]
    v_exp_f32 v62, v62
    v_mfma_f32_16x16x32_bf16 v[248:251], a[252:255], v[32:35], v[248:251]
    v_exp_f32 v63, v63
    v_mfma_f32_16x16x32_bf16 v[252:255], a[252:255], v[36:39], v[252:255]
    v_mfma_f32_16x16x32_bf16 v[148:151], v[12:15], v[28:31], v[148:151]
    v_cvt_pk_bf16_f32 v26, v60, v61
    v_mfma_f32_16x16x32_bf16 v[152:155], v[12:15], v[32:35], v[152:155]
    v_cvt_pk_bf16_f32 v27, v62, v63
    v_mfma_f32_16x16x32_bf16 v[156:159], v[12:15], v[36:39], v[156:159]
    s_waitcnt lgkmcnt(0)
    s_waitcnt vmcnt(2)
    s_barrier
    v_add_u32 v2, 0x1ad00, v2
    v_mfma_f32_16x16x32_bf16 v[40:43], a[192:195], v[100:103], v[88:91]
    ds_read_b64_tr_b16 a[224:225], v2 offset:0
    v_exp_f32 v64, v64
    v_mfma_f32_16x16x32_bf16 v[48:51], a[192:195], v[104:107], v[92:95]
    ds_read_b64_tr_b16 a[226:227], v2 offset:4224
    v_exp_f32 v65, v65
    v_mfma_f32_16x16x32_bf16 v[56:59], a[192:195], v[108:111], v[96:99]
    ds_read_b64_tr_b16 a[228:229], v2 offset:32
    s_add_u32 s63, s63, 256
    v_exp_f32 v66, v66
    v_mfma_f32_16x16x32_bf16 v[40:43], a[196:199], v[112:115], v[40:43]
    ds_read_b64_tr_b16 a[230:231], v2 offset:4256
    s_add_u32 m0, s26, 126720
    v_mfma_f32_16x16x32_bf16 v[48:51], a[196:199], v[116:119], v[48:51]
    ds_read_b64_tr_b16 a[232:233], v2 offset:256
    s_add_u32 s27, s63, 0
    v_exp_f32 v67, v67
    v_mfma_f32_16x16x32_bf16 v[56:59], a[196:199], v[120:123], v[56:59]
    ds_read_b64_tr_b16 a[234:235], v2 offset:4480
    buffer_load_dwordx4 v5, s[8:11], s27 offen lds
    v_exp_f32 v68, v68
    v_mfma_f32_16x16x32_bf16 v[40:43], a[200:203], v[124:127], v[40:43]
    ds_read_b64_tr_b16 a[236:237], v2 offset:288
    v_mfma_f32_16x16x32_bf16 v[48:51], a[200:203], v[128:131], v[48:51]
    ds_read_b64_tr_b16 a[238:239], v2 offset:4512
    v_exp_f32 v69, v69
    v_mfma_f32_16x16x32_bf16 v[56:59], a[200:203], v[132:135], v[56:59]
    ds_read_b64_tr_b16 a[240:241], v2 offset:512
    v_cvt_pk_bf16_f32 v28, v64, v65
    v_mfma_f32_16x16x32_bf16 v[40:43], a[204:207], v[136:139], v[40:43]
    ds_read_b64_tr_b16 a[242:243], v2 offset:4736
    s_add_u32 m0, s26, 127744
    v_cvt_pk_bf16_f32 v29, v66, v67
    v_mfma_f32_16x16x32_bf16 v[48:51], a[204:207], v[140:143], v[48:51]
    ds_read_b64_tr_b16 a[244:245], v2 offset:544
    s_add_u32 s27, s63, 32768
    v_mfma_f32_16x16x32_bf16 v[56:59], a[204:207], v[144:147], v[56:59]
    ds_read_b64_tr_b16 a[246:247], v2 offset:4768
    buffer_load_dwordx4 v5, s[8:11], s27 offen lds
    v_exp_f32 v70, v70
    v_mfma_f32_16x16x32_bf16 v[44:47], a[208:211], v[100:103], v[88:91]
    ds_read_b64_tr_b16 a[248:249], v2 offset:768
    v_exp_f32 v71, v71
    v_mfma_f32_16x16x32_bf16 v[52:55], a[208:211], v[104:107], v[92:95]
    ds_read_b64_tr_b16 a[250:251], v2 offset:4992
    v_mfma_f32_16x16x32_bf16 v[60:63], a[208:211], v[108:111], v[96:99]
    ds_read_b64_tr_b16 a[252:253], v2 offset:800
    v_exp_f32 v72, v72
    v_mfma_f32_16x16x32_bf16 v[44:47], a[212:215], v[112:115], v[44:47]
    ds_read_b64_tr_b16 a[254:255], v2 offset:5024
    s_add_u32 m0, s26, 118272
    v_exp_f32 v73, v73
    v_mfma_f32_16x16x32_bf16 v[52:55], a[212:215], v[116:119], v[52:55]
    s_add_u32 s27, s63, 262144
    v_mfma_f32_16x16x32_bf16 v[60:63], a[212:215], v[120:123], v[60:63]
    buffer_load_dwordx4 v5, s[8:11], s27 offen lds
    v_cvt_pk_bf16_f32 v30, v68, v69
    v_mfma_f32_16x16x32_bf16 v[44:47], a[216:219], v[124:127], v[44:47]
    v_exp_f32 v74, v74
    v_mfma_f32_16x16x32_bf16 v[52:55], a[216:219], v[128:131], v[52:55]
    v_cvt_pk_bf16_f32 v31, v70, v71
    v_mfma_f32_16x16x32_bf16 v[60:63], a[216:219], v[132:135], v[60:63]
    v_mfma_f32_16x16x32_bf16 v[44:47], a[220:223], v[136:139], v[44:47]
    s_add_u32 m0, s26, 119296
    v_exp_f32 v75, v75
    v_mfma_f32_16x16x32_bf16 v[52:55], a[220:223], v[140:143], v[52:55]
    s_add_u32 s27, s63, 294912
    v_exp_f32 v76, v76
    v_mfma_f32_16x16x32_bf16 v[60:63], a[220:223], v[144:147], v[60:63]
    buffer_load_dwordx4 v5, s[8:11], s27 offen lds
    s_waitcnt lgkmcnt(0)
    v_mfma_f32_16x16x32_bf16 v[160:163], a[224:227], v[16:19], v[160:163]
    v_exp_f32 v77, v77
    v_mfma_f32_16x16x32_bf16 v[164:167], a[224:227], v[20:23], v[164:167]
    v_add_u32 v1, 0x4200, v1
    v_cvt_pk_bf16_f32 v32, v72, v73
    v_mfma_f32_16x16x32_bf16 v[168:171], a[224:227], v[24:27], v[168:171]
    ds_read_b128 a[192:195], v1 offset:0
    v_cvt_pk_bf16_f32 v33, v74, v75
    v_mfma_f32_16x16x32_bf16 v[172:175], a[228:231], v[16:19], v[172:175]
    s_add_u32 m0, s26, 109824
    v_mfma_f32_16x16x32_bf16 v[176:179], a[228:231], v[20:23], v[176:179]
    ds_read_b128 a[196:199], v1 offset:256
    s_add_u32 s27, s63, 524288
    v_exp_f32 v78, v78
    v_mfma_f32_16x16x32_bf16 v[180:183], a[228:231], v[24:27], v[180:183]
    buffer_load_dwordx4 v5, s[8:11], s27 offen lds
    v_exp_f32 v79, v79
    v_mfma_f32_16x16x32_bf16 v[184:187], a[232:235], v[16:19], v[184:187]
    ds_read_b128 a[200:203], v1 offset:512
    v_mfma_f32_16x16x32_bf16 v[188:191], a[232:235], v[20:23], v[188:191]
    v_exp_f32 v80, v80
    v_mfma_f32_16x16x32_bf16 v[192:195], a[232:235], v[24:27], v[192:195]
    ds_read_b128 a[204:207], v1 offset:768
    v_exp_f32 v81, v81
    v_mfma_f32_16x16x32_bf16 v[196:199], a[236:239], v[16:19], v[196:199]
    s_add_u32 m0, s26, 110848
    v_mfma_f32_16x16x32_bf16 v[200:203], a[236:239], v[20:23], v[200:203]
    ds_read_b128 a[208:211], v1 offset:4224
    s_add_u32 s27, s63, 557056
    v_cvt_pk_bf16_f32 v34, v76, v77
    v_mfma_f32_16x16x32_bf16 v[204:207], a[236:239], v[24:27], v[204:207]
    buffer_load_dwordx4 v5, s[8:11], s27 offen lds
    v_exp_f32 v82, v82
    v_mfma_f32_16x16x32_bf16 v[208:211], a[240:243], v[16:19], v[208:211]
    ds_read_b128 a[212:215], v1 offset:4480
    v_cvt_pk_bf16_f32 v35, v78, v79
    v_mfma_f32_16x16x32_bf16 v[212:215], a[240:243], v[20:23], v[212:215]
    v_mfma_f32_16x16x32_bf16 v[216:219], a[240:243], v[24:27], v[216:219]
    ds_read_b128 a[216:219], v1 offset:4736
    v_exp_f32 v83, v83
    v_mfma_f32_16x16x32_bf16 v[220:223], a[244:247], v[16:19], v[220:223]
    s_add_u32 m0, s26, 101376
    v_exp_f32 v84, v84
    v_mfma_f32_16x16x32_bf16 v[224:227], a[244:247], v[20:23], v[224:227]
    ds_read_b128 a[220:223], v1 offset:4992
    s_add_u32 s27, s63, 786432
    v_mfma_f32_16x16x32_bf16 v[228:231], a[244:247], v[24:27], v[228:231]
    buffer_load_dwordx4 v5, s[8:11], s27 offen lds
    v_exp_f32 v85, v85
    v_mfma_f32_16x16x32_bf16 v[232:235], a[248:251], v[16:19], v[232:235]
    v_cvt_pk_bf16_f32 v36, v80, v81
    v_mfma_f32_16x16x32_bf16 v[236:239], a[248:251], v[20:23], v[236:239]
    v_cvt_pk_bf16_f32 v37, v82, v83
    v_mfma_f32_16x16x32_bf16 v[240:243], a[248:251], v[24:27], v[240:243]
    v_mfma_f32_16x16x32_bf16 v[244:247], a[252:255], v[16:19], v[244:247]
    s_add_u32 m0, s26, 102400
    v_exp_f32 v86, v86
    v_mfma_f32_16x16x32_bf16 v[248:251], a[252:255], v[20:23], v[248:251]
    s_add_u32 s27, s63, 819200
    v_exp_f32 v87, v87
    v_mfma_f32_16x16x32_bf16 v[252:255], a[252:255], v[24:27], v[252:255]
    buffer_load_dwordx4 v5, s[8:11], s27 offen lds
    v_mfma_f32_16x16x32_bf16 v[148:151], v[12:15], v[16:19], v[148:151]
    v_cvt_pk_bf16_f32 v38, v84, v85
    v_mfma_f32_16x16x32_bf16 v[152:155], v[12:15], v[20:23], v[152:155]
    v_cvt_pk_bf16_f32 v39, v86, v87
    v_mfma_f32_16x16x32_bf16 v[156:159], v[12:15], v[24:27], v[156:159]
    s_waitcnt lgkmcnt(0)
    v_add_u32 v2, 0xfffeb600, v2
    v_mfma_f32_16x16x32_bf16 v[64:67], a[192:195], v[100:103], v[88:91]
    ds_read_b64_tr_b16 a[224:225], v2 offset:0
    v_exp_f32 v40, v40
    v_mfma_f32_16x16x32_bf16 v[72:75], a[192:195], v[104:107], v[92:95]
    ds_read_b64_tr_b16 a[226:227], v2 offset:4224
    v_exp_f32 v41, v41
    v_mfma_f32_16x16x32_bf16 v[80:83], a[192:195], v[108:111], v[96:99]
    ds_read_b64_tr_b16 a[228:229], v2 offset:32
    v_exp_f32 v42, v42
    v_mfma_f32_16x16x32_bf16 v[64:67], a[196:199], v[112:115], v[64:67]
    ds_read_b64_tr_b16 a[230:231], v2 offset:4256
    v_mfma_f32_16x16x32_bf16 v[72:75], a[196:199], v[116:119], v[72:75]
    ds_read_b64_tr_b16 a[232:233], v2 offset:256
    s_add_u32 m0, s26, 92928
    v_exp_f32 v43, v43
    v_mfma_f32_16x16x32_bf16 v[80:83], a[196:199], v[120:123], v[80:83]
    ds_read_b64_tr_b16 a[234:235], v2 offset:4480
    s_add_u32 s27, s63, 1048576
    v_exp_f32 v44, v44
    v_mfma_f32_16x16x32_bf16 v[64:67], a[200:203], v[124:127], v[64:67]
    ds_read_b64_tr_b16 a[236:237], v2 offset:288
    buffer_load_dwordx4 v5, s[8:11], s27 offen lds
    v_mfma_f32_16x16x32_bf16 v[72:75], a[200:203], v[128:131], v[72:75]
    ds_read_b64_tr_b16 a[238:239], v2 offset:4512
    v_exp_f32 v45, v45
    v_mfma_f32_16x16x32_bf16 v[80:83], a[200:203], v[132:135], v[80:83]
    ds_read_b64_tr_b16 a[240:241], v2 offset:512
    v_cvt_pk_bf16_f32 v16, v40, v41
    v_mfma_f32_16x16x32_bf16 v[64:67], a[204:207], v[136:139], v[64:67]
    ds_read_b64_tr_b16 a[242:243], v2 offset:4736
    v_cvt_pk_bf16_f32 v17, v42, v43
    v_mfma_f32_16x16x32_bf16 v[72:75], a[204:207], v[140:143], v[72:75]
    ds_read_b64_tr_b16 a[244:245], v2 offset:544
    v_mfma_f32_16x16x32_bf16 v[80:83], a[204:207], v[144:147], v[80:83]
    ds_read_b64_tr_b16 a[246:247], v2 offset:4768
    v_exp_f32 v46, v46
    v_mfma_f32_16x16x32_bf16 v[68:71], a[208:211], v[100:103], v[88:91]
    ds_read_b64_tr_b16 a[248:249], v2 offset:768
    s_add_u32 m0, s26, 93952
    v_exp_f32 v47, v47
    v_mfma_f32_16x16x32_bf16 v[76:79], a[208:211], v[104:107], v[92:95]
    ds_read_b64_tr_b16 a[250:251], v2 offset:4992
    s_add_u32 s27, s63, 1081344
    v_mfma_f32_16x16x32_bf16 v[84:87], a[208:211], v[108:111], v[96:99]
    ds_read_b64_tr_b16 a[252:253], v2 offset:800
    buffer_load_dwordx4 v5, s[8:11], s27 offen lds
    v_exp_f32 v48, v48
    v_mfma_f32_16x16x32_bf16 v[68:71], a[212:215], v[112:115], v[68:71]
    ds_read_b64_tr_b16 a[254:255], v2 offset:5024
    v_exp_f32 v49, v49
    v_mfma_f32_16x16x32_bf16 v[76:79], a[212:215], v[116:119], v[76:79]
    v_mfma_f32_16x16x32_bf16 v[84:87], a[212:215], v[120:123], v[84:87]
    v_cvt_pk_bf16_f32 v18, v44, v45
    v_mfma_f32_16x16x32_bf16 v[68:71], a[216:219], v[124:127], v[68:71]
    v_exp_f32 v50, v50
    v_mfma_f32_16x16x32_bf16 v[76:79], a[216:219], v[128:131], v[76:79]
    s_add_u32 s62, s62, 0x20000
    v_cvt_pk_bf16_f32 v19, v46, v47
    v_mfma_f32_16x16x32_bf16 v[84:87], a[216:219], v[132:135], v[84:87]
    s_add_u32 m0, s25, 84480
    v_mfma_f32_16x16x32_bf16 v[68:71], a[220:223], v[136:139], v[68:71]
    s_add_u32 s27, s62, 0
    v_exp_f32 v51, v51
    v_mfma_f32_16x16x32_bf16 v[76:79], a[220:223], v[140:143], v[76:79]
    buffer_load_dwordx4 v4, s[12:15], s27 offen nt lds
    v_exp_f32 v52, v52
    v_mfma_f32_16x16x32_bf16 v[84:87], a[220:223], v[144:147], v[84:87]
    s_waitcnt lgkmcnt(0)
    v_mfma_f32_16x16x32_bf16 v[160:163], a[224:227], v[28:31], v[160:163]
    v_exp_f32 v53, v53
    v_mfma_f32_16x16x32_bf16 v[164:167], a[224:227], v[32:35], v[164:167]
    v_add_u32 v2, 0x2100, v2
    v_cvt_pk_bf16_f32 v20, v48, v49
    v_mfma_f32_16x16x32_bf16 v[168:171], a[224:227], v[36:39], v[168:171]
    ds_read_b64_tr_b16 a[192:193], v2 offset:0
    v_cvt_pk_bf16_f32 v21, v50, v51
    v_mfma_f32_16x16x32_bf16 v[172:175], a[228:231], v[28:31], v[172:175]
    ds_read_b64_tr_b16 a[194:195], v2 offset:4224
    v_mfma_f32_16x16x32_bf16 v[176:179], a[228:231], v[32:35], v[176:179]
    ds_read_b64_tr_b16 a[196:197], v2 offset:32
    v_exp_f32 v54, v54
    v_mfma_f32_16x16x32_bf16 v[180:183], a[228:231], v[36:39], v[180:183]
    ds_read_b64_tr_b16 a[198:199], v2 offset:4256
    s_add_u32 m0, s25, 84512
    v_exp_f32 v55, v55
    v_mfma_f32_16x16x32_bf16 v[184:187], a[232:235], v[28:31], v[184:187]
    ds_read_b64_tr_b16 a[200:201], v2 offset:256
    buffer_load_dwordx4 v4, s[12:15], s27 offen offset:1024 nt lds
    v_mfma_f32_16x16x32_bf16 v[188:191], a[232:235], v[32:35], v[188:191]
    ds_read_b64_tr_b16 a[202:203], v2 offset:4480
    v_exp_f32 v56, v56
    v_mfma_f32_16x16x32_bf16 v[192:195], a[232:235], v[36:39], v[192:195]
    ds_read_b64_tr_b16 a[204:205], v2 offset:288
    v_exp_f32 v57, v57
    v_mfma_f32_16x16x32_bf16 v[196:199], a[236:239], v[28:31], v[196:199]
    ds_read_b64_tr_b16 a[206:207], v2 offset:4512
    v_mfma_f32_16x16x32_bf16 v[200:203], a[236:239], v[32:35], v[200:203]
    ds_read_b64_tr_b16 a[208:209], v2 offset:512
    v_cvt_pk_bf16_f32 v22, v52, v53
    v_mfma_f32_16x16x32_bf16 v[204:207], a[236:239], v[36:39], v[204:207]
    ds_read_b64_tr_b16 a[210:211], v2 offset:4736
    v_exp_f32 v58, v58
    v_mfma_f32_16x16x32_bf16 v[208:211], a[240:243], v[28:31], v[208:211]
    ds_read_b64_tr_b16 a[212:213], v2 offset:544
    s_add_u32 m0, s25, 76032
    v_cvt_pk_bf16_f32 v23, v54, v55
    v_mfma_f32_16x16x32_bf16 v[212:215], a[240:243], v[32:35], v[212:215]
    ds_read_b64_tr_b16 a[214:215], v2 offset:4768
    s_add_u32 s27, s62, 8192
    v_mfma_f32_16x16x32_bf16 v[216:219], a[240:243], v[36:39], v[216:219]
    ds_read_b64_tr_b16 a[216:217], v2 offset:768
    buffer_load_dwordx4 v4, s[12:15], s27 offen nt lds
    v_exp_f32 v59, v59
    v_mfma_f32_16x16x32_bf16 v[220:223], a[244:247], v[28:31], v[220:223]
    ds_read_b64_tr_b16 a[218:219], v2 offset:4992
    v_exp_f32 v60, v60
    v_mfma_f32_16x16x32_bf16 v[224:227], a[244:247], v[32:35], v[224:227]
    ds_read_b64_tr_b16 a[220:221], v2 offset:800
    v_mfma_f32_16x16x32_bf16 v[228:231], a[244:247], v[36:39], v[228:231]
    ds_read_b64_tr_b16 a[222:223], v2 offset:5024
    v_exp_f32 v61, v61
    v_mfma_f32_16x16x32_bf16 v[232:235], a[248:251], v[28:31], v[232:235]
    v_cvt_pk_bf16_f32 v24, v56, v57
    v_mfma_f32_16x16x32_bf16 v[236:239], a[248:251], v[32:35], v[236:239]
    v_cvt_pk_bf16_f32 v25, v58, v59
    v_mfma_f32_16x16x32_bf16 v[240:243], a[248:251], v[36:39], v[240:243]
    v_mfma_f32_16x16x32_bf16 v[244:247], a[252:255], v[28:31], v[244:247]
    s_add_u32 m0, s25, 76064
    v_exp_f32 v62, v62
    v_mfma_f32_16x16x32_bf16 v[248:251], a[252:255], v[32:35], v[248:251]
    buffer_load_dwordx4 v4, s[12:15], s27 offen offset:1024 nt lds
    v_exp_f32 v63, v63
    v_mfma_f32_16x16x32_bf16 v[252:255], a[252:255], v[36:39], v[252:255]
    v_mfma_f32_16x16x32_bf16 v[148:151], v[12:15], v[28:31], v[148:151]
    v_cvt_pk_bf16_f32 v26, v60, v61
    v_mfma_f32_16x16x32_bf16 v[152:155], v[12:15], v[32:35], v[152:155]
    v_cvt_pk_bf16_f32 v27, v62, v63
    v_mfma_f32_16x16x32_bf16 v[156:159], v[12:15], v[36:39], v[156:159]
    s_waitcnt lgkmcnt(0)
    s_waitcnt vmcnt(12)
    s_barrier
    v_add_u32 v2, 0xffffbe00, v2
    v_mfma_f32_16x16x32_bf16 v[160:163], a[192:195], v[16:19], v[160:163]
    ds_read_b64_tr_b16 a[224:225], v2 offset:0
    v_exp_f32 v64, v64
    v_exp_f32 v65, v65
    v_mfma_f32_16x16x32_bf16 v[164:167], a[192:195], v[20:23], v[164:167]
    ds_read_b64_tr_b16 a[226:227], v2 offset:4224
    v_exp_f32 v66, v66
    v_mfma_f32_16x16x32_bf16 v[168:171], a[192:195], v[24:27], v[168:171]
    ds_read_b64_tr_b16 a[228:229], v2 offset:32
    v_exp_f32 v67, v67
    v_exp_f32 v68, v68
    v_mfma_f32_16x16x32_bf16 v[172:175], a[196:199], v[16:19], v[172:175]
    ds_read_b64_tr_b16 a[230:231], v2 offset:4256
    v_exp_f32 v69, v69
    v_mfma_f32_16x16x32_bf16 v[176:179], a[196:199], v[20:23], v[176:179]
    ds_read_b64_tr_b16 a[232:233], v2 offset:256
    v_cvt_pk_bf16_f32 v28, v64, v65
    v_cvt_pk_bf16_f32 v29, v66, v67
    v_mfma_f32_16x16x32_bf16 v[180:183], a[196:199], v[24:27], v[180:183]
    ds_read_b64_tr_b16 a[234:235], v2 offset:4480
    v_exp_f32 v70, v70
    v_mfma_f32_16x16x32_bf16 v[184:187], a[200:203], v[16:19], v[184:187]
    ds_read_b64_tr_b16 a[236:237], v2 offset:288
    s_add_u32 m0, s26, 67584
    v_exp_f32 v71, v71
    v_exp_f32 v72, v72
    v_mfma_f32_16x16x32_bf16 v[188:191], a[200:203], v[20:23], v[188:191]
    ds_read_b64_tr_b16 a[238:239], v2 offset:4512
    s_add_u32 s27, s63, 1310720
    v_exp_f32 v73, v73
    v_mfma_f32_16x16x32_bf16 v[192:195], a[200:203], v[24:27], v[192:195]
    ds_read_b64_tr_b16 a[240:241], v2 offset:512
    buffer_load_dwordx4 v5, s[8:11], s27 offen lds
    v_cvt_pk_bf16_f32 v30, v68, v69
    v_mfma_f32_16x16x32_bf16 v[196:199], a[204:207], v[16:19], v[196:199]
    ds_read_b64_tr_b16 a[242:243], v2 offset:4736
    v_exp_f32 v74, v74
    v_cvt_pk_bf16_f32 v31, v70, v71
    v_mfma_f32_16x16x32_bf16 v[200:203], a[204:207], v[20:23], v[200:203]
    ds_read_b64_tr_b16 a[244:245], v2 offset:544
    v_exp_f32 v75, v75
    v_mfma_f32_16x16x32_bf16 v[204:207], a[204:207], v[24:27], v[204:207]
    ds_read_b64_tr_b16 a[246:247], v2 offset:4768
    v_exp_f32 v76, v76
    v_exp_f32 v77, v77
    v_mfma_f32_16x16x32_bf16 v[208:211], a[208:211], v[16:19], v[208:211]
    ds_read_b64_tr_b16 a[248:249], v2 offset:768
    v_cvt_pk_bf16_f32 v32, v72, v73
    v_mfma_f32_16x16x32_bf16 v[212:215], a[208:211], v[20:23], v[212:215]
    ds_read_b64_tr_b16 a[250:251], v2 offset:4992
    v_cvt_pk_bf16_f32 v33, v74, v75
    v_exp_f32 v78, v78
    v_mfma_f32_16x16x32_bf16 v[216:219], a[208:211], v[24:27], v[216:219]
    ds_read_b64_tr_b16 a[252:253], v2 offset:800
    v_exp_f32 v79, v79
    v_mfma_f32_16x16x32_bf16 v[220:223], a[212:215], v[16:19], v[220:223]
    ds_read_b64_tr_b16 a[254:255], v2 offset:5024
    v_exp_f32 v80, v80
    v_exp_f32 v81, v81
    v_mfma_f32_16x16x32_bf16 v[224:227], a[212:215], v[20:23], v[224:227]
    v_cvt_pk_bf16_f32 v34, v76, v77
    v_mfma_f32_16x16x32_bf16 v[228:231], a[212:215], v[24:27], v[228:231]
    v_exp_f32 v82, v82
    v_mfma_f32_16x16x32_bf16 v[232:235], a[216:219], v[16:19], v[232:235]
    s_add_u32 m0, s26, 68608
    v_cvt_pk_bf16_f32 v35, v78, v79
    v_exp_f32 v83, v83
    v_mfma_f32_16x16x32_bf16 v[236:239], a[216:219], v[20:23], v[236:239]
    s_add_u32 s27, s63, 1343488
    v_exp_f32 v84, v84
    v_mfma_f32_16x16x32_bf16 v[240:243], a[216:219], v[24:27], v[240:243]
    buffer_load_dwordx4 v5, s[8:11], s27 offen lds
    v_exp_f32 v85, v85
    v_cvt_pk_bf16_f32 v36, v80, v81
    v_mfma_f32_16x16x32_bf16 v[244:247], a[220:223], v[16:19], v[244:247]
    v_cvt_pk_bf16_f32 v37, v82, v83
    v_mfma_f32_16x16x32_bf16 v[248:251], a[220:223], v[20:23], v[248:251]
    v_exp_f32 v86, v86
    v_exp_f32 v87, v87
    v_mfma_f32_16x16x32_bf16 v[252:255], a[220:223], v[24:27], v[252:255]
    v_cvt_pk_bf16_f32 v38, v84, v85
    v_mfma_f32_16x16x32_bf16 v[148:151], v[12:15], v[16:19], v[148:151]
    v_cvt_pk_bf16_f32 v39, v86, v87
    v_mfma_f32_16x16x32_bf16 v[152:155], v[12:15], v[20:23], v[152:155]
    v_mfma_f32_16x16x32_bf16 v[156:159], v[12:15], v[24:27], v[156:159]
    s_waitcnt lgkmcnt(0)
    s_mov_b64 s[40:41], 0
    v_mfma_f32_16x16x32_bf16 v[148:151], v[12:15], v[28:31], v[148:151]
    ds_read_b64_tr_b16 a[192:193], v3 offset:0
    v_mfma_f32_16x16x32_bf16 v[160:163], a[224:227], v[28:31], v[160:163]
    ds_read_b64_tr_b16 a[194:195], v3 offset:1024
    v_mfma_f32_16x16x32_bf16 v[172:175], a[228:231], v[28:31], v[172:175]
    ds_read_b64_tr_b16 a[196:197], v3 offset:8
    v_mfma_f32_16x16x32_bf16 v[184:187], a[232:235], v[28:31], v[184:187]
    ds_read_b64_tr_b16 a[198:199], v3 offset:1032
    v_mfma_f32_16x16x32_bf16 v[196:199], a[236:239], v[28:31], v[196:199]
    ds_read_b64_tr_b16 a[200:201], v3 offset:256
    v_mfma_f32_16x16x32_bf16 v[208:211], a[240:243], v[28:31], v[208:211]
    ds_read_b64_tr_b16 a[202:203], v3 offset:1280
    v_mfma_f32_16x16x32_bf16 v[220:223], a[244:247], v[28:31], v[220:223]
    ds_read_b64_tr_b16 a[204:205], v3 offset:264
    s_add_u32 m0, s26, 59136
    v_mfma_f32_16x16x32_bf16 v[232:235], a[248:251], v[28:31], v[232:235]
    ds_read_b64_tr_b16 a[206:207], v3 offset:1288
    s_add_u32 s27, s63, 1572864
    v_mfma_f32_16x16x32_bf16 v[244:247], a[252:255], v[28:31], v[244:247]
    ds_read_b64_tr_b16 a[208:209], v3 offset:512
    buffer_load_dwordx4 v5, s[8:11], s27 offen lds
    v_mfma_f32_16x16x32_bf16 v[152:155], v[12:15], v[32:35], v[152:155]
    ds_read_b64_tr_b16 a[210:211], v3 offset:1536
    v_mfma_f32_16x16x32_bf16 v[164:167], a[224:227], v[32:35], v[164:167]
    ds_read_b64_tr_b16 a[212:213], v3 offset:520
    v_mfma_f32_16x16x32_bf16 v[176:179], a[228:231], v[32:35], v[176:179]
    ds_read_b64_tr_b16 a[214:215], v3 offset:1544
    v_rcp_f32 v8, v148
    v_cmp_nge_f32 vcc, 0x53800000, v148
    s_nop 3
    s_or_b64 s[40:41], s[40:41], vcc
    v_pk_mul_f32 v[160:161], v[160:161], v[8:9] op_sel_hi:[1,0]
    v_pk_mul_f32 v[162:163], v[162:163], v[8:9] op_sel_hi:[1,0]
    v_mfma_f32_16x16x32_bf16 v[188:191], a[232:235], v[32:35], v[188:191]
    ds_read_b64_tr_b16 a[216:217], v3 offset:768
    v_pk_mul_f32 v[172:173], v[172:173], v[8:9] op_sel_hi:[1,0]
    v_pk_mul_f32 v[174:175], v[174:175], v[8:9] op_sel_hi:[1,0]
    v_cvt_pk_bf16_f32 v40, v160, v161
    v_cvt_pk_bf16_f32 v41, v162, v163
    v_cvt_pk_bf16_f32 v42, v172, v173
    v_mfma_f32_16x16x32_bf16 v[200:203], a[236:239], v[32:35], v[200:203]
    ds_read_b64_tr_b16 a[218:219], v3 offset:1792
    v_cvt_pk_bf16_f32 v43, v174, v175
    buffer_store_dwordx4 v[40:43], v6, s[20:23], s52 offen offset:0
    v_pk_mul_f32 v[184:185], v[184:185], v[8:9] op_sel_hi:[1,0]
    v_pk_mul_f32 v[186:187], v[186:187], v[8:9] op_sel_hi:[1,0]
    v_pk_mul_f32 v[196:197], v[196:197], v[8:9] op_sel_hi:[1,0]
    v_mfma_f32_16x16x32_bf16 v[212:215], a[240:243], v[32:35], v[212:215]
    ds_read_b64_tr_b16 a[220:221], v3 offset:776
    v_pk_mul_f32 v[198:199], v[198:199], v[8:9] op_sel_hi:[1,0]
    v_cvt_pk_bf16_f32 v44, v184, v185
    v_cvt_pk_bf16_f32 v45, v186, v187
    v_cvt_pk_bf16_f32 v46, v196, v197
    v_cvt_pk_bf16_f32 v47, v198, v199
    v_mfma_f32_16x16x32_bf16 v[224:227], a[244:247], v[32:35], v[224:227]
    ds_read_b64_tr_b16 a[222:223], v3 offset:1800
    buffer_store_dwordx4 v[44:47], v6, s[20:23], s52 offen offset:1024
    v_pk_mul_f32 v[208:209], v[208:209], v[8:9] op_sel_hi:[1,0]
    v_pk_mul_f32 v[210:211], v[210:211], v[8:9] op_sel_hi:[1,0]
    v_pk_mul_f32 v[220:221], v[220:221], v[8:9] op_sel_hi:[1,0]
    v_pk_mul_f32 v[222:223], v[222:223], v[8:9] op_sel_hi:[1,0]
    v_mfma_f32_16x16x32_bf16 v[236:239], a[248:251], v[32:35], v[236:239]
    v_cvt_pk_bf16_f32 v48, v208, v209
    v_cvt_pk_bf16_f32 v49, v210, v211
    v_cvt_pk_bf16_f32 v50, v220, v221
    v_cvt_pk_bf16_f32 v51, v222, v223
    buffer_store_dwordx4 v[48:51], v6, s[20:23], s52 offen offset:2048
    v_mfma_f32_16x16x32_bf16 v[248:251], a[252:255], v[32:35], v[248:251]
    v_pk_mul_f32 v[232:233], v[232:233], v[8:9] op_sel_hi:[1,0]
    v_pk_mul_f32 v[234:235], v[234:235], v[8:9] op_sel_hi:[1,0]
    v_pk_mul_f32 v[244:245], v[244:245], v[8:9] op_sel_hi:[1,0]
    v_pk_mul_f32 v[246:247], v[246:247], v[8:9] op_sel_hi:[1,0]
    v_cvt_pk_bf16_f32 v52, v232, v233
    v_mfma_f32_16x16x32_bf16 v[156:159], v[12:15], v[36:39], v[156:159]
    s_add_u32 m0, s26, 60160
    v_cvt_pk_bf16_f32 v53, v234, v235
    v_cvt_pk_bf16_f32 v54, v244, v245
    v_cvt_pk_bf16_f32 v55, v246, v247
    buffer_store_dwordx4 v[52:55], v6, s[20:23], s52 offen offset:3072
    v_mfma_f32_16x16x32_bf16 v[168:171], a[224:227], v[36:39], v[168:171]
    s_add_u32 s27, s63, 1605632
    v_mfma_f32_16x16x32_bf16 v[180:183], a[228:231], v[36:39], v[180:183]
    buffer_load_dwordx4 v5, s[8:11], s27 offen lds
    v_rcp_f32 v10, v152
    v_cmp_nge_f32 vcc, 0x53800000, v152
    s_nop 3
    s_or_b64 s[40:41], s[40:41], vcc
    v_pk_mul_f32 v[164:165], v[164:165], v[10:11] op_sel_hi:[1,0]
    v_pk_mul_f32 v[166:167], v[166:167], v[10:11] op_sel_hi:[1,0]
    v_pk_mul_f32 v[176:177], v[176:177], v[10:11] op_sel_hi:[1,0]
    v_mfma_f32_16x16x32_bf16 v[192:195], a[232:235], v[36:39], v[192:195]
    v_pk_mul_f32 v[178:179], v[178:179], v[10:11] op_sel_hi:[1,0]
    v_cvt_pk_bf16_f32 v56, v164, v165
    v_cvt_pk_bf16_f32 v57, v166, v167
    v_cvt_pk_bf16_f32 v58, v176, v177
    v_cvt_pk_bf16_f32 v59, v178, v179
    buffer_store_dwordx4 v[56:59], v6, s[20:23], s53 offen offset:0
    v_mfma_f32_16x16x32_bf16 v[204:207], a[236:239], v[36:39], v[204:207]
    v_pk_mul_f32 v[188:189], v[188:189], v[10:11] op_sel_hi:[1,0]
    v_pk_mul_f32 v[190:191], v[190:191], v[10:11] op_sel_hi:[1,0]
    v_pk_mul_f32 v[200:201], v[200:201], v[10:11] op_sel_hi:[1,0]
    v_pk_mul_f32 v[202:203], v[202:203], v[10:11] op_sel_hi:[1,0]
    v_cvt_pk_bf16_f32 v60, v188, v189
    v_mfma_f32_16x16x32_bf16 v[216:219], a[240:243], v[36:39], v[216:219]
    v_cvt_pk_bf16_f32 v61, v190, v191
    v_cvt_pk_bf16_f32 v62, v200, v201
    v_cvt_pk_bf16_f32 v63, v202, v203
    buffer_store_dwordx4 v[60:63], v6, s[20:23], s53 offen offset:1024
    v_pk_mul_f32 v[212:213], v[212:213], v[10:11] op_sel_hi:[1,0]
    v_pk_mul_f32 v[214:215], v[214:215], v[10:11] op_sel_hi:[1,0]
    v_mfma_f32_16x16x32_bf16 v[228:231], a[244:247], v[36:39], v[228:231]
    v_pk_mul_f32 v[224:225], v[224:225], v[10:11] op_sel_hi:[1,0]
    v_pk_mul_f32 v[226:227], v[226:227], v[10:11] op_sel_hi:[1,0]
    v_cvt_pk_bf16_f32 v64, v212, v213
    v_cvt_pk_bf16_f32 v65, v214, v215
    v_cvt_pk_bf16_f32 v66, v224, v225
    v_mfma_f32_16x16x32_bf16 v[240:243], a[248:251], v[36:39], v[240:243]
    v_cvt_pk_bf16_f32 v67, v226, v227
    buffer_store_dwordx4 v[64:67], v6, s[20:23], s53 offen offset:2048
    v_pk_mul_f32 v[236:237], v[236:237], v[10:11] op_sel_hi:[1,0]
    v_pk_mul_f32 v[238:239], v[238:239], v[10:11] op_sel_hi:[1,0]
    v_pk_mul_f32 v[248:249], v[248:249], v[10:11] op_sel_hi:[1,0]
    v_pk_mul_f32 v[250:251], v[250:251], v[10:11] op_sel_hi:[1,0]
    v_mfma_f32_16x16x32_bf16 v[252:255], a[252:255], v[36:39], v[252:255]
    v_cvt_pk_bf16_f32 v68, v236, v237
    v_cvt_pk_bf16_f32 v69, v238, v239
    v_cvt_pk_bf16_f32 v70, v248, v249
    v_cvt_pk_bf16_f32 v71, v250, v251
    buffer_store_dwordx4 v[68:71], v6, s[20:23], s53 offen offset:3072
    v_rcp_f32 v28, v156
    v_cmp_nge_f32 vcc, 0x53800000, v156
    s_nop 3
    s_or_b64 s[40:41], s[40:41], vcc
    v_pk_mul_f32 v[168:169], v[168:169], v[28:29] op_sel_hi:[1,0]
    v_pk_mul_f32 v[170:171], v[170:171], v[28:29] op_sel_hi:[1,0]
    v_pk_mul_f32 v[180:181], v[180:181], v[28:29] op_sel_hi:[1,0]
    v_pk_mul_f32 v[182:183], v[182:183], v[28:29] op_sel_hi:[1,0]
    v_cvt_pk_bf16_f32 v72, v168, v169
    v_cvt_pk_bf16_f32 v73, v170, v171
    v_cvt_pk_bf16_f32 v74, v180, v181
    v_cvt_pk_bf16_f32 v75, v182, v183
    buffer_store_dwordx4 v[72:75], v6, s[20:23], s54 offen offset:0
    v_pk_mul_f32 v[192:193], v[192:193], v[28:29] op_sel_hi:[1,0]
    v_pk_mul_f32 v[194:195], v[194:195], v[28:29] op_sel_hi:[1,0]
    v_pk_mul_f32 v[204:205], v[204:205], v[28:29] op_sel_hi:[1,0]
    v_pk_mul_f32 v[206:207], v[206:207], v[28:29] op_sel_hi:[1,0]
    v_cvt_pk_bf16_f32 v76, v192, v193
    v_cvt_pk_bf16_f32 v77, v194, v195
    v_cvt_pk_bf16_f32 v78, v204, v205
    v_cvt_pk_bf16_f32 v79, v206, v207
    buffer_store_dwordx4 v[76:79], v6, s[20:23], s54 offen offset:1024
    v_pk_mul_f32 v[216:217], v[216:217], v[28:29] op_sel_hi:[1,0]
    v_pk_mul_f32 v[218:219], v[218:219], v[28:29] op_sel_hi:[1,0]
    v_pk_mul_f32 v[228:229], v[228:229], v[28:29] op_sel_hi:[1,0]
    v_pk_mul_f32 v[230:231], v[230:231], v[28:29] op_sel_hi:[1,0]
    v_cvt_pk_bf16_f32 v80, v216, v217
    v_cvt_pk_bf16_f32 v81, v218, v219
    v_cvt_pk_bf16_f32 v82, v228, v229
    v_cvt_pk_bf16_f32 v83, v230, v231
    buffer_store_dwordx4 v[80:83], v6, s[20:23], s54 offen offset:2048
    v_pk_mul_f32 v[240:241], v[240:241], v[28:29] op_sel_hi:[1,0]
    v_pk_mul_f32 v[242:243], v[242:243], v[28:29] op_sel_hi:[1,0]
    v_pk_mul_f32 v[252:253], v[252:253], v[28:29] op_sel_hi:[1,0]
    v_pk_mul_f32 v[254:255], v[254:255], v[28:29] op_sel_hi:[1,0]
    v_cvt_pk_bf16_f32 v84, v240, v241
    v_cvt_pk_bf16_f32 v85, v242, v243
    v_cvt_pk_bf16_f32 v86, v252, v253
    v_cvt_pk_bf16_f32 v87, v254, v255
    buffer_store_dwordx4 v[84:87], v6, s[20:23], s54 offen offset:3072
    s_cmp_eq_u64 s[40:41], 0
    s_cbranch_scc1 A_NOBAD
    s_lshl_b32 s42, s30, 2
    s_add_u32 s42, s42, 159744
    v_mov_b32 v7, 1
    v_mov_b32 v8, s42
    ds_write_b32 v8, v7
A_NOBAD:
    s_waitcnt lgkmcnt(0)
    s_waitcnt vmcnt(24)
    s_barrier
    s_lshl_b32 s42, s30, 2
    s_add_u32 s42, s42, 159744
    v_mov_b32 v8, s42
    ds_read_b32 v7, v8
    s_waitcnt lgkmcnt(0)
    v_readfirstlane_b32 s42, v7
    s_nop 3
    s_cmp_lg_u32 s42, 0
    s_cbranch_scc1 A_SLOW
A_RESUME:
    s_add_u32 s30, s30, 1
    s_cmp_eq_u32 s30, 4
    s_cbranch_scc1 A_DONE
    v_mfma_f32_16x16x32_bf16 v[160:163], a[192:195], a[0:3], 0
    v_add_u32 v3, 0xffffdf00, v3
    v_mfma_f32_16x16x32_bf16 v[164:167], a[192:195], a[4:7], 0
    ds_read_b64_tr_b16 a[224:225], v3 offset:0
    v_mfma_f32_16x16x32_bf16 v[168:171], a[192:195], a[8:11], 0
    ds_read_b64_tr_b16 a[226:227], v3 offset:1024
    v_mfma_f32_16x16x32_bf16 v[172:175], a[196:199], a[0:3], 0
    ds_read_b64_tr_b16 a[228:229], v3 offset:8
    v_mfma_f32_16x16x32_bf16 v[176:179], a[196:199], a[4:7], 0
    ds_read_b64_tr_b16 a[230:231], v3 offset:1032
    v_mfma_f32_16x16x32_bf16 v[180:183], a[196:199], a[8:11], 0
    ds_read_b64_tr_b16 a[232:233], v3 offset:256
    v_mfma_f32_16x16x32_bf16 v[184:187], a[200:203], a[0:3], 0
    ds_read_b64_tr_b16 a[234:235], v3 offset:1280
    s_add_u32 m0, s26, 126720
    v_mfma_f32_16x16x32_bf16 v[188:191], a[200:203], a[4:7], 0
    ds_read_b64_tr_b16 a[236:237], v3 offset:264
    s_add_u32 s27, s63, 1835008
    v_mfma_f32_16x16x32_bf16 v[192:195], a[200:203], a[8:11], 0
    ds_read_b64_tr_b16 a[238:239], v3 offset:1288
    buffer_load_dwordx4 v5, s[8:11], s27 offen lds
    v_mfma_f32_16x16x32_bf16 v[196:199], a[204:207], a[0:3], 0
    ds_read_b64_tr_b16 a[240:241], v3 offset:512
    v_mfma_f32_16x16x32_bf16 v[200:203], a[204:207], a[4:7], 0
    ds_read_b64_tr_b16 a[242:243], v3 offset:1536
    v_mfma_f32_16x16x32_bf16 v[204:207], a[204:207], a[8:11], 0
    ds_read_b64_tr_b16 a[244:245], v3 offset:520
    v_mfma_f32_16x16x32_bf16 v[208:211], a[208:211], a[0:3], 0
    ds_read_b64_tr_b16 a[246:247], v3 offset:1544
    v_mfma_f32_16x16x32_bf16 v[212:215], a[208:211], a[4:7], 0
    ds_read_b64_tr_b16 a[248:249], v3 offset:768
    v_mfma_f32_16x16x32_bf16 v[216:219], a[208:211], a[8:11], 0
    ds_read_b64_tr_b16 a[250:251], v3 offset:1792
    v_mfma_f32_16x16x32_bf16 v[220:223], a[212:215], a[0:3], 0
    ds_read_b64_tr_b16 a[252:253], v3 offset:776
    v_mfma_f32_16x16x32_bf16 v[224:227], a[212:215], a[4:7], 0
    ds_read_b64_tr_b16 a[254:255], v3 offset:1800
    s_add_u32 m0, s26, 127744
    v_mfma_f32_16x16x32_bf16 v[228:231], a[212:215], a[8:11], 0
    s_add_u32 s27, s63, 1867776
    v_mfma_f32_16x16x32_bf16 v[232:235], a[216:219], a[0:3], 0
    buffer_load_dwordx4 v5, s[8:11], s27 offen lds
    v_mfma_f32_16x16x32_bf16 v[236:239], a[216:219], a[4:7], 0
    v_mfma_f32_16x16x32_bf16 v[240:243], a[216:219], a[8:11], 0
    v_mfma_f32_16x16x32_bf16 v[244:247], a[220:223], a[0:3], 0
    v_mfma_f32_16x16x32_bf16 v[248:251], a[220:223], a[4:7], 0
    v_mfma_f32_16x16x32_bf16 v[252:255], a[220:223], a[8:11], 0
    s_waitcnt lgkmcnt(0)
    v_mfma_f32_16x16x32_bf16 v[160:163], a[224:227], a[12:15], v[160:163]
    v_add_u32 v3, 0xffffdf00, v3
    v_mfma_f32_16x16x32_bf16 v[164:167], a[224:227], a[16:19], v[164:167]
    ds_read_b64_tr_b16 a[192:193], v3 offset:0
    v_mfma_f32_16x16x32_bf16 v[168:171], a[224:227], a[20:23], v[168:171]
    ds_read_b64_tr_b16 a[194:195], v3 offset:1024
    v_mfma_f32_16x16x32_bf16 v[172:175], a[228:231], a[12:15], v[172:175]
    ds_read_b64_tr_b16 a[196:197], v3 offset:8
    v_mfma_f32_16x16x32_bf16 v[176:179], a[228:231], a[16:19], v[176:179]
    ds_read_b64_tr_b16 a[198:199], v3 offset:1032
    v_mfma_f32_16x16x32_bf16 v[180:183], a[228:231], a[20:23], v[180:183]
    ds_read_b64_tr_b16 a[200:201], v3 offset:256
    v_mfma_f32_16x16x32_bf16 v[184:187], a[232:235], a[12:15], v[184:187]
    ds_read_b64_tr_b16 a[202:203], v3 offset:1280
    s_add_u32 m0, s26, 50688
    v_mfma_f32_16x16x32_bf16 v[188:191], a[232:235], a[16:19], v[188:191]
    ds_read_b64_tr_b16 a[204:205], v3 offset:264
    s_add_u32 s27, s63, 2097152
    v_mfma_f32_16x16x32_bf16 v[192:195], a[232:235], a[20:23], v[192:195]
    ds_read_b64_tr_b16 a[206:207], v3 offset:1288
    buffer_load_dwordx4 v5, s[8:11], s27 offen lds
    v_mfma_f32_16x16x32_bf16 v[196:199], a[236:239], a[12:15], v[196:199]
    ds_read_b64_tr_b16 a[208:209], v3 offset:512
    v_mfma_f32_16x16x32_bf16 v[200:203], a[236:239], a[16:19], v[200:203]
    ds_read_b64_tr_b16 a[210:211], v3 offset:1536
    v_mfma_f32_16x16x32_bf16 v[204:207], a[236:239], a[20:23], v[204:207]
    ds_read_b64_tr_b16 a[212:213], v3 offset:520
    v_mfma_f32_16x16x32_bf16 v[208:211], a[240:243], a[12:15], v[208:211]
    ds_read_b64_tr_b16 a[214:215], v3 offset:1544
    v_mfma_f32_16x16x32_bf16 v[212:215], a[240:243], a[16:19], v[212:215]
    ds_read_b64_tr_b16 a[216:217], v3 offset:768
    v_mfma_f32_16x16x32_bf16 v[216:219], a[240:243], a[20:23], v[216:219]
    ds_read_b64_tr_b16 a[218:219], v3 offset:1792
    v_mfma_f32_16x16x32_bf16 v[220:223], a[244:247], a[12:15], v[220:223]
    ds_read_b64_tr_b16 a[220:221], v3 offset:776
    v_mfma_f32_16x16x32_bf16 v[224:227], a[244:247], a[16:19], v[224:227]
    ds_read_b64_tr_b16 a[222:223], v3 offset:1800
    s_add_u32 m0, s26, 51712
    v_mfma_f32_16x16x32_bf16 v[228:231], a[244:247], a[20:23], v[228:231]
    s_add_u32 s27, s63, 2129920
    v_mfma_f32_16x16x32_bf16 v[232:235], a[248:251], a[12:15], v[232:235]
    buffer_load_dwordx4 v5, s[8:11], s27 offen lds
    v_mfma_f32_16x16x32_bf16 v[236:239], a[248:251], a[16:19], v[236:239]
    v_mfma_f32_16x16x32_bf16 v[240:243], a[248:251], a[20:23], v[240:243]
    v_mfma_f32_16x16x32_bf16 v[244:247], a[252:255], a[12:15], v[244:247]
    v_mfma_f32_16x16x32_bf16 v[248:251], a[252:255], a[16:19], v[248:251]
    v_mfma_f32_16x16x32_bf16 v[252:255], a[252:255], a[20:23], v[252:255]
    s_waitcnt lgkmcnt(0)
    s_waitcnt vmcnt(24)
    s_barrier
    v_mfma_f32_16x16x32_bf16 v[160:163], a[192:195], a[24:27], v[160:163]
    v_add_u32 v3, 0xffffdf00, v3
    v_mfma_f32_16x16x32_bf16 v[164:167], a[192:195], a[28:31], v[164:167]
    ds_read_b64_tr_b16 a[224:225], v3 offset:0
    v_mfma_f32_16x16x32_bf16 v[168:171], a[192:195], a[32:35], v[168:171]
    ds_read_b64_tr_b16 a[226:227], v3 offset:1024
    v_mfma_f32_16x16x32_bf16 v[172:175], a[196:199], a[24:27], v[172:175]
    ds_read_b64_tr_b16 a[228:229], v3 offset:8
    v_mfma_f32_16x16x32_bf16 v[176:179], a[196:199], a[28:31], v[176:179]
    ds_read_b64_tr_b16 a[230:231], v3 offset:1032
    v_mfma_f32_16x16x32_bf16 v[180:183], a[196:199], a[32:35], v[180:183]
    ds_read_b64_tr_b16 a[232:233], v3 offset:256
    v_mfma_f32_16x16x32_bf16 v[184:187], a[200:203], a[24:27], v[184:187]
    ds_read_b64_tr_b16 a[234:235], v3 offset:1280
    s_add_u32 m0, s26, 118272
    v_mfma_f32_16x16x32_bf16 v[188:191], a[200:203], a[28:31], v[188:191]
    ds_read_b64_tr_b16 a[236:237], v3 offset:264
    s_add_u32 s27, s63, 2359296
    v_mfma_f32_16x16x32_bf16 v[192:195], a[200:203], a[32:35], v[192:195]
    ds_read_b64_tr_b16 a[238:239], v3 offset:1288
    buffer_load_dwordx4 v5, s[8:11], s27 offen lds
    v_mfma_f32_16x16x32_bf16 v[196:199], a[204:207], a[24:27], v[196:199]
    ds_read_b64_tr_b16 a[240:241], v3 offset:512
    v_mfma_f32_16x16x32_bf16 v[200:203], a[204:207], a[28:31], v[200:203]
    ds_read_b64_tr_b16 a[242:243], v3 offset:1536
    v_mfma_f32_16x16x32_bf16 v[204:207], a[204:207], a[32:35], v[204:207]
    ds_read_b64_tr_b16 a[244:245], v3 offset:520
    v_mfma_f32_16x16x32_bf16 v[208:211], a[208:211], a[24:27], v[208:211]
    ds_read_b64_tr_b16 a[246:247], v3 offset:1544
    v_mfma_f32_16x16x32_bf16 v[212:215], a[208:211], a[28:31], v[212:215]
    ds_read_b64_tr_b16 a[248:249], v3 offset:768
    v_mfma_f32_16x16x32_bf16 v[216:219], a[208:211], a[32:35], v[216:219]
    ds_read_b64_tr_b16 a[250:251], v3 offset:1792
    v_mfma_f32_16x16x32_bf16 v[220:223], a[212:215], a[24:27], v[220:223]
    ds_read_b64_tr_b16 a[252:253], v3 offset:776
    v_mfma_f32_16x16x32_bf16 v[224:227], a[212:215], a[28:31], v[224:227]
    ds_read_b64_tr_b16 a[254:255], v3 offset:1800
    s_add_u32 m0, s26, 119296
    v_mfma_f32_16x16x32_bf16 v[228:231], a[212:215], a[32:35], v[228:231]
    s_add_u32 s27, s63, 2392064
    v_mfma_f32_16x16x32_bf16 v[232:235], a[216:219], a[24:27], v[232:235]
    buffer_load_dwordx4 v5, s[8:11], s27 offen lds
    v_mfma_f32_16x16x32_bf16 v[236:239], a[216:219], a[28:31], v[236:239]
    v_mfma_f32_16x16x32_bf16 v[240:243], a[216:219], a[32:35], v[240:243]
    v_mfma_f32_16x16x32_bf16 v[244:247], a[220:223], a[24:27], v[244:247]
    v_mfma_f32_16x16x32_bf16 v[248:251], a[220:223], a[28:31], v[248:251]
    v_mfma_f32_16x16x32_bf16 v[252:255], a[220:223], a[32:35], v[252:255]
    s_waitcnt lgkmcnt(0)
    v_mfma_f32_16x16x32_bf16 v[160:163], a[224:227], a[36:39], v[160:163]
    v_add_u32 v3, 0xffffdf00, v3
    v_mfma_f32_16x16x32_bf16 v[164:167], a[224:227], a[40:43], v[164:167]
    ds_read_b64_tr_b16 a[192:193], v3 offset:0
    v_mfma_f32_16x16x32_bf16 v[168:171], a[224:227], a[44:47], v[168:171]
    ds_read_b64_tr_b16 a[194:195], v3 offset:1024
    v_mfma_f32_16x16x32_bf16 v[172:175], a[228:231], a[36:39], v[172:175]
    ds_read_b64_tr_b16 a[196:197], v3 offset:8
    v_mfma_f32_16x16x32_bf16 v[176:179], a[228:231], a[40:43], v[176:179]
    ds_read_b64_tr_b16 a[198:199], v3 offset:1032
    v_mfma_f32_16x16x32_bf16 v[180:183], a[228:231], a[44:47], v[180:183]
    ds_read_b64_tr_b16 a[200:201], v3 offset:256
    v_mfma_f32_16x16x32_bf16 v[184:187], a[232:235], a[36:39], v[184:187]
    ds_read_b64_tr_b16 a[202:203], v3 offset:1280
    s_add_u32 m0, s26, 109824
    v_mfma_f32_16x16x32_bf16 v[188:191], a[232:235], a[40:43], v[188:191]
    ds_read_b64_tr_b16 a[204:205], v3 offset:264
    s_add_u32 s27, s63, 2621440
    v_mfma_f32_16x16x32_bf16 v[192:195], a[232:235], a[44:47], v[192:195]
    ds_read_b64_tr_b16 a[206:207], v3 offset:1288
    buffer_load_dwordx4 v5, s[8:11], s27 offen lds
    v_mfma_f32_16x16x32_bf16 v[196:199], a[236:239], a[36:39], v[196:199]
    ds_read_b64_tr_b16 a[208:209], v3 offset:512
    v_mfma_f32_16x16x32_bf16 v[200:203], a[236:239], a[40:43], v[200:203]
    ds_read_b64_tr_b16 a[210:211], v3 offset:1536
    v_mfma_f32_16x16x32_bf16 v[204:207], a[236:239], a[44:47], v[204:207]
    ds_read_b64_tr_b16 a[212:213], v3 offset:520
    v_mfma_f32_16x16x32_bf16 v[208:211], a[240:243], a[36:39], v[208:211]
    ds_read_b64_tr_b16 a[214:215], v3 offset:1544
    v_mfma_f32_16x16x32_bf16 v[212:215], a[240:243], a[40:43], v[212:215]
    ds_read_b64_tr_b16 a[216:217], v3 offset:768
    v_mfma_f32_16x16x32_bf16 v[216:219], a[240:243], a[44:47], v[216:219]
    ds_read_b64_tr_b16 a[218:219], v3 offset:1792
    v_mfma_f32_16x16x32_bf16 v[220:223], a[244:247], a[36:39], v[220:223]
    ds_read_b64_tr_b16 a[220:221], v3 offset:776
    v_mfma_f32_16x16x32_bf16 v[224:227], a[244:247], a[40:43], v[224:227]
    ds_read_b64_tr_b16 a[222:223], v3 offset:1800
    s_add_u32 m0, s26, 110848
    v_mfma_f32_16x16x32_bf16 v[228:231], a[244:247], a[44:47], v[228:231]
    s_add_u32 s27, s63, 2654208
    v_mfma_f32_16x16x32_bf16 v[232:235], a[248:251], a[36:39], v[232:235]
    buffer_load_dwordx4 v5, s[8:11], s27 offen lds
    v_mfma_f32_16x16x32_bf16 v[236:239], a[248:251], a[40:43], v[236:239]
    v_mfma_f32_16x16x32_bf16 v[240:243], a[248:251], a[44:47], v[240:243]
    v_mfma_f32_16x16x32_bf16 v[244:247], a[252:255], a[36:39], v[244:247]
    v_mfma_f32_16x16x32_bf16 v[248:251], a[252:255], a[40:43], v[248:251]
    v_mfma_f32_16x16x32_bf16 v[252:255], a[252:255], a[44:47], v[252:255]
    s_waitcnt lgkmcnt(0)
    s_waitcnt vmcnt(16)
    s_barrier
    v_mfma_f32_16x16x32_bf16 v[160:163], a[192:195], a[48:51], v[160:163]
    v_add_u32 v3, 0xffff9d00, v3
    v_mfma_f32_16x16x32_bf16 v[164:167], a[192:195], a[52:55], v[164:167]
    ds_read_b64_tr_b16 a[224:225], v3 offset:0
    v_mfma_f32_16x16x32_bf16 v[168:171], a[192:195], a[56:59], v[168:171]
    ds_read_b64_tr_b16 a[226:227], v3 offset:1024
    v_mfma_f32_16x16x32_bf16 v[172:175], a[196:199], a[48:51], v[172:175]
    ds_read_b64_tr_b16 a[228:229], v3 offset:8
    s_add_u32 m0, s26, 101376
    v_mfma_f32_16x16x32_bf16 v[176:179], a[196:199], a[52:55], v[176:179]
    ds_read_b64_tr_b16 a[230:231], v3 offset:1032
    s_add_u32 s27, s63, 2883584
    v_mfma_f32_16x16x32_bf16 v[180:183], a[196:199], a[56:59], v[180:183]
    ds_read_b64_tr_b16 a[232:233], v3 offset:256
    buffer_load_dwordx4 v5, s[8:11], s27 offen lds
    v_mfma_f32_16x16x32_bf16 v[184:187], a[200:203], a[48:51], v[184:187]
    ds_read_b64_tr_b16 a[234:235], v3 offset:1280
    v_mfma_f32_16x16x32_bf16 v[188:191], a[200:203], a[52:55], v[188:191]
    ds_read_b64_tr_b16 a[236:237], v3 offset:264
    v_mfma_f32_16x16x32_bf16 v[192:195], a[200:203], a[56:59], v[192:195]
    ds_read_b64_tr_b16 a[238:239], v3 offset:1288
    s_add_u32 m0, s26, 102400
    v_mfma_f32_16x16x32_bf16 v[196:199], a[204:207], a[48:51], v[196:199]
    ds_read_b64_tr_b16 a[240:241], v3 offset:512
    s_add_u32 s27, s63, 2916352
    v_mfma_f32_16x16x32_bf16 v[200:203], a[204:207], a[52:55], v[200:203]
    ds_read_b64_tr_b16 a[242:243], v3 offset:1536
    buffer_load_dwordx4 v5, s[8:11], s27 offen lds
    v_mfma_f32_16x16x32_bf16 v[204:207], a[204:207], a[56:59], v[204:207]
    ds_read_b64_tr_b16 a[244:245], v3 offset:520
    v_mfma_f32_16x16x32_bf16 v[208:211], a[208:211], a[48:51], v[208:211]
    ds_read_b64_tr_b16 a[246:247], v3 offset:1544
    v_mfma_f32_16x16x32_bf16 v[212:215], a[208:211], a[52:55], v[212:215]
    ds_read_b64_tr_b16 a[248:249], v3 offset:768
    s_add_u32 m0, s26, 92928
    v_mfma_f32_16x16x32_bf16 v[216:219], a[208:211], a[56:59], v[216:219]
    ds_read_b64_tr_b16 a[250:251], v3 offset:1792
    s_add_u32 s27, s63, 3145728
    v_mfma_f32_16x16x32_bf16 v[220:223], a[212:215], a[48:51], v[220:223]
    ds_read_b64_tr_b16 a[252:253], v3 offset:776
    buffer_load_dwordx4 v5, s[8:11], s27 offen lds
    v_mfma_f32_16x16x32_bf16 v[224:227], a[212:215], a[52:55], v[224:227]
    ds_read_b64_tr_b16 a[254:255], v3 offset:1800
    v_mfma_f32_16x16x32_bf16 v[228:231], a[212:215], a[56:59], v[228:231]
    v_mfma_f32_16x16x32_bf16 v[232:235], a[216:219], a[48:51], v[232:235]
    s_add_u32 m0, s26, 93952
    v_mfma_f32_16x16x32_bf16 v[236:239], a[216:219], a[52:55], v[236:239]
    s_add_u32 s27, s63, 3178496
    v_mfma_f32_16x16x32_bf16 v[240:243], a[216:219], a[56:59], v[240:243]
    buffer_load_dwordx4 v5, s[8:11], s27 offen lds
    v_mfma_f32_16x16x32_bf16 v[244:247], a[220:223], a[48:51], v[244:247]
    v_mfma_f32_16x16x32_bf16 v[248:251], a[220:223], a[52:55], v[248:251]
    v_mfma_f32_16x16x32_bf16 v[252:255], a[220:223], a[56:59], v[252:255]
    s_waitcnt lgkmcnt(0)
    v_mfma_f32_16x16x32_bf16 v[160:163], a[224:227], a[60:63], v[160:163]
    v_add_u32 v3, 0xffffdf00, v3
    v_mfma_f32_16x16x32_bf16 v[164:167], a[224:227], a[64:67], v[164:167]
    ds_read_b64_tr_b16 a[192:193], v3 offset:0
    v_mfma_f32_16x16x32_bf16 v[168:171], a[224:227], a[68:71], v[168:171]
    ds_read_b64_tr_b16 a[194:195], v3 offset:1024
    v_mfma_f32_16x16x32_bf16 v[172:175], a[228:231], a[60:63], v[172:175]
    ds_read_b64_tr_b16 a[196:197], v3 offset:8
    v_mfma_f32_16x16x32_bf16 v[176:179], a[228:231], a[64:67], v[176:179]
    ds_read_b64_tr_b16 a[198:199], v3 offset:1032
    v_mfma_f32_16x16x32_bf16 v[180:183], a[228:231], a[68:71], v[180:183]
    ds_read_b64_tr_b16 a[200:201], v3 offset:256
    v_mfma_f32_16x16x32_bf16 v[184:187], a[232:235], a[60:63], v[184:187]
    ds_read_b64_tr_b16 a[202:203], v3 offset:1280
    s_add_u32 m0, s25, 42240
    v_mfma_f32_16x16x32_bf16 v[188:191], a[232:235], a[64:67], v[188:191]
    ds_read_b64_tr_b16 a[204:205], v3 offset:264
    s_add_u32 s27, s62, 16384
    v_mfma_f32_16x16x32_bf16 v[192:195], a[232:235], a[68:71], v[192:195]
    ds_read_b64_tr_b16 a[206:207], v3 offset:1288
    buffer_load_dwordx4 v4, s[12:15], s27 offen nt lds
    v_mfma_f32_16x16x32_bf16 v[196:199], a[236:239], a[60:63], v[196:199]
    ds_read_b64_tr_b16 a[208:209], v3 offset:512
    v_mfma_f32_16x16x32_bf16 v[200:203], a[236:239], a[64:67], v[200:203]
    ds_read_b64_tr_b16 a[210:211], v3 offset:1536
    v_mfma_f32_16x16x32_bf16 v[204:207], a[236:239], a[68:71], v[204:207]
    ds_read_b64_tr_b16 a[212:213], v3 offset:520
    v_mfma_f32_16x16x32_bf16 v[208:211], a[240:243], a[60:63], v[208:211]
    ds_read_b64_tr_b16 a[214:215], v3 offset:1544
    v_mfma_f32_16x16x32_bf16 v[212:215], a[240:243], a[64:67], v[212:215]
    ds_read_b64_tr_b16 a[216:217], v3 offset:768
    v_mfma_f32_16x16x32_bf16 v[216:219], a[240:243], a[68:71], v[216:219]
    ds_read_b64_tr_b16 a[218:219], v3 offset:1792
    v_mfma_f32_16x16x32_bf16 v[220:223], a[244:247], a[60:63], v[220:223]
    ds_read_b64_tr_b16 a[220:221], v3 offset:776
    v_mfma_f32_16x16x32_bf16 v[224:227], a[244:247], a[64:67], v[224:227]
    ds_read_b64_tr_b16 a[222:223], v3 offset:1800
    v_mfma_f32_16x16x32_bf16 v[228:231], a[244:247], a[68:71], v[228:231]
    s_add_u32 m0, s25, 42272
    v_mfma_f32_16x16x32_bf16 v[232:235], a[248:251], a[60:63], v[232:235]
    buffer_load_dwordx4 v4, s[12:15], s27 offen offset:1024 nt lds
    v_mfma_f32_16x16x32_bf16 v[236:239], a[248:251], a[64:67], v[236:239]
    v_mfma_f32_16x16x32_bf16 v[240:243], a[248:251], a[68:71], v[240:243]
    v_mfma_f32_16x16x32_bf16 v[244:247], a[252:255], a[60:63], v[244:247]
    v_mfma_f32_16x16x32_bf16 v[248:251], a[252:255], a[64:67], v[248:251]
    v_mfma_f32_16x16x32_bf16 v[252:255], a[252:255], a[68:71], v[252:255]
    s_waitcnt lgkmcnt(0)
    s_waitcnt vmcnt(10)
    s_barrier
    v_mfma_f32_16x16x32_bf16 v[160:163], a[192:195], a[72:75], v[160:163]
    v_add_u32 v3, 0x10800, v3
    v_mfma_f32_16x16x32_bf16 v[164:167], a[192:195], a[76:79], v[164:167]
    ds_read_b64_tr_b16 a[224:225], v3 offset:0
    v_mfma_f32_16x16x32_bf16 v[168:171], a[192:195], a[80:83], v[168:171]
    ds_read_b64_tr_b16 a[226:227], v3 offset:1024
    v_mfma_f32_16x16x32_bf16 v[172:175], a[196:199], a[72:75], v[172:175]
    ds_read_b64_tr_b16 a[228:229], v3 offset:8
    s_add_u32 m0, s26, 67584
    v_mfma_f32_16x16x32_bf16 v[176:179], a[196:199], a[76:79], v[176:179]
    ds_read_b64_tr_b16 a[230:231], v3 offset:1032
    s_add_u32 s27, s63, 3407872
    v_mfma_f32_16x16x32_bf16 v[180:183], a[196:199], a[80:83], v[180:183]
    ds_read_b64_tr_b16 a[232:233], v3 offset:256
    buffer_load_dwordx4 v5, s[8:11], s27 offen lds
    v_mfma_f32_16x16x32_bf16 v[184:187], a[200:203], a[72:75], v[184:187]
    ds_read_b64_tr_b16 a[234:235], v3 offset:1280
    v_mfma_f32_16x16x32_bf16 v[188:191], a[200:203], a[76:79], v[188:191]
    ds_read_b64_tr_b16 a[236:237], v3 offset:264
    v_mfma_f32_16x16x32_bf16 v[192:195], a[200:203], a[80:83], v[192:195]
    ds_read_b64_tr_b16 a[238:239], v3 offset:1288
    s_add_u32 m0, s26, 68608
    v_mfma_f32_16x16x32_bf16 v[196:199], a[204:207], a[72:75], v[196:199]
    ds_read_b64_tr_b16 a[240:241], v3 offset:512
    s_add_u32 s27, s63, 3440640
    v_mfma_f32_16x16x32_bf16 v[200:203], a[204:207], a[76:79], v[200:203]
    ds_read_b64_tr_b16 a[242:243], v3 offset:1536
    buffer_load_dwordx4 v5, s[8:11], s27 offen lds
    v_mfma_f32_16x16x32_bf16 v[204:207], a[204:207], a[80:83], v[204:207]
    ds_read_b64_tr_b16 a[244:245], v3 offset:520
    v_mfma_f32_16x16x32_bf16 v[208:211], a[208:211], a[72:75], v[208:211]
    ds_read_b64_tr_b16 a[246:247], v3 offset:1544
    v_mfma_f32_16x16x32_bf16 v[212:215], a[208:211], a[76:79], v[212:215]
    ds_read_b64_tr_b16 a[248:249], v3 offset:768
    s_add_u32 m0, s26, 59136
    v_mfma_f32_16x16x32_bf16 v[216:219], a[208:211], a[80:83], v[216:219]
    ds_read_b64_tr_b16 a[250:251], v3 offset:1792
    s_add_u32 s27, s63, 3670016
    v_mfma_f32_16x16x32_bf16 v[220:223], a[212:215], a[72:75], v[220:223]
    ds_read_b64_tr_b16 a[252:253], v3 offset:776
    buffer_load_dwordx4 v5, s[8:11], s27 offen lds
    v_mfma_f32_16x16x32_bf16 v[224:227], a[212:215], a[76:79], v[224:227]
    ds_read_b64_tr_b16 a[254:255], v3 offset:1800
    v_mfma_f32_16x16x32_bf16 v[228:231], a[212:215], a[80:83], v[228:231]
    v_mfma_f32_16x16x32_bf16 v[232:235], a[216:219], a[72:75], v[232:235]
    s_add_u32 m0, s26, 60160
    v_mfma_f32_16x16x32_bf16 v[236:239], a[216:219], a[76:79], v[236:239]
    s_add_u32 s27, s63, 3702784
    v_mfma_f32_16x16x32_bf16 v[240:243], a[216:219], a[80:83], v[240:243]
    buffer_load_dwordx4 v5, s[8:11], s27 offen lds
    v_mfma_f32_16x16x32_bf16 v[244:247], a[220:223], a[72:75], v[244:247]
    v_mfma_f32_16x16x32_bf16 v[248:251], a[220:223], a[76:79], v[248:251]
    v_mfma_f32_16x16x32_bf16 v[252:255], a[220:223], a[80:83], v[252:255]
    s_waitcnt lgkmcnt(0)
    v_mfma_f32_16x16x32_bf16 v[160:163], a[224:227], a[84:87], v[160:163]
    v_add_u32 v3, 0xfffed700, v3
    v_mfma_f32_16x16x32_bf16 v[164:167], a[224:227], a[88:91], v[164:167]
    ds_read_b64_tr_b16 a[192:193], v3 offset:0
    v_mfma_f32_16x16x32_bf16 v[168:171], a[224:227], a[92:95], v[168:171]
    ds_read_b64_tr_b16 a[194:195], v3 offset:1024
    v_mfma_f32_16x16x32_bf16 v[172:175], a[228:231], a[84:87], v[172:175]
    ds_read_b64_tr_b16 a[196:197], v3 offset:8
    v_mfma_f32_16x16x32_bf16 v[176:179], a[228:231], a[88:91], v[176:179]
    ds_read_b64_tr_b16 a[198:199], v3 offset:1032
    v_mfma_f32_16x16x32_bf16 v[180:183], a[228:231], a[92:95], v[180:183]
    ds_read_b64_tr_b16 a[200:201], v3 offset:256
    v_mfma_f32_16x16x32_bf16 v[184:187], a[232:235], a[84:87], v[184:187]
    ds_read_b64_tr_b16 a[202:203], v3 offset:1280
    s_add_u32 m0, s25, 33792
    v_mfma_f32_16x16x32_bf16 v[188:191], a[232:235], a[88:91], v[188:191]
    ds_read_b64_tr_b16 a[204:205], v3 offset:264
    s_add_u32 s27, s62, 0
    v_mfma_f32_16x16x32_bf16 v[192:195], a[232:235], a[92:95], v[192:195]
    ds_read_b64_tr_b16 a[206:207], v3 offset:1288
    buffer_load_dwordx4 v4, s[16:19], s27 offen nt lds
    v_mfma_f32_16x16x32_bf16 v[196:199], a[236:239], a[84:87], v[196:199]
    ds_read_b64_tr_b16 a[208:209], v3 offset:512
    v_mfma_f32_16x16x32_bf16 v[200:203], a[236:239], a[88:91], v[200:203]
    ds_read_b64_tr_b16 a[210:211], v3 offset:1536
    v_mfma_f32_16x16x32_bf16 v[204:207], a[236:239], a[92:95], v[204:207]
    ds_read_b64_tr_b16 a[212:213], v3 offset:520
    v_mfma_f32_16x16x32_bf16 v[208:211], a[240:243], a[84:87], v[208:211]
    ds_read_b64_tr_b16 a[214:215], v3 offset:1544
    v_mfma_f32_16x16x32_bf16 v[212:215], a[240:243], a[88:91], v[212:215]
    ds_read_b64_tr_b16 a[216:217], v3 offset:768
    v_mfma_f32_16x16x32_bf16 v[216:219], a[240:243], a[92:95], v[216:219]
    ds_read_b64_tr_b16 a[218:219], v3 offset:1792
    v_mfma_f32_16x16x32_bf16 v[220:223], a[244:247], a[84:87], v[220:223]
    ds_read_b64_tr_b16 a[220:221], v3 offset:776
    v_mfma_f32_16x16x32_bf16 v[224:227], a[244:247], a[88:91], v[224:227]
    ds_read_b64_tr_b16 a[222:223], v3 offset:1800
    v_mfma_f32_16x16x32_bf16 v[228:231], a[244:247], a[92:95], v[228:231]
    s_add_u32 m0, s25, 33824
    v_mfma_f32_16x16x32_bf16 v[232:235], a[248:251], a[84:87], v[232:235]
    buffer_load_dwordx4 v4, s[16:19], s27 offen offset:1024 nt lds
    v_mfma_f32_16x16x32_bf16 v[236:239], a[248:251], a[88:91], v[236:239]
    v_mfma_f32_16x16x32_bf16 v[240:243], a[248:251], a[92:95], v[240:243]
    v_mfma_f32_16x16x32_bf16 v[244:247], a[252:255], a[84:87], v[244:247]
    v_mfma_f32_16x16x32_bf16 v[248:251], a[252:255], a[88:91], v[248:251]
    v_mfma_f32_16x16x32_bf16 v[252:255], a[252:255], a[92:95], v[252:255]
    s_waitcnt lgkmcnt(0)
    s_waitcnt vmcnt(12)
    s_barrier
    v_mfma_f32_16x16x32_bf16 v[160:163], a[192:195], a[96:99], v[160:163]
    v_add_u32 v3, 0x10800, v3
    v_mfma_f32_16x16x32_bf16 v[164:167], a[192:195], a[100:103], v[164:167]
    ds_read_b64_tr_b16 a[224:225], v3 offset:0
    v_mfma_f32_16x16x32_bf16 v[168:171], a[192:195], a[104:107], v[168:171]
    ds_read_b64_tr_b16 a[226:227], v3 offset:1024
    v_mfma_f32_16x16x32_bf16 v[172:175], a[196:199], a[96:99], v[172:175]
    ds_read_b64_tr_b16 a[228:229], v3 offset:8
    v_mfma_f32_16x16x32_bf16 v[176:179], a[196:199], a[100:103], v[176:179]
    ds_read_b64_tr_b16 a[230:231], v3 offset:1032
    v_mfma_f32_16x16x32_bf16 v[180:183], a[196:199], a[104:107], v[180:183]
    ds_read_b64_tr_b16 a[232:233], v3 offset:256
    v_mfma_f32_16x16x32_bf16 v[184:187], a[200:203], a[96:99], v[184:187]
    ds_read_b64_tr_b16 a[234:235], v3 offset:1280
    s_add_u32 m0, s26, 126720
    v_mfma_f32_16x16x32_bf16 v[188:191], a[200:203], a[100:103], v[188:191]
    ds_read_b64_tr_b16 a[236:237], v3 offset:264
    s_add_u32 s27, s63, 3932160
    v_mfma_f32_16x16x32_bf16 v[192:195], a[200:203], a[104:107], v[192:195]
    ds_read_b64_tr_b16 a[238:239], v3 offset:1288
    buffer_load_dwordx4 v5, s[8:11], s27 offen lds
    v_mfma_f32_16x16x32_bf16 v[196:199], a[204:207], a[96:99], v[196:199]
    ds_read_b64_tr_b16 a[240:241], v3 offset:512
    v_mfma_f32_16x16x32_bf16 v[200:203], a[204:207], a[100:103], v[200:203]
    ds_read_b64_tr_b16 a[242:243], v3 offset:1536
    v_mfma_f32_16x16x32_bf16 v[204:207], a[204:207], a[104:107], v[204:207]
    ds_read_b64_tr_b16 a[244:245], v3 offset:520
    v_mfma_f32_16x16x32_bf16 v[208:211], a[208:211], a[96:99], v[208:211]
    ds_read_b64_tr_b16 a[246:247], v3 offset:1544
    v_mfma_f32_16x16x32_bf16 v[212:215], a[208:211], a[100:103], v[212:215]
    ds_read_b64_tr_b16 a[248:249], v3 offset:768
    v_mfma_f32_16x16x32_bf16 v[216:219], a[208:211], a[104:107], v[216:219]
    ds_read_b64_tr_b16 a[250:251], v3 offset:1792
    v_mfma_f32_16x16x32_bf16 v[220:223], a[212:215], a[96:99], v[220:223]
    ds_read_b64_tr_b16 a[252:253], v3 offset:776
    v_mfma_f32_16x16x32_bf16 v[224:227], a[212:215], a[100:103], v[224:227]
    ds_read_b64_tr_b16 a[254:255], v3 offset:1800
    s_add_u32 m0, s26, 127744
    v_mfma_f32_16x16x32_bf16 v[228:231], a[212:215], a[104:107], v[228:231]
    s_add_u32 s27, s63, 3964928
    v_mfma_f32_16x16x32_bf16 v[232:235], a[216:219], a[96:99], v[232:235]
    buffer_load_dwordx4 v5, s[8:11], s27 offen lds
    v_mfma_f32_16x16x32_bf16 v[236:239], a[216:219], a[100:103], v[236:239]
    v_mfma_f32_16x16x32_bf16 v[240:243], a[216:219], a[104:107], v[240:243]
    v_mfma_f32_16x16x32_bf16 v[244:247], a[220:223], a[96:99], v[244:247]
    v_mfma_f32_16x16x32_bf16 v[248:251], a[220:223], a[100:103], v[248:251]
    v_mfma_f32_16x16x32_bf16 v[252:255], a[220:223], a[104:107], v[252:255]
    s_waitcnt lgkmcnt(0)
    v_mfma_f32_16x16x32_bf16 v[160:163], a[224:227], a[108:111], v[160:163]
    v_add_u32 v3, 0xffffdf00, v3
    v_mfma_f32_16x16x32_bf16 v[164:167], a[224:227], a[112:115], v[164:167]
    ds_read_b64_tr_b16 a[192:193], v3 offset:0
    v_mfma_f32_16x16x32_bf16 v[168:171], a[224:227], a[116:119], v[168:171]
    ds_read_b64_tr_b16 a[194:195], v3 offset:1024
    v_mfma_f32_16x16x32_bf16 v[172:175], a[228:231], a[108:111], v[172:175]
    ds_read_b64_tr_b16 a[196:197], v3 offset:8
    v_mfma_f32_16x16x32_bf16 v[176:179], a[228:231], a[112:115], v[176:179]
    ds_read_b64_tr_b16 a[198:199], v3 offset:1032
    v_mfma_f32_16x16x32_bf16 v[180:183], a[228:231], a[116:119], v[180:183]
    ds_read_b64_tr_b16 a[200:201], v3 offset:256
    v_mfma_f32_16x16x32_bf16 v[184:187], a[232:235], a[108:111], v[184:187]
    ds_read_b64_tr_b16 a[202:203], v3 offset:1280
    s_add_u32 m0, s25, 50688
    v_mfma_f32_16x16x32_bf16 v[188:191], a[232:235], a[112:115], v[188:191]
    ds_read_b64_tr_b16 a[204:205], v3 offset:264
    s_add_u32 s27, s62, 24576
    v_mfma_f32_16x16x32_bf16 v[192:195], a[232:235], a[116:119], v[192:195]
    ds_read_b64_tr_b16 a[206:207], v3 offset:1288
    buffer_load_dwordx4 v4, s[12:15], s27 offen nt lds
    v_mfma_f32_16x16x32_bf16 v[196:199], a[236:239], a[108:111], v[196:199]
    ds_read_b64_tr_b16 a[208:209], v3 offset:512
    v_mfma_f32_16x16x32_bf16 v[200:203], a[236:239], a[112:115], v[200:203]
    ds_read_b64_tr_b16 a[210:211], v3 offset:1536
    v_mfma_f32_16x16x32_bf16 v[204:207], a[236:239], a[116:119], v[204:207]
    ds_read_b64_tr_b16 a[212:213], v3 offset:520
    v_mfma_f32_16x16x32_bf16 v[208:211], a[240:243], a[108:111], v[208:211]
    ds_read_b64_tr_b16 a[214:215], v3 offset:1544
    v_mfma_f32_16x16x32_bf16 v[212:215], a[240:243], a[112:115], v[212:215]
    ds_read_b64_tr_b16 a[216:217], v3 offset:768
    v_mfma_f32_16x16x32_bf16 v[216:219], a[240:243], a[116:119], v[216:219]
    ds_read_b64_tr_b16 a[218:219], v3 offset:1792
    v_mfma_f32_16x16x32_bf16 v[220:223], a[244:247], a[108:111], v[220:223]
    ds_read_b64_tr_b16 a[220:221], v3 offset:776
    v_mfma_f32_16x16x32_bf16 v[224:227], a[244:247], a[112:115], v[224:227]
    ds_read_b64_tr_b16 a[222:223], v3 offset:1800
    v_mfma_f32_16x16x32_bf16 v[228:231], a[244:247], a[116:119], v[228:231]
    s_add_u32 m0, s25, 50720
    v_mfma_f32_16x16x32_bf16 v[232:235], a[248:251], a[108:111], v[232:235]
    buffer_load_dwordx4 v4, s[12:15], s27 offen offset:1024 nt lds
    v_mfma_f32_16x16x32_bf16 v[236:239], a[248:251], a[112:115], v[236:239]
    v_mfma_f32_16x16x32_bf16 v[240:243], a[248:251], a[116:119], v[240:243]
    v_mfma_f32_16x16x32_bf16 v[244:247], a[252:255], a[108:111], v[244:247]
    v_mfma_f32_16x16x32_bf16 v[248:251], a[252:255], a[112:115], v[248:251]
    v_mfma_f32_16x16x32_bf16 v[252:255], a[252:255], a[116:119], v[252:255]
    s_waitcnt lgkmcnt(0)
    s_waitcnt vmcnt(12)
    s_barrier
    v_mfma_f32_16x16x32_bf16 v[160:163], a[192:195], a[120:123], v[160:163]
    v_add_u32 v3, 0xffffdf00, v3
    v_mfma_f32_16x16x32_bf16 v[164:167], a[192:195], a[124:127], v[164:167]
    ds_read_b64_tr_b16 a[224:225], v3 offset:0
    v_mfma_f32_16x16x32_bf16 v[168:171], a[192:195], a[128:131], v[168:171]
    ds_read_b64_tr_b16 a[226:227], v3 offset:1024
    v_mfma_f32_16x16x32_bf16 v[172:175], a[196:199], a[120:123], v[172:175]
    ds_read_b64_tr_b16 a[228:229], v3 offset:8
    v_mfma_f32_16x16x32_bf16 v[176:179], a[196:199], a[124:127], v[176:179]
    ds_read_b64_tr_b16 a[230:231], v3 offset:1032
    v_mfma_f32_16x16x32_bf16 v[180:183], a[196:199], a[128:131], v[180:183]
    ds_read_b64_tr_b16 a[232:233], v3 offset:256
    v_mfma_f32_16x16x32_bf16 v[184:187], a[200:203], a[120:123], v[184:187]
    ds_read_b64_tr_b16 a[234:235], v3 offset:1280
    s_add_u32 m0, s25, 118272
    v_mfma_f32_16x16x32_bf16 v[188:191], a[200:203], a[124:127], v[188:191]
    ds_read_b64_tr_b16 a[236:237], v3 offset:264
    s_add_u32 s27, s62, 8192
    v_mfma_f32_16x16x32_bf16 v[192:195], a[200:203], a[128:131], v[192:195]
    ds_read_b64_tr_b16 a[238:239], v3 offset:1288
    buffer_load_dwordx4 v4, s[16:19], s27 offen nt lds
    v_mfma_f32_16x16x32_bf16 v[196:199], a[204:207], a[120:123], v[196:199]
    ds_read_b64_tr_b16 a[240:241], v3 offset:512
    v_mfma_f32_16x16x32_bf16 v[200:203], a[204:207], a[124:127], v[200:203]
    ds_read_b64_tr_b16 a[242:243], v3 offset:1536
    v_mfma_f32_16x16x32_bf16 v[204:207], a[204:207], a[128:131], v[204:207]
    ds_read_b64_tr_b16 a[244:245], v3 offset:520
    v_mfma_f32_16x16x32_bf16 v[208:211], a[208:211], a[120:123], v[208:211]
    ds_read_b64_tr_b16 a[246:247], v3 offset:1544
    v_mfma_f32_16x16x32_bf16 v[212:215], a[208:211], a[124:127], v[212:215]
    ds_read_b64_tr_b16 a[248:249], v3 offset:768
    v_mfma_f32_16x16x32_bf16 v[216:219], a[208:211], a[128:131], v[216:219]
    ds_read_b64_tr_b16 a[250:251], v3 offset:1792
    v_mfma_f32_16x16x32_bf16 v[220:223], a[212:215], a[120:123], v[220:223]
    ds_read_b64_tr_b16 a[252:253], v3 offset:776
    v_mfma_f32_16x16x32_bf16 v[224:227], a[212:215], a[124:127], v[224:227]
    ds_read_b64_tr_b16 a[254:255], v3 offset:1800
    v_mfma_f32_16x16x32_bf16 v[228:231], a[212:215], a[128:131], v[228:231]
    s_add_u32 m0, s25, 118304
    v_mfma_f32_16x16x32_bf16 v[232:235], a[216:219], a[120:123], v[232:235]
    buffer_load_dwordx4 v4, s[16:19], s27 offen offset:1024 nt lds
    v_mfma_f32_16x16x32_bf16 v[236:239], a[216:219], a[124:127], v[236:239]
    v_mfma_f32_16x16x32_bf16 v[240:243], a[216:219], a[128:131], v[240:243]
    v_mfma_f32_16x16x32_bf16 v[244:247], a[220:223], a[120:123], v[244:247]
    v_mfma_f32_16x16x32_bf16 v[248:251], a[220:223], a[124:127], v[248:251]
    v_mfma_f32_16x16x32_bf16 v[252:255], a[220:223], a[128:131], v[252:255]
    s_waitcnt lgkmcnt(0)
    v_mfma_f32_16x16x32_bf16 v[160:163], a[224:227], a[132:135], v[160:163]
    v_add_u32 v3, 0xffffdf00, v3
    v_mfma_f32_16x16x32_bf16 v[164:167], a[224:227], a[136:139], v[164:167]
    ds_read_b64_tr_b16 a[192:193], v3 offset:0
    v_mfma_f32_16x16x32_bf16 v[168:171], a[224:227], a[140:143], v[168:171]
    ds_read_b64_tr_b16 a[194:195], v3 offset:1024
    v_mfma_f32_16x16x32_bf16 v[172:175], a[228:231], a[132:135], v[172:175]
    ds_read_b64_tr_b16 a[196:197], v3 offset:8
    v_mfma_f32_16x16x32_bf16 v[176:179], a[228:231], a[136:139], v[176:179]
    ds_read_b64_tr_b16 a[198:199], v3 offset:1032
    v_mfma_f32_16x16x32_bf16 v[180:183], a[228:231], a[140:143], v[180:183]
    ds_read_b64_tr_b16 a[200:201], v3 offset:256
    v_mfma_f32_16x16x32_bf16 v[184:187], a[232:235], a[132:135], v[184:187]
    ds_read_b64_tr_b16 a[202:203], v3 offset:1280
    s_add_u32 m0, s25, 109824
    v_mfma_f32_16x16x32_bf16 v[188:191], a[232:235], a[136:139], v[188:191]
    ds_read_b64_tr_b16 a[204:205], v3 offset:264
    s_add_u32 s27, s62, 32768
    v_mfma_f32_16x16x32_bf16 v[192:195], a[232:235], a[140:143], v[192:195]
    ds_read_b64_tr_b16 a[206:207], v3 offset:1288
    buffer_load_dwordx4 v4, s[12:15], s27 offen nt lds
    v_mfma_f32_16x16x32_bf16 v[196:199], a[236:239], a[132:135], v[196:199]
    ds_read_b64_tr_b16 a[208:209], v3 offset:512
    v_mfma_f32_16x16x32_bf16 v[200:203], a[236:239], a[136:139], v[200:203]
    ds_read_b64_tr_b16 a[210:211], v3 offset:1536
    v_mfma_f32_16x16x32_bf16 v[204:207], a[236:239], a[140:143], v[204:207]
    ds_read_b64_tr_b16 a[212:213], v3 offset:520
    v_mfma_f32_16x16x32_bf16 v[208:211], a[240:243], a[132:135], v[208:211]
    ds_read_b64_tr_b16 a[214:215], v3 offset:1544
    v_mfma_f32_16x16x32_bf16 v[212:215], a[240:243], a[136:139], v[212:215]
    ds_read_b64_tr_b16 a[216:217], v3 offset:768
    v_mfma_f32_16x16x32_bf16 v[216:219], a[240:243], a[140:143], v[216:219]
    ds_read_b64_tr_b16 a[218:219], v3 offset:1792
    v_mfma_f32_16x16x32_bf16 v[220:223], a[244:247], a[132:135], v[220:223]
    ds_read_b64_tr_b16 a[220:221], v3 offset:776
    v_mfma_f32_16x16x32_bf16 v[224:227], a[244:247], a[136:139], v[224:227]
    ds_read_b64_tr_b16 a[222:223], v3 offset:1800
    v_mfma_f32_16x16x32_bf16 v[228:231], a[244:247], a[140:143], v[228:231]
    s_add_u32 m0, s25, 109856
    v_mfma_f32_16x16x32_bf16 v[232:235], a[248:251], a[132:135], v[232:235]
    buffer_load_dwordx4 v4, s[12:15], s27 offen offset:1024 nt lds
    v_mfma_f32_16x16x32_bf16 v[236:239], a[248:251], a[136:139], v[236:239]
    v_mfma_f32_16x16x32_bf16 v[240:243], a[248:251], a[140:143], v[240:243]
    v_mfma_f32_16x16x32_bf16 v[244:247], a[252:255], a[132:135], v[244:247]
    v_mfma_f32_16x16x32_bf16 v[248:251], a[252:255], a[136:139], v[248:251]
    v_mfma_f32_16x16x32_bf16 v[252:255], a[252:255], a[140:143], v[252:255]
    s_waitcnt lgkmcnt(0)
    s_waitcnt vmcnt(10)
    s_barrier
    v_mfma_f32_16x16x32_bf16 v[160:163], a[192:195], a[144:147], v[160:163]
    v_add_u32 v3, 0xffff9d00, v3
    v_mfma_f32_16x16x32_bf16 v[164:167], a[192:195], a[148:151], v[164:167]
    ds_read_b64_tr_b16 a[224:225], v3 offset:0
    v_mfma_f32_16x16x32_bf16 v[168:171], a[192:195], a[152:155], v[168:171]
    ds_read_b64_tr_b16 a[226:227], v3 offset:1024
    v_mfma_f32_16x16x32_bf16 v[172:175], a[196:199], a[144:147], v[172:175]
    ds_read_b64_tr_b16 a[228:229], v3 offset:8
    v_mfma_f32_16x16x32_bf16 v[176:179], a[196:199], a[148:151], v[176:179]
    ds_read_b64_tr_b16 a[230:231], v3 offset:1032
    v_mfma_f32_16x16x32_bf16 v[180:183], a[196:199], a[152:155], v[180:183]
    ds_read_b64_tr_b16 a[232:233], v3 offset:256
    v_mfma_f32_16x16x32_bf16 v[184:187], a[200:203], a[144:147], v[184:187]
    ds_read_b64_tr_b16 a[234:235], v3 offset:1280
    s_add_u32 m0, s25, 101376
    v_mfma_f32_16x16x32_bf16 v[188:191], a[200:203], a[148:151], v[188:191]
    ds_read_b64_tr_b16 a[236:237], v3 offset:264
    s_add_u32 s27, s62, 16384
    v_mfma_f32_16x16x32_bf16 v[192:195], a[200:203], a[152:155], v[192:195]
    ds_read_b64_tr_b16 a[238:239], v3 offset:1288
    buffer_load_dwordx4 v4, s[16:19], s27 offen nt lds
    v_mfma_f32_16x16x32_bf16 v[196:199], a[204:207], a[144:147], v[196:199]
    ds_read_b64_tr_b16 a[240:241], v3 offset:512
    v_mfma_f32_16x16x32_bf16 v[200:203], a[204:207], a[148:151], v[200:203]
    ds_read_b64_tr_b16 a[242:243], v3 offset:1536
    v_mfma_f32_16x16x32_bf16 v[204:207], a[204:207], a[152:155], v[204:207]
    ds_read_b64_tr_b16 a[244:245], v3 offset:520
    v_mfma_f32_16x16x32_bf16 v[208:211], a[208:211], a[144:147], v[208:211]
    ds_read_b64_tr_b16 a[246:247], v3 offset:1544
    v_mfma_f32_16x16x32_bf16 v[212:215], a[208:211], a[148:151], v[212:215]
    ds_read_b64_tr_b16 a[248:249], v3 offset:768
    v_mfma_f32_16x16x32_bf16 v[216:219], a[208:211], a[152:155], v[216:219]
    ds_read_b64_tr_b16 a[250:251], v3 offset:1792
    v_mfma_f32_16x16x32_bf16 v[220:223], a[212:215], a[144:147], v[220:223]
    ds_read_b64_tr_b16 a[252:253], v3 offset:776
    v_mfma_f32_16x16x32_bf16 v[224:227], a[212:215], a[148:151], v[224:227]
    ds_read_b64_tr_b16 a[254:255], v3 offset:1800
    v_mfma_f32_16x16x32_bf16 v[228:231], a[212:215], a[152:155], v[228:231]
    s_add_u32 m0, s25, 101408
    v_mfma_f32_16x16x32_bf16 v[232:235], a[216:219], a[144:147], v[232:235]
    buffer_load_dwordx4 v4, s[16:19], s27 offen offset:1024 nt lds
    v_mfma_f32_16x16x32_bf16 v[236:239], a[216:219], a[148:151], v[236:239]
    v_mfma_f32_16x16x32_bf16 v[240:243], a[216:219], a[152:155], v[240:243]
    v_mfma_f32_16x16x32_bf16 v[244:247], a[220:223], a[144:147], v[244:247]
    v_mfma_f32_16x16x32_bf16 v[248:251], a[220:223], a[148:151], v[248:251]
    v_mfma_f32_16x16x32_bf16 v[252:255], a[220:223], a[152:155], v[252:255]
    s_waitcnt lgkmcnt(0)
    v_mfma_f32_16x16x32_bf16 v[160:163], a[224:227], a[156:159], v[160:163]
    s_add_u32 s52, s52, 4096
    s_add_u32 s53, s53, 4096
    s_add_u32 s54, s54, 4096
    v_add_u32 v3, 0xffffdf00, v3
    v_mfma_f32_16x16x32_bf16 v[164:167], a[224:227], a[160:163], v[164:167]
    ds_read_b64_tr_b16 a[192:193], v3 offset:0
    v_mfma_f32_16x16x32_bf16 v[168:171], a[224:227], a[164:167], v[168:171]
    ds_read_b64_tr_b16 a[194:195], v3 offset:1024
    v_mfma_f32_16x16x32_bf16 v[172:175], a[228:231], a[156:159], v[172:175]
    ds_read_b64_tr_b16 a[196:197], v3 offset:8
    v_mfma_f32_16x16x32_bf16 v[176:179], a[228:231], a[160:163], v[176:179]
    ds_read_b64_tr_b16 a[198:199], v3 offset:1032
    v_mfma_f32_16x16x32_bf16 v[180:183], a[228:231], a[164:167], v[180:183]
    ds_read_b64_tr_b16 a[200:201], v3 offset:256
    v_mfma_f32_16x16x32_bf16 v[184:187], a[232:235], a[156:159], v[184:187]
    ds_read_b64_tr_b16 a[202:203], v3 offset:1280
    s_add_u32 m0, s25, 92928
    v_mfma_f32_16x16x32_bf16 v[188:191], a[232:235], a[160:163], v[188:191]
    ds_read_b64_tr_b16 a[204:205], v3 offset:264
    s_add_u32 s27, s62, 40960
    v_mfma_f32_16x16x32_bf16 v[192:195], a[232:235], a[164:167], v[192:195]
    ds_read_b64_tr_b16 a[206:207], v3 offset:1288
    buffer_load_dwordx4 v4, s[12:15], s27 offen nt lds
    v_mfma_f32_16x16x32_bf16 v[196:199], a[236:239], a[156:159], v[196:199]
    ds_read_b64_tr_b16 a[208:209], v3 offset:512
    v_mfma_f32_16x16x32_bf16 v[200:203], a[236:239], a[160:163], v[200:203]
    ds_read_b64_tr_b16 a[210:211], v3 offset:1536
    v_mfma_f32_16x16x32_bf16 v[204:207], a[236:239], a[164:167], v[204:207]
    ds_read_b64_tr_b16 a[212:213], v3 offset:520
    v_mfma_f32_16x16x32_bf16 v[208:211], a[240:243], a[156:159], v[208:211]
    ds_read_b64_tr_b16 a[214:215], v3 offset:1544
    v_mfma_f32_16x16x32_bf16 v[212:215], a[240:243], a[160:163], v[212:215]
    ds_read_b64_tr_b16 a[216:217], v3 offset:768
    v_mfma_f32_16x16x32_bf16 v[216:219], a[240:243], a[164:167], v[216:219]
    ds_read_b64_tr_b16 a[218:219], v3 offset:1792
    v_mfma_f32_16x16x32_bf16 v[220:223], a[244:247], a[156:159], v[220:223]
    ds_read_b64_tr_b16 a[220:221], v3 offset:776
    v_mfma_f32_16x16x32_bf16 v[224:227], a[244:247], a[160:163], v[224:227]
    ds_read_b64_tr_b16 a[222:223], v3 offset:1800
    v_mfma_f32_16x16x32_bf16 v[228:231], a[244:247], a[164:167], v[228:231]
    s_add_u32 m0, s25, 92960
    v_mfma_f32_16x16x32_bf16 v[232:235], a[248:251], a[156:159], v[232:235]
    buffer_load_dwordx4 v4, s[12:15], s27 offen offset:1024 nt lds
    v_mfma_f32_16x16x32_bf16 v[236:239], a[248:251], a[160:163], v[236:239]
    v_mfma_f32_16x16x32_bf16 v[240:243], a[248:251], a[164:167], v[240:243]
    v_mfma_f32_16x16x32_bf16 v[244:247], a[252:255], a[156:159], v[244:247]
    v_mfma_f32_16x16x32_bf16 v[248:251], a[252:255], a[160:163], v[248:251]
    v_mfma_f32_16x16x32_bf16 v[252:255], a[252:255], a[164:167], v[252:255]
    s_waitcnt lgkmcnt(0)
    s_waitcnt vmcnt(10)
    s_barrier
    v_mfma_f32_16x16x32_bf16 v[160:163], a[192:195], a[168:171], v[160:163]
    v_add_u32 v3, 0x10800, v3
    v_mfma_f32_16x16x32_bf16 v[164:167], a[192:195], a[172:175], v[164:167]
    ds_read_b64_tr_b16 a[224:225], v3 offset:0
    v_mfma_f32_16x16x32_bf16 v[168:171], a[192:195], a[176:179], v[168:171]
    ds_read_b64_tr_b16 a[226:227], v3 offset:1024
    v_mfma_f32_16x16x32_bf16 v[172:175], a[196:199], a[168:171], v[172:175]
    ds_read_b64_tr_b16 a[228:229], v3 offset:8
    v_mfma_f32_16x16x32_bf16 v[176:179], a[196:199], a[172:175], v[176:179]
    ds_read_b64_tr_b16 a[230:231], v3 offset:1032
    v_mfma_f32_16x16x32_bf16 v[180:183], a[196:199], a[176:179], v[180:183]
    ds_read_b64_tr_b16 a[232:233], v3 offset:256
    v_mfma_f32_16x16x32_bf16 v[184:187], a[200:203], a[168:171], v[184:187]
    ds_read_b64_tr_b16 a[234:235], v3 offset:1280
    s_add_u32 m0, s25, 67584
    v_mfma_f32_16x16x32_bf16 v[188:191], a[200:203], a[172:175], v[188:191]
    ds_read_b64_tr_b16 a[236:237], v3 offset:264
    s_add_u32 s27, s62, 24576
    v_mfma_f32_16x16x32_bf16 v[192:195], a[200:203], a[176:179], v[192:195]
    ds_read_b64_tr_b16 a[238:239], v3 offset:1288
    buffer_load_dwordx4 v4, s[16:19], s27 offen nt lds
    v_mfma_f32_16x16x32_bf16 v[196:199], a[204:207], a[168:171], v[196:199]
    ds_read_b64_tr_b16 a[240:241], v3 offset:512
    v_mfma_f32_16x16x32_bf16 v[200:203], a[204:207], a[172:175], v[200:203]
    ds_read_b64_tr_b16 a[242:243], v3 offset:1536
    v_mfma_f32_16x16x32_bf16 v[204:207], a[204:207], a[176:179], v[204:207]
    ds_read_b64_tr_b16 a[244:245], v3 offset:520
    v_mfma_f32_16x16x32_bf16 v[208:211], a[208:211], a[168:171], v[208:211]
    ds_read_b64_tr_b16 a[246:247], v3 offset:1544
    v_mfma_f32_16x16x32_bf16 v[212:215], a[208:211], a[172:175], v[212:215]
    ds_read_b64_tr_b16 a[248:249], v3 offset:768
    v_mfma_f32_16x16x32_bf16 v[216:219], a[208:211], a[176:179], v[216:219]
    ds_read_b64_tr_b16 a[250:251], v3 offset:1792
    v_mfma_f32_16x16x32_bf16 v[220:223], a[212:215], a[168:171], v[220:223]
    ds_read_b64_tr_b16 a[252:253], v3 offset:776
    v_mfma_f32_16x16x32_bf16 v[224:227], a[212:215], a[172:175], v[224:227]
    ds_read_b64_tr_b16 a[254:255], v3 offset:1800
    v_mfma_f32_16x16x32_bf16 v[228:231], a[212:215], a[176:179], v[228:231]
    s_add_u32 m0, s25, 67616
    v_mfma_f32_16x16x32_bf16 v[232:235], a[216:219], a[168:171], v[232:235]
    buffer_load_dwordx4 v4, s[16:19], s27 offen offset:1024 nt lds
    v_mfma_f32_16x16x32_bf16 v[236:239], a[216:219], a[172:175], v[236:239]
    v_mfma_f32_16x16x32_bf16 v[240:243], a[216:219], a[176:179], v[240:243]
    v_mfma_f32_16x16x32_bf16 v[244:247], a[220:223], a[168:171], v[244:247]
    v_mfma_f32_16x16x32_bf16 v[248:251], a[220:223], a[172:175], v[248:251]
    v_mfma_f32_16x16x32_bf16 v[252:255], a[220:223], a[176:179], v[252:255]
    s_waitcnt lgkmcnt(0)
    v_mfma_f32_16x16x32_bf16 v[160:163], a[224:227], a[180:183], v[160:163]
    v_add_u32 v1, 0xffff3a00, v1
    v_mfma_f32_16x16x32_bf16 v[164:167], a[224:227], a[184:187], v[164:167]
    ds_read_b128 a[192:195], v1 offset:0
    v_mfma_f32_16x16x32_bf16 v[168:171], a[224:227], a[188:191], v[168:171]
    v_mfma_f32_16x16x32_bf16 v[172:175], a[228:231], a[180:183], v[172:175]
    ds_read_b128 a[196:199], v1 offset:256
    v_mfma_f32_16x16x32_bf16 v[176:179], a[228:231], a[184:187], v[176:179]
    v_mfma_f32_16x16x32_bf16 v[180:183], a[228:231], a[188:191], v[180:183]
    ds_read_b128 a[200:203], v1 offset:512
    v_mfma_f32_16x16x32_bf16 v[184:187], a[232:235], a[180:183], v[184:187]
    s_add_u32 m0, s25, 59136
    v_mfma_f32_16x16x32_bf16 v[188:191], a[232:235], a[184:187], v[188:191]
    ds_read_b128 a[204:207], v1 offset:768
    s_add_u32 s27, s62, 49152
    v_mfma_f32_16x16x32_bf16 v[192:195], a[232:235], a[188:191], v[192:195]
    buffer_load_dwordx4 v4, s[12:15], s27 offen nt lds
    v_pk_mul_f32 v[160:161], v[160:161], s[60:61]
    v_pk_mul_f32 v[162:163], v[162:163], s[60:61]
    v_pk_mul_f32 v[172:173], v[172:173], s[60:61]
    v_mfma_f32_16x16x32_bf16 v[196:199], a[236:239], a[180:183], v[196:199]
    ds_read_b128 a[208:211], v1 offset:4224
    v_pk_mul_f32 v[174:175], v[174:175], s[60:61]
    v_cvt_pk_bf16_f32 v100, v160, v161
    v_cvt_pk_bf16_f32 v101, v162, v163
    v_mfma_f32_16x16x32_bf16 v[200:203], a[236:239], a[184:187], v[200:203]
    v_cvt_pk_bf16_f32 v102, v172, v173
    v_cvt_pk_bf16_f32 v103, v174, v175
    v_pk_mul_f32 v[164:165], v[164:165], s[60:61]
    v_mfma_f32_16x16x32_bf16 v[204:207], a[236:239], a[188:191], v[204:207]
    ds_read_b128 a[212:215], v1 offset:4480
    v_pk_mul_f32 v[166:167], v[166:167], s[60:61]
    v_pk_mul_f32 v[176:177], v[176:177], s[60:61]
    v_pk_mul_f32 v[178:179], v[178:179], s[60:61]
    v_mfma_f32_16x16x32_bf16 v[208:211], a[240:243], a[180:183], v[208:211]
    v_cvt_pk_bf16_f32 v104, v164, v165
    v_cvt_pk_bf16_f32 v105, v166, v167
    v_cvt_pk_bf16_f32 v106, v176, v177
    v_mfma_f32_16x16x32_bf16 v[212:215], a[240:243], a[184:187], v[212:215]
    ds_read_b128 a[216:219], v1 offset:4736
    v_cvt_pk_bf16_f32 v107, v178, v179
    v_pk_mul_f32 v[168:169], v[168:169], s[60:61]
    v_pk_mul_f32 v[170:171], v[170:171], s[60:61]
    v_mfma_f32_16x16x32_bf16 v[216:219], a[240:243], a[188:191], v[216:219]
    v_pk_mul_f32 v[180:181], v[180:181], s[60:61]
    v_pk_mul_f32 v[182:183], v[182:183], s[60:61]
    v_cvt_pk_bf16_f32 v108, v168, v169
    v_pk_mul_f32 v[184:185], v[184:185], s[60:61]
    v_pk_mul_f32 v[186:187], v[186:187], s[60:61]
    v_pk_mul_f32 v[196:197], v[196:197], s[60:61]
    v_mfma_f32_16x16x32_bf16 v[220:223], a[244:247], a[180:183], v[220:223]
    ds_read_b128 a[220:223], v1 offset:4992
    v_cvt_pk_bf16_f32 v109, v170, v171
    v_cvt_pk_bf16_f32 v110, v180, v181
    v_cvt_pk_bf16_f32 v111, v182, v183
    v_pk_mul_f32 v[198:199], v[198:199], s[60:61]
    v_cvt_pk_bf16_f32 v112, v184, v185
    v_cvt_pk_bf16_f32 v113, v186, v187
    v_mfma_f32_16x16x32_bf16 v[224:227], a[244:247], a[184:187], v[224:227]
    v_cvt_pk_bf16_f32 v114, v196, v197
    v_cvt_pk_bf16_f32 v115, v198, v199
    v_pk_mul_f32 v[188:189], v[188:189], s[60:61]
    v_mfma_f32_16x16x32_bf16 v[228:231], a[244:247], a[188:191], v[228:231]
    s_add_u32 m0, s25, 59168
    v_pk_mul_f32 v[190:191], v[190:191], s[60:61]
    v_pk_mul_f32 v[200:201], v[200:201], s[60:61]
    v_pk_mul_f32 v[202:203], v[202:203], s[60:61]
    v_mfma_f32_16x16x32_bf16 v[232:235], a[248:251], a[180:183], v[232:235]
    buffer_load_dwordx4 v4, s[12:15], s27 offen offset:1024 nt lds
    v_cvt_pk_bf16_f32 v116, v188, v189
    v_cvt_pk_bf16_f32 v117, v190, v191
    v_cvt_pk_bf16_f32 v118, v200, v201
    v_mfma_f32_16x16x32_bf16 v[236:239], a[248:251], a[184:187], v[236:239]
    v_cvt_pk_bf16_f32 v119, v202, v203
    v_pk_mul_f32 v[192:193], v[192:193], s[60:61]
    v_pk_mul_f32 v[194:195], v[194:195], s[60:61]
    v_mfma_f32_16x16x32_bf16 v[240:243], a[248:251], a[188:191], v[240:243]
    v_pk_mul_f32 v[204:205], v[204:205], s[60:61]
    v_pk_mul_f32 v[206:207], v[206:207], s[60:61]
    v_cvt_pk_bf16_f32 v120, v192, v193
    v_pk_mul_f32 v[208:209], v[208:209], s[60:61]
    v_pk_mul_f32 v[210:211], v[210:211], s[60:61]
    v_pk_mul_f32 v[220:221], v[220:221], s[60:61]
    v_pk_mul_f32 v[222:223], v[222:223], s[60:61]
    v_cvt_pk_bf16_f32 v124, v208, v209
    v_cvt_pk_bf16_f32 v125, v210, v211
    v_mfma_f32_16x16x32_bf16 v[244:247], a[252:255], a[180:183], v[244:247]
    v_cvt_pk_bf16_f32 v121, v194, v195
    v_cvt_pk_bf16_f32 v122, v204, v205
    v_cvt_pk_bf16_f32 v123, v206, v207
    v_cvt_pk_bf16_f32 v126, v220, v221
    v_cvt_pk_bf16_f32 v127, v222, v223
    v_pk_mul_f32 v[212:213], v[212:213], s[60:61]
    v_pk_mul_f32 v[214:215], v[214:215], s[60:61]
    v_pk_mul_f32 v[224:225], v[224:225], s[60:61]
    v_pk_mul_f32 v[226:227], v[226:227], s[60:61]
    v_mfma_f32_16x16x32_bf16 v[248:251], a[252:255], a[184:187], v[248:251]
    v_cvt_pk_bf16_f32 v128, v212, v213
    v_cvt_pk_bf16_f32 v129, v214, v215
    v_cvt_pk_bf16_f32 v130, v224, v225
    v_cvt_pk_bf16_f32 v131, v226, v227
    v_pk_mul_f32 v[216:217], v[216:217], s[60:61]
    v_pk_mul_f32 v[218:219], v[218:219], s[60:61]
    v_mfma_f32_16x16x32_bf16 v[252:255], a[252:255], a[188:191], v[252:255]
    v_pk_mul_f32 v[228:229], v[228:229], s[60:61]
    v_pk_mul_f32 v[230:231], v[230:231], s[60:61]
    v_cvt_pk_bf16_f32 v132, v216, v217
    v_cvt_pk_bf16_f32 v133, v218, v219
    v_cvt_pk_bf16_f32 v134, v228, v229
    v_cvt_pk_bf16_f32 v135, v230, v231
    s_waitcnt lgkmcnt(0)
    s_waitcnt vmcnt(8)
    s_nop 7
    s_branch A_LOOP
A_SLOW:
    s_nop 9
    s_waitcnt vmcnt(0) lgkmcnt(0)
    v_add_u32 v10, 0x0, v1
    v_add_u32 v11, 0x16b00, v2
    v_mov_b32 v28, 0xff800000
    v_mov_b32 v32, 0xff800000
    v_mov_b32 v36, 0xff800000
    s_mov_b32 s58, 0
A_SLOW1:
    s_add_u32 m0, s25, 135168
    s_lshl_b32 s27, s58, 13
    s_add_u32 s27, s27, s62
    s_sub_u32 s27, s27, 0x20000
    buffer_load_dwordx4 v4, s[12:15], s27 offen lds
    s_add_u32 m0, s25, 135200
    s_nop 0
    buffer_load_dwordx4 v4, s[12:15], s27 offen offset:1024 lds
    s_waitcnt vmcnt(0)
    s_barrier
    ds_read_b128 a[192:195], v10 offset:0
    ds_read_b128 a[196:199], v10 offset:256
    ds_read_b128 a[200:203], v10 offset:512
    ds_read_b128 a[204:207], v10 offset:768
    ds_read_b128 a[208:211], v10 offset:4224
    ds_read_b128 a[212:215], v10 offset:4480
    ds_read_b128 a[216:219], v10 offset:4736
    ds_read_b128 a[220:223], v10 offset:4992
    s_waitcnt lgkmcnt(0)
    v_mfma_f32_16x16x32_bf16 v[40:43], a[192:195], v[100:103], 0
    v_mfma_f32_16x16x32_bf16 v[48:51], a[192:195], v[104:107], 0
    v_mfma_f32_16x16x32_bf16 v[56:59], a[192:195], v[108:111], 0
    v_mfma_f32_16x16x32_bf16 v[40:43], a[196:199], v[112:115], v[40:43]
    v_mfma_f32_16x16x32_bf16 v[48:51], a[196:199], v[116:119], v[48:51]
    v_mfma_f32_16x16x32_bf16 v[56:59], a[196:199], v[120:123], v[56:59]
    v_mfma_f32_16x16x32_bf16 v[40:43], a[200:203], v[124:127], v[40:43]
    v_mfma_f32_16x16x32_bf16 v[48:51], a[200:203], v[128:131], v[48:51]
    v_mfma_f32_16x16x32_bf16 v[56:59], a[200:203], v[132:135], v[56:59]
    v_mfma_f32_16x16x32_bf16 v[40:43], a[204:207], v[136:139], v[40:43]
    v_mfma_f32_16x16x32_bf16 v[48:51], a[204:207], v[140:143], v[48:51]
    v_mfma_f32_16x16x32_bf16 v[56:59], a[204:207], v[144:147], v[56:59]
    v_mfma_f32_16x16x32_bf16 v[44:47], a[208:211], v[100:103], 0
    v_mfma_f32_16x16x32_bf16 v[52:55], a[208:211], v[104:107], 0
    v_mfma_f32_16x16x32_bf16 v[60:63], a[208:211], v[108:111], 0
    v_mfma_f32_16x16x32_bf16 v[44:47], a[212:215], v[112:115], v[44:47]
    v_mfma_f32_16x16x32_bf16 v[52:55], a[212:215], v[116:119], v[52:55]
    v_mfma_f32_16x16x32_bf16 v[60:63], a[212:215], v[120:123], v[60:63]
    v_mfma_f32_16x16x32_bf16 v[44:47], a[216:219], v[124:127], v[44:47]
    v_mfma_f32_16x16x32_bf16 v[52:55], a[216:219], v[128:131], v[52:55]
    v_mfma_f32_16x16x32_bf16 v[60:63], a[216:219], v[132:135], v[60:63]
    v_mfma_f32_16x16x32_bf16 v[44:47], a[220:223], v[136:139], v[44:47]
    v_mfma_f32_16x16x32_bf16 v[52:55], a[220:223], v[140:143], v[52:55]
    v_mfma_f32_16x16x32_bf16 v[60:63], a[220:223], v[144:147], v[60:63]
    s_nop 9
    v_max3_f32 v28, v28, v40, v41
    v_max3_f32 v28, v28, v42, v43
    v_max3_f32 v28, v28, v44, v45
    v_max3_f32 v28, v28, v46, v47
    v_max3_f32 v32, v32, v48, v49
    v_max3_f32 v32, v32, v50, v51
    v_max3_f32 v32, v32, v52, v53
    v_max3_f32 v32, v32, v54, v55
    v_max3_f32 v36, v36, v56, v57
    v_max3_f32 v36, v36, v58, v59
    v_max3_f32 v36, v36, v60, v61
    v_max3_f32 v36, v36, v62, v63
    s_barrier
    s_add_u32 s58, s58, 1
    s_cmp_lt_u32 s58, 16
    s_cbranch_scc1 A_SLOW1
    s_nop 9
    v_mov_b32 v7, v28
    s_nop 1
    v_permlane32_swap_b32 v28, v7
    v_max_f32 v28, v28, v7
    v_mov_b32 v7, v28
    s_nop 0
    s_nop 0
    v_permlane16_swap_b32 v28, v7
    v_max_f32 v28, v28, v7
    v_mov_b32 v8, v32
    s_nop 1
    v_permlane32_swap_b32 v32, v8
    v_max_f32 v32, v32, v8
    v_mov_b32 v8, v32
    s_nop 0
    s_nop 0
    v_permlane16_swap_b32 v32, v8
    v_max_f32 v32, v32, v8
    v_mov_b32 v9, v36
    s_nop 1
    v_permlane32_swap_b32 v36, v9
    v_max_f32 v36, v36, v9
    v_mov_b32 v9, v36
    s_nop 0
    s_nop 0
    v_permlane16_swap_b32 v36, v9
    v_max_f32 v36, v36, v9
    v_sub_f32 v88, 0, v28
    v_sub_f32 v89, 0, v28
    v_sub_f32 v90, 0, v28
    v_sub_f32 v91, 0, v28
    v_sub_f32 v92, 0, v32
    v_sub_f32 v93, 0, v32
    v_sub_f32 v94, 0, v32
    v_sub_f32 v95, 0, v32
    v_sub_f32 v96, 0, v36
    v_sub_f32 v97, 0, v36
    v_sub_f32 v98, 0, v36
    v_sub_f32 v99, 0, v36
    v_mov_b32 v148, 0
    v_mov_b32 v149, 0
    v_mov_b32 v150, 0
    v_mov_b32 v151, 0
    v_mov_b32 v152, 0
    v_mov_b32 v153, 0
    v_mov_b32 v154, 0
    v_mov_b32 v155, 0
    v_mov_b32 v156, 0
    v_mov_b32 v157, 0
    v_mov_b32 v158, 0
    v_mov_b32 v159, 0
    v_mov_b32 v160, 0
    v_mov_b32 v161, 0
    v_mov_b32 v162, 0
    v_mov_b32 v163, 0
    v_mov_b32 v164, 0
    v_mov_b32 v165, 0
    v_mov_b32 v166, 0
    v_mov_b32 v167, 0
    v_mov_b32 v168, 0
    v_mov_b32 v169, 0
    v_mov_b32 v170, 0
    v_mov_b32 v171, 0
    v_mov_b32 v172, 0
    v_mov_b32 v173, 0
    v_mov_b32 v174, 0
    v_mov_b32 v175, 0
    v_mov_b32 v176, 0
    v_mov_b32 v177, 0
    v_mov_b32 v178, 0
    v_mov_b32 v179, 0
    v_mov_b32 v180, 0
    v_mov_b32 v181, 0
    v_mov_b32 v182, 0
    v_mov_b32 v183, 0
    v_mov_b32 v184, 0
    v_mov_b32 v185, 0
    v_mov_b32 v186, 0
    v_mov_b32 v187, 0
    v_mov_b32 v188, 0
    v_mov_b32 v189, 0
    v_mov_b32 v190, 0
    v_mov_b32 v191, 0
    v_mov_b32 v192, 0
    v_mov_b32 v193, 0
    v_mov_b32 v194, 0
    v_mov_b32 v195, 0
    v_mov_b32 v196, 0
    v_mov_b32 v197, 0
    v_mov_b32 v198, 0
    v_mov_b32 v199, 0
    v_mov_b32 v200, 0
    v_mov_b32 v201, 0
    v_mov_b32 v202, 0
    v_mov_b32 v203, 0
    v_mov_b32 v204, 0
    v_mov_b32 v205, 0
    v_mov_b32 v206, 0
    v_mov_b32 v207, 0
    v_mov_b32 v208, 0
    v_mov_b32 v209, 0
    v_mov_b32 v210, 0
    v_mov_b32 v211, 0
    v_mov_b32 v212, 0
    v_mov_b32 v213, 0
    v_mov_b32 v214, 0
    v_mov_b32 v215, 0
    v_mov_b32 v216, 0
    v_mov_b32 v217, 0
    v_mov_b32 v218, 0
    v_mov_b32 v219, 0
    v_mov_b32 v220, 0
    v_mov_b32 v221, 0
    v_mov_b32 v222, 0
    v_mov_b32 v223, 0
    v_mov_b32 v224, 0
    v_mov_b32 v225, 0
    v_mov_b32 v226, 0
    v_mov_b32 v227, 0
    v_mov_b32 v228, 0
    v_mov_b32 v229, 0
    v_mov_b32 v230, 0
    v_mov_b32 v231, 0
    v_mov_b32 v232, 0
    v_mov_b32 v233, 0
    v_mov_b32 v234, 0
    v_mov_b32 v235, 0
    v_mov_b32 v236, 0
    v_mov_b32 v237, 0
    v_mov_b32 v238, 0
    v_mov_b32 v239, 0
    v_mov_b32 v240, 0
    v_mov_b32 v241, 0
    v_mov_b32 v242, 0
    v_mov_b32 v243, 0
    v_mov_b32 v244, 0
    v_mov_b32 v245, 0
    v_mov_b32 v246, 0
    v_mov_b32 v247, 0
    v_mov_b32 v248, 0
    v_mov_b32 v249, 0
    v_mov_b32 v250, 0
    v_mov_b32 v251, 0
    v_mov_b32 v252, 0
    v_mov_b32 v253, 0
    v_mov_b32 v254, 0
    v_mov_b32 v255, 0
    s_mov_b32 s58, 0
A_SLOW2:
    s_add_u32 m0, s25, 135168
    s_lshl_b32 s27, s58, 13
    s_add_u32 s27, s27, s62
    s_sub_u32 s27, s27, 0x20000
    buffer_load_dwordx4 v4, s[12:15], s27 offen lds
    s_add_u32 m0, s25, 135200
    s_nop 0
    buffer_load_dwordx4 v4, s[12:15], s27 offen offset:1024 lds
    s_add_u32 m0, s25, 143616
    s_lshl_b32 s27, s58, 13
    s_add_u32 s27, s27, s62
    s_sub_u32 s27, s27, 0x20000
    buffer_load_dwordx4 v4, s[16:19], s27 offen lds
    s_add_u32 m0, s25, 143648
    s_nop 0
    buffer_load_dwordx4 v4, s[16:19], s27 offen offset:1024 lds
    s_waitcnt vmcnt(0)
    s_barrier
    ds_read_b128 a[192:195], v10 offset:0
    ds_read_b128 a[196:199], v10 offset:256
    ds_read_b128 a[200:203], v10 offset:512
    ds_read_b128 a[204:207], v10 offset:768
    ds_read_b128 a[208:211], v10 offset:4224
    ds_read_b128 a[212:215], v10 offset:4480
    ds_read_b128 a[216:219], v10 offset:4736
    ds_read_b128 a[220:223], v10 offset:4992
    ds_read_b64_tr_b16 a[224:225], v11 offset:0
    ds_read_b64_tr_b16 a[226:227], v11 offset:4224
    ds_read_b64_tr_b16 a[228:229], v11 offset:32
    ds_read_b64_tr_b16 a[230:231], v11 offset:4256
    ds_read_b64_tr_b16 a[232:233], v11 offset:256
    ds_read_b64_tr_b16 a[234:235], v11 offset:4480
    ds_read_b64_tr_b16 a[236:237], v11 offset:288
    ds_read_b64_tr_b16 a[238:239], v11 offset:4512
    ds_read_b64_tr_b16 a[240:241], v11 offset:512
    ds_read_b64_tr_b16 a[242:243], v11 offset:4736
    ds_read_b64_tr_b16 a[244:245], v11 offset:544
    ds_read_b64_tr_b16 a[246:247], v11 offset:4768
    ds_read_b64_tr_b16 a[248:249], v11 offset:768
    ds_read_b64_tr_b16 a[250:251], v11 offset:4992
    ds_read_b64_tr_b16 a[252:253], v11 offset:800
    ds_read_b64_tr_b16 a[254:255], v11 offset:5024
    s_waitcnt lgkmcnt(0)
    v_mfma_f32_16x16x32_bf16 v[40:43], a[192:195], v[100:103], v[88:91]
    v_mfma_f32_16x16x32_bf16 v[48:51], a[192:195], v[104:107], v[92:95]
    v_mfma_f32_16x16x32_bf16 v[56:59], a[192:195], v[108:111], v[96:99]
    v_mfma_f32_16x16x32_bf16 v[40:43], a[196:199], v[112:115], v[40:43]
    v_mfma_f32_16x16x32_bf16 v[48:51], a[196:199], v[116:119], v[48:51]
    v_mfma_f32_16x16x32_bf16 v[56:59], a[196:199], v[120:123], v[56:59]
    v_mfma_f32_16x16x32_bf16 v[40:43], a[200:203], v[124:127], v[40:43]
    v_mfma_f32_16x16x32_bf16 v[48:51], a[200:203], v[128:131], v[48:51]
    v_mfma_f32_16x16x32_bf16 v[56:59], a[200:203], v[132:135], v[56:59]
    v_mfma_f32_16x16x32_bf16 v[40:43], a[204:207], v[136:139], v[40:43]
    v_mfma_f32_16x16x32_bf16 v[48:51], a[204:207], v[140:143], v[48:51]
    v_mfma_f32_16x16x32_bf16 v[56:59], a[204:207], v[144:147], v[56:59]
    v_mfma_f32_16x16x32_bf16 v[44:47], a[208:211], v[100:103], v[88:91]
    v_mfma_f32_16x16x32_bf16 v[52:55], a[208:211], v[104:107], v[92:95]
    v_mfma_f32_16x16x32_bf16 v[60:63], a[208:211], v[108:111], v[96:99]
    v_mfma_f32_16x16x32_bf16 v[44:47], a[212:215], v[112:115], v[44:47]
    v_mfma_f32_16x16x32_bf16 v[52:55], a[212:215], v[116:119], v[52:55]
    v_mfma_f32_16x16x32_bf16 v[60:63], a[212:215], v[120:123], v[60:63]
    v_mfma_f32_16x16x32_bf16 v[44:47], a[216:219], v[124:127], v[44:47]
    v_mfma_f32_16x16x32_bf16 v[52:55], a[216:219], v[128:131], v[52:55]
    v_mfma_f32_16x16x32_bf16 v[60:63], a[216:219], v[132:135], v[60:63]
    v_mfma_f32_16x16x32_bf16 v[44:47], a[220:223], v[136:139], v[44:47]
    v_mfma_f32_16x16x32_bf16 v[52:55], a[220:223], v[140:143], v[52:55]
    v_mfma_f32_16x16x32_bf16 v[60:63], a[220:223], v[144:147], v[60:63]
    s_nop 9
    v_exp_f32 v40, v40
    v_exp_f32 v41, v41
    v_exp_f32 v42, v42
    v_exp_f32 v43, v43
    v_exp_f32 v44, v44
    v_exp_f32 v45, v45
    v_exp_f32 v46, v46
    v_exp_f32 v47, v47
    v_exp_f32 v48, v48
    v_exp_f32 v49, v49
    v_exp_f32 v50, v50
    v_exp_f32 v51, v51
    v_exp_f32 v52, v52
    v_exp_f32 v53, v53
    v_exp_f32 v54, v54
    v_exp_f32 v55, v55
    v_exp_f32 v56, v56
    v_exp_f32 v57, v57
    v_exp_f32 v58, v58
    v_exp_f32 v59, v59
    v_exp_f32 v60, v60
    v_exp_f32 v61, v61
    v_exp_f32 v62, v62
    v_exp_f32 v63, v63
    v_cvt_pk_bf16_f32 v16, v40, v41
    v_cvt_pk_bf16_f32 v17, v42, v43
    v_cvt_pk_bf16_f32 v18, v44, v45
    v_cvt_pk_bf16_f32 v19, v46, v47
    v_cvt_pk_bf16_f32 v20, v48, v49
    v_cvt_pk_bf16_f32 v21, v50, v51
    v_cvt_pk_bf16_f32 v22, v52, v53
    v_cvt_pk_bf16_f32 v23, v54, v55
    v_cvt_pk_bf16_f32 v24, v56, v57
    v_cvt_pk_bf16_f32 v25, v58, v59
    v_cvt_pk_bf16_f32 v26, v60, v61
    v_cvt_pk_bf16_f32 v27, v62, v63
    s_nop 1
    v_mfma_f32_16x16x32_bf16 v[160:163], a[224:227], v[16:19], v[160:163]
    v_mfma_f32_16x16x32_bf16 v[164:167], a[224:227], v[20:23], v[164:167]
    v_mfma_f32_16x16x32_bf16 v[168:171], a[224:227], v[24:27], v[168:171]
    v_mfma_f32_16x16x32_bf16 v[172:175], a[228:231], v[16:19], v[172:175]
    v_mfma_f32_16x16x32_bf16 v[176:179], a[228:231], v[20:23], v[176:179]
    v_mfma_f32_16x16x32_bf16 v[180:183], a[228:231], v[24:27], v[180:183]
    v_mfma_f32_16x16x32_bf16 v[184:187], a[232:235], v[16:19], v[184:187]
    v_mfma_f32_16x16x32_bf16 v[188:191], a[232:235], v[20:23], v[188:191]
    v_mfma_f32_16x16x32_bf16 v[192:195], a[232:235], v[24:27], v[192:195]
    v_mfma_f32_16x16x32_bf16 v[196:199], a[236:239], v[16:19], v[196:199]
    v_mfma_f32_16x16x32_bf16 v[200:203], a[236:239], v[20:23], v[200:203]
    v_mfma_f32_16x16x32_bf16 v[204:207], a[236:239], v[24:27], v[204:207]
    v_mfma_f32_16x16x32_bf16 v[208:211], a[240:243], v[16:19], v[208:211]
    v_mfma_f32_16x16x32_bf16 v[212:215], a[240:243], v[20:23], v[212:215]
    v_mfma_f32_16x16x32_bf16 v[216:219], a[240:243], v[24:27], v[216:219]
    v_mfma_f32_16x16x32_bf16 v[220:223], a[244:247], v[16:19], v[220:223]
    v_mfma_f32_16x16x32_bf16 v[224:227], a[244:247], v[20:23], v[224:227]
    v_mfma_f32_16x16x32_bf16 v[228:231], a[244:247], v[24:27], v[228:231]
    v_mfma_f32_16x16x32_bf16 v[232:235], a[248:251], v[16:19], v[232:235]
    v_mfma_f32_16x16x32_bf16 v[236:239], a[248:251], v[20:23], v[236:239]
    v_mfma_f32_16x16x32_bf16 v[240:243], a[248:251], v[24:27], v[240:243]
    v_mfma_f32_16x16x32_bf16 v[244:247], a[252:255], v[16:19], v[244:247]
    v_mfma_f32_16x16x32_bf16 v[248:251], a[252:255], v[20:23], v[248:251]
    v_mfma_f32_16x16x32_bf16 v[252:255], a[252:255], v[24:27], v[252:255]
    v_mfma_f32_16x16x32_bf16 v[148:151], v[12:15], v[16:19], v[148:151]
    v_mfma_f32_16x16x32_bf16 v[152:155], v[12:15], v[20:23], v[152:155]
    v_mfma_f32_16x16x32_bf16 v[156:159], v[12:15], v[24:27], v[156:159]
    s_barrier
    s_add_u32 s58, s58, 1
    s_cmp_lt_u32 s58, 16
    s_cbranch_scc1 A_SLOW2
    s_nop 9
    v_rcp_f32 v8, v148
    s_nop 0
    v_pk_mul_f32 v[160:161], v[160:161], v[8:9] op_sel_hi:[1,0]
    v_pk_mul_f32 v[162:163], v[162:163], v[8:9] op_sel_hi:[1,0]
    v_pk_mul_f32 v[172:173], v[172:173], v[8:9] op_sel_hi:[1,0]
    v_pk_mul_f32 v[174:175], v[174:175], v[8:9] op_sel_hi:[1,0]
    v_cvt_pk_bf16_f32 v40, v160, v161
    v_cvt_pk_bf16_f32 v41, v162, v163
    v_cvt_pk_bf16_f32 v42, v172, v173
    v_cvt_pk_bf16_f32 v43, v174, v175
    buffer_store_dwordx4 v[40:43], v6, s[20:23], s52 offen offset:0
    v_pk_mul_f32 v[184:185], v[184:185], v[8:9] op_sel_hi:[1,0]
    v_pk_mul_f32 v[186:187], v[186:187], v[8:9] op_sel_hi:[1,0]
    v_pk_mul_f32 v[196:197], v[196:197], v[8:9] op_sel_hi:[1,0]
    v_pk_mul_f32 v[198:199], v[198:199], v[8:9] op_sel_hi:[1,0]
    v_cvt_pk_bf16_f32 v44, v184, v185
    v_cvt_pk_bf16_f32 v45, v186, v187
    v_cvt_pk_bf16_f32 v46, v196, v197
    v_cvt_pk_bf16_f32 v47, v198, v199
    buffer_store_dwordx4 v[44:47], v6, s[20:23], s52 offen offset:1024
    v_pk_mul_f32 v[208:209], v[208:209], v[8:9] op_sel_hi:[1,0]
    v_pk_mul_f32 v[210:211], v[210:211], v[8:9] op_sel_hi:[1,0]
    v_pk_mul_f32 v[220:221], v[220:221], v[8:9] op_sel_hi:[1,0]
    v_pk_mul_f32 v[222:223], v[222:223], v[8:9] op_sel_hi:[1,0]
    v_cvt_pk_bf16_f32 v48, v208, v209
    v_cvt_pk_bf16_f32 v49, v210, v211
    v_cvt_pk_bf16_f32 v50, v220, v221
    v_cvt_pk_bf16_f32 v51, v222, v223
    buffer_store_dwordx4 v[48:51], v6, s[20:23], s52 offen offset:2048
    v_pk_mul_f32 v[232:233], v[232:233], v[8:9] op_sel_hi:[1,0]
    v_pk_mul_f32 v[234:235], v[234:235], v[8:9] op_sel_hi:[1,0]
    v_pk_mul_f32 v[244:245], v[244:245], v[8:9] op_sel_hi:[1,0]
    v_pk_mul_f32 v[246:247], v[246:247], v[8:9] op_sel_hi:[1,0]
    v_cvt_pk_bf16_f32 v52, v232, v233
    v_cvt_pk_bf16_f32 v53, v234, v235
    v_cvt_pk_bf16_f32 v54, v244, v245
    v_cvt_pk_bf16_f32 v55, v246, v247
    buffer_store_dwordx4 v[52:55], v6, s[20:23], s52 offen offset:3072
    v_rcp_f32 v10, v152
    s_nop 0
    v_pk_mul_f32 v[164:165], v[164:165], v[10:11] op_sel_hi:[1,0]
    v_pk_mul_f32 v[166:167], v[166:167], v[10:11] op_sel_hi:[1,0]
    v_pk_mul_f32 v[176:177], v[176:177], v[10:11] op_sel_hi:[1,0]
    v_pk_mul_f32 v[178:179], v[178:179], v[10:11] op_sel_hi:[1,0]
    v_cvt_pk_bf16_f32 v56, v164, v165
    v_cvt_pk_bf16_f32 v57, v166, v167
    v_cvt_pk_bf16_f32 v58, v176, v177
    v_cvt_pk_bf16_f32 v59, v178, v179
    buffer_store_dwordx4 v[56:59], v6, s[20:23], s53 offen offset:0
    v_pk_mul_f32 v[188:189], v[188:189], v[10:11] op_sel_hi:[1,0]
    v_pk_mul_f32 v[190:191], v[190:191], v[10:11] op_sel_hi:[1,0]
    v_pk_mul_f32 v[200:201], v[200:201], v[10:11] op_sel_hi:[1,0]
    v_pk_mul_f32 v[202:203], v[202:203], v[10:11] op_sel_hi:[1,0]
    v_cvt_pk_bf16_f32 v60, v188, v189
    v_cvt_pk_bf16_f32 v61, v190, v191
    v_cvt_pk_bf16_f32 v62, v200, v201
    v_cvt_pk_bf16_f32 v63, v202, v203
    buffer_store_dwordx4 v[60:63], v6, s[20:23], s53 offen offset:1024
    v_pk_mul_f32 v[212:213], v[212:213], v[10:11] op_sel_hi:[1,0]
    v_pk_mul_f32 v[214:215], v[214:215], v[10:11] op_sel_hi:[1,0]
    v_pk_mul_f32 v[224:225], v[224:225], v[10:11] op_sel_hi:[1,0]
    v_pk_mul_f32 v[226:227], v[226:227], v[10:11] op_sel_hi:[1,0]
    v_cvt_pk_bf16_f32 v64, v212, v213
    v_cvt_pk_bf16_f32 v65, v214, v215
    v_cvt_pk_bf16_f32 v66, v224, v225
    v_cvt_pk_bf16_f32 v67, v226, v227
    buffer_store_dwordx4 v[64:67], v6, s[20:23], s53 offen offset:2048
    v_pk_mul_f32 v[236:237], v[236:237], v[10:11] op_sel_hi:[1,0]
    v_pk_mul_f32 v[238:239], v[238:239], v[10:11] op_sel_hi:[1,0]
    v_pk_mul_f32 v[248:249], v[248:249], v[10:11] op_sel_hi:[1,0]
    v_pk_mul_f32 v[250:251], v[250:251], v[10:11] op_sel_hi:[1,0]
    v_cvt_pk_bf16_f32 v68, v236, v237
    v_cvt_pk_bf16_f32 v69, v238, v239
    v_cvt_pk_bf16_f32 v70, v248, v249
    v_cvt_pk_bf16_f32 v71, v250, v251
    buffer_store_dwordx4 v[68:71], v6, s[20:23], s53 offen offset:3072
    v_rcp_f32 v28, v156
    s_nop 0
    v_pk_mul_f32 v[168:169], v[168:169], v[28:29] op_sel_hi:[1,0]
    v_pk_mul_f32 v[170:171], v[170:171], v[28:29] op_sel_hi:[1,0]
    v_pk_mul_f32 v[180:181], v[180:181], v[28:29] op_sel_hi:[1,0]
    v_pk_mul_f32 v[182:183], v[182:183], v[28:29] op_sel_hi:[1,0]
    v_cvt_pk_bf16_f32 v72, v168, v169
    v_cvt_pk_bf16_f32 v73, v170, v171
    v_cvt_pk_bf16_f32 v74, v180, v181
    v_cvt_pk_bf16_f32 v75, v182, v183
    buffer_store_dwordx4 v[72:75], v6, s[20:23], s54 offen offset:0
    v_pk_mul_f32 v[192:193], v[192:193], v[28:29] op_sel_hi:[1,0]
    v_pk_mul_f32 v[194:195], v[194:195], v[28:29] op_sel_hi:[1,0]
    v_pk_mul_f32 v[204:205], v[204:205], v[28:29] op_sel_hi:[1,0]
    v_pk_mul_f32 v[206:207], v[206:207], v[28:29] op_sel_hi:[1,0]
    v_cvt_pk_bf16_f32 v76, v192, v193
    v_cvt_pk_bf16_f32 v77, v194, v195
    v_cvt_pk_bf16_f32 v78, v204, v205
    v_cvt_pk_bf16_f32 v79, v206, v207
    buffer_store_dwordx4 v[76:79], v6, s[20:23], s54 offen offset:1024
    v_pk_mul_f32 v[216:217], v[216:217], v[28:29] op_sel_hi:[1,0]
    v_pk_mul_f32 v[218:219], v[218:219], v[28:29] op_sel_hi:[1,0]
    v_pk_mul_f32 v[228:229], v[228:229], v[28:29] op_sel_hi:[1,0]
    v_pk_mul_f32 v[230:231], v[230:231], v[28:29] op_sel_hi:[1,0]
    v_cvt_pk_bf16_f32 v80, v216, v217
    v_cvt_pk_bf16_f32 v81, v218, v219
    v_cvt_pk_bf16_f32 v82, v228, v229
    v_cvt_pk_bf16_f32 v83, v230, v231
    buffer_store_dwordx4 v[80:83], v6, s[20:23], s54 offen offset:2048
    v_pk_mul_f32 v[240:241], v[240:241], v[28:29] op_sel_hi:[1,0]
    v_pk_mul_f32 v[242:243], v[242:243], v[28:29] op_sel_hi:[1,0]
    v_pk_mul_f32 v[252:253], v[252:253], v[28:29] op_sel_hi:[1,0]
    v_pk_mul_f32 v[254:255], v[254:255], v[28:29] op_sel_hi:[1,0]
    v_cvt_pk_bf16_f32 v84, v240, v241
    v_cvt_pk_bf16_f32 v85, v242, v243
    v_cvt_pk_bf16_f32 v86, v252, v253
    v_cvt_pk_bf16_f32 v87, v254, v255
    buffer_store_dwordx4 v[84:87], v6, s[20:23], s54 offen offset:3072
    s_barrier
    s_waitcnt vmcnt(0)
    s_barrier
    ds_read_b64_tr_b16 a[192:193], v3 offset:0
    ds_read_b64_tr_b16 a[194:195], v3 offset:1024
    ds_read_b64_tr_b16 a[196:197], v3 offset:8
    ds_read_b64_tr_b16 a[198:199], v3 offset:1032
    ds_read_b64_tr_b16 a[200:201], v3 offset:256
    ds_read_b64_tr_b16 a[202:203], v3 offset:1280
    ds_read_b64_tr_b16 a[204:205], v3 offset:264
    ds_read_b64_tr_b16 a[206:207], v3 offset:1288
    ds_read_b64_tr_b16 a[208:209], v3 offset:512
    ds_read_b64_tr_b16 a[210:211], v3 offset:1536
    ds_read_b64_tr_b16 a[212:213], v3 offset:520
    ds_read_b64_tr_b16 a[214:215], v3 offset:1544
    ds_read_b64_tr_b16 a[216:217], v3 offset:768
    ds_read_b64_tr_b16 a[218:219], v3 offset:1792
    ds_read_b64_tr_b16 a[220:221], v3 offset:776
    ds_read_b64_tr_b16 a[222:223], v3 offset:1800
    s_waitcnt lgkmcnt(0)
    s_nop 9
    s_branch A_RESUME
A_DONE:
    s_nop 9
    v_mbcnt_lo_u32_b32 v0, -1, 0
    v_mbcnt_hi_u32_b32 v0, -1, v0
    s_waitcnt vmcnt(0) lgkmcnt(0)
    s_barrier
    s_nop 9
    s_mov_b32 s29, s24
    s_load_dwordx2 s[62:63], s[0:1], 88
    s_load_dwordx2 s[32:33], s[0:1], 32
    s_load_dwordx2 s[34:35], s[0:1], 72
    s_load_dwordx2 s[36:37], s[0:1], 80
    s_load_dwordx2 s[38:39], s[0:1], 96
    s_and_b32 s50, s2, 7
    s_lshr_b32 s51, s2, 3
    s_and_b32 s60, s51, 1
    s_lshr_b32 s52, s51, 1
    s_and_b32 s52, s52, 3
    s_lshr_b32 s53, s51, 3
    s_lshl_b32 s54, s50, 2
    s_add_u32 s54, s54, s53
    s_lshr_b32 s55, s54, 4
    s_and_b32 s56, s54, 15
    s_waitcnt lgkmcnt(0)
    s_cmp_eq_u32 s55, 0
    s_cselect_b64 s[32:33], s[32:33], s[34:35]
    s_mul_i32 s57, s54, 0x180000
    s_add_u32 s4, s38, s57
    s_addc_u32 s5, s39, 0
    s_and_b32 s5, s5, 0xffff
    s_mov_b32 s6, 0x180000
    s_mov_b32 s7, 0x20000
    s_lshl_b32 s57, s60, 21
    s_lshl_b32 s58, s52, 8
    s_add_u32 s57, s57, s58
    s_add_u32 s8, s32, s57
    s_addc_u32 s9, s33, 0
    s_and_b32 s9, s9, 0xffff
    s_sub_u32 s10, 0x400000, s57
    s_mov_b32 s11, 0x20000
    s_add_u32 s16, s32, s57
    s_addc_u32 s17, s33, 0
    s_and_b32 s17, s17, 0xffff
    s_sub_u32 s18, 0x400000, s57
    s_mov_b32 s19, 0x20000
    s_lshl_b32 s58, s55, 10
    s_lshl_b32 s59, s52, 8
    s_add_u32 s58, s58, s59
    s_lshl_b32 s59, s60, 7
    s_add_u32 s58, s58, s59
    s_mul_i32 s59, s56, 0x60000
    s_add_u32 s59, s59, s58
    s_add_u32 s12, s36, s59
    s_addc_u32 s13, s37, 0
    s_and_b32 s13, s13, 0xffff
    s_sub_u32 s14, 0x60000, s58
    s_mov_b32 s15, 0x20000
    s_lshr_b32 s57, s2, 4
    s_lshl_b32 s57, s57, 3
    s_add_u32 s57, s57, s50
    s_mov_b32 s61, s57
    s_mul_i32 s57, s57, 98304
    s_add_u32 s57, s57, 0x4000000
    s_add_u32 s20, s38, s57
    s_addc_u32 s21, s39, 0
    s_and_b32 s21, s21, 0xffff
    s_mov_b32 s22, 98304
    s_mov_b32 s23, 0x20000
    s_add_u32 s68, s38, 0x5000000
    s_addc_u32 s69, s39, 0
    s_and_b32 s69, s69, 0xffff
    s_mov_b32 s70, 65536
    s_mov_b32 s71, 0x20000
    v_and_b32 v8, 15, v0
    v_lshrrev_b32 v9, 4, v0
    v_bfe_u32 v10, v0, 2, 2
    v_and_b32 v11, 3, v0
    s_mul_i32 s57, s29, 393216
    s_lshl_b32 s58, s60, 16
    s_add_u32 s57, s57, s58
    v_lshlrev_b32 v12, 4, v0
    v_add_u32 v1, s57, v12
    s_lshl_b32 s57, s29, 3
    v_add_u32 v12, s57, v10
    v_lshlrev_b32 v12, 10, v12
    v_lshl_add_u32 v12, v9, 6, v12
    v_lshl_add_u32 v2, v11, 4, v12
    v_mul_u32_u24 v12, 1056, v9
    v_lshl_add_u32 v12, v10, 6, v12
    v_lshl_add_u32 v3, v11, 3, v12
    s_mul_i32 s57, s29, 48
    v_add_u32 v12, s57, v8
    v_lshlrev_b32 v12, 11, v12
    v_lshl_add_u32 v4, v9, 3, v12
    s_mul_i32 s57, s29, 12288
    v_lshlrev_b32 v12, 4, v0
    v_add_u32 v5, s57, v12
    s_mul_i32 s28, s29, 2112
    s_xor_b32 s66, s2, 8
    s_lshl_b32 s66, s66, 7
    v_mov_b32 v7, s66
    s_mov_b32 s44, 0
    s_lshl_b32 s40, s44, 14
    s_lshl_b32 s42, s44, 19
    s_mov_b32 s64, s62
    s_and_b32 s65, s63, 0xffff
    s_mov_b32 s66, 256
    s_mov_b32 s67, 0x20000
    s_lshl_b32 s57, s54, 3
    v_mov_b32 v8, s57
    s_lshl_b32 s57, s54, 7
    s_add_u32 s57, s57, 32768
    v_mov_b32 v10, s57
    s_mov_b32 s57, 0
B_G1:
    buffer_load_dword v9, v8, s[64:67], 0 offen sc0 sc1
    s_waitcnt vmcnt(0)
    v_readfirstlane_b32 s58, v9
    s_nop 3
B_G1T:
    s_and_b32 s59, s58, 0x0f0f0f0f
    s_lshr_b32 s56, s58, 4
    s_and_b32 s56, s56, 0x0f0f0f0f
    s_add_u32 s59, s59, s56
    s_mul_i32 s59, s59, 0x01010101
    s_lshr_b32 s59, s59, 24
    s_add_u32 s57, s57, 1
    s_cmp_ge_u32 s59, 8
    s_cbranch_scc1 B_G1OK
    s_cmp_lt_u32 s57, 0x40000
    s_cbranch_scc1 B_G1
B_G1OK:
    s_and_b32 s58, s58, 0x88888888
    s_cmp_lg_u32 s58, 0
    s_cselect_b32 s67, 1, 0
    s_cmp_lg_u32 s29, 0
    s_cbranch_scc1 B_SIGNED
    s_cmp_eq_u32 s67, 1
    s_cbranch_scc1 B_NOWB
    buffer_wbl2 sc1
    s_waitcnt vmcnt(0)
B_NOWB:
    v_mov_b32 v9, 1
    v_cmp_eq_u32 vcc, 0, v0
    s_nop 3
    s_and_saveexec_b64 s[46:47], vcc
    buffer_atomic_add v9, v10, s[68:71], 0 offen
    s_mov_b64 exec, s[46:47]
B_SIGNED:
    s_nop 9
    s_add_u32 m0, s28, 0
    s_add_u32 s27, s42, 0
    buffer_load_dwordx4 v2, s[16:19], s27 offen lds
    s_add_u32 m0, s28, 1056
    s_add_u32 s27, s42, 4096
    buffer_load_dwordx4 v2, s[16:19], s27 offen lds
    s_add_u32 m0, s28, 8448
    s_add_u32 s27, s42, 32768
    buffer_load_dwordx4 v2, s[16:19], s27 offen lds
    s_add_u32 m0, s28, 9504
    s_add_u32 s27, s42, 36864
    buffer_load_dwordx4 v2, s[16:19], s27 offen lds
    s_add_u32 m0, s28, 16896
    s_add_u32 s27, s42, 65536
    buffer_load_dwordx4 v2, s[16:19], s27 offen lds
    s_add_u32 m0, s28, 17952
    s_add_u32 s27, s42, 69632
    buffer_load_dwordx4 v2, s[16:19], s27 offen lds
    s_add_u32 m0, s28, 25344
    s_add_u32 s27, s42, 98304
    buffer_load_dwordx4 v2, s[16:19], s27 offen lds
    s_add_u32 m0, s28, 26400
    s_add_u32 s27, s42, 102400
    buffer_load_dwordx4 v2, s[16:19], s27 offen lds
    s_add_u32 m0, s28, 33792
    s_add_u32 s27, s42, 131072
    buffer_load_dwordx4 v2, s[16:19], s27 offen lds
    s_add_u32 m0, s28, 34848
    s_add_u32 s27, s42, 135168
    buffer_load_dwordx4 v2, s[16:19], s27 offen lds
    s_add_u32 m0, s28, 42240
    s_add_u32 s27, s42, 163840
    buffer_load_dwordx4 v2, s[16:19], s27 offen lds
    s_add_u32 m0, s28, 43296
    s_add_u32 s27, s42, 167936
    buffer_load_dwordx4 v2, s[16:19], s27 offen lds
    s_add_u32 m0, s28, 50688
    s_add_u32 s27, s42, 196608
    buffer_load_dwordx4 v2, s[16:19], s27 offen lds
    s_add_u32 m0, s28, 51744
    s_add_u32 s27, s42, 200704
    buffer_load_dwordx4 v2, s[16:19], s27 offen lds
    s_add_u32 m0, s28, 59136
    s_add_u32 s27, s42, 229376
    buffer_load_dwordx4 v2, s[16:19], s27 offen lds
    s_add_u32 m0, s28, 60192
    s_add_u32 s27, s42, 233472
    buffer_load_dwordx4 v2, s[16:19], s27 offen lds
    v_mov_b32 v160, 0
    v_mov_b32 v161, 0
    v_mov_b32 v162, 0
    v_mov_b32 v163, 0
    v_mov_b32 v164, 0
    v_mov_b32 v165, 0
    v_mov_b32 v166, 0
    v_mov_b32 v167, 0
    v_mov_b32 v168, 0
    v_mov_b32 v169, 0
    v_mov_b32 v170, 0
    v_mov_b32 v171, 0
    v_mov_b32 v172, 0
    v_mov_b32 v173, 0
    v_mov_b32 v174, 0
    v_mov_b32 v175, 0
    v_mov_b32 v176, 0
    v_mov_b32 v177, 0
    v_mov_b32 v178, 0
    v_mov_b32 v179, 0
    v_mov_b32 v180, 0
    v_mov_b32 v181, 0
    v_mov_b32 v182, 0
    v_mov_b32 v183, 0
    v_mov_b32 v184, 0
    v_mov_b32 v185, 0
    v_mov_b32 v186, 0
    v_mov_b32 v187, 0
    v_mov_b32 v188, 0
    v_mov_b32 v189, 0
    v_mov_b32 v190, 0
    v_mov_b32 v191, 0
    v_mov_b32 v192, 0
    v_mov_b32 v193, 0
    v_mov_b32 v194, 0
    v_mov_b32 v195, 0
    v_mov_b32 v196, 0
    v_mov_b32 v197, 0
    v_mov_b32 v198, 0
    v_mov_b32 v199, 0
    v_mov_b32 v200, 0
    v_mov_b32 v201, 0
    v_mov_b32 v202, 0
    v_mov_b32 v203, 0
    v_mov_b32 v204, 0
    v_mov_b32 v205, 0
    v_mov_b32 v206, 0
    v_mov_b32 v207, 0
    v_mov_b32 v208, 0
    v_mov_b32 v209, 0
    v_mov_b32 v210, 0
    v_mov_b32 v211, 0
    v_mov_b32 v212, 0
    v_mov_b32 v213, 0
    v_mov_b32 v214, 0
    v_mov_b32 v215, 0
    v_mov_b32 v216, 0
    v_mov_b32 v217, 0
    v_mov_b32 v218, 0
    v_mov_b32 v219, 0
    v_mov_b32 v220, 0
    v_mov_b32 v221, 0
    v_mov_b32 v222, 0
    v_mov_b32 v223, 0
    v_mov_b32 v224, 0
    v_mov_b32 v225, 0
    v_mov_b32 v226, 0
    v_mov_b32 v227, 0
    v_mov_b32 v228, 0
    v_mov_b32 v229, 0
    v_mov_b32 v230, 0
    v_mov_b32 v231, 0
    v_mov_b32 v232, 0
    v_mov_b32 v233, 0
    v_mov_b32 v234, 0
    v_mov_b32 v235, 0
    v_mov_b32 v236, 0
    v_mov_b32 v237, 0
    v_mov_b32 v238, 0
    v_mov_b32 v239, 0
    v_mov_b32 v240, 0
    v_mov_b32 v241, 0
    v_mov_b32 v242, 0
    v_mov_b32 v243, 0
    v_mov_b32 v244, 0
    v_mov_b32 v245, 0
    v_mov_b32 v246, 0
    v_mov_b32 v247, 0
    v_mov_b32 v248, 0
    v_mov_b32 v249, 0
    v_mov_b32 v250, 0
    v_mov_b32 v251, 0
    v_mov_b32 v252, 0
    v_mov_b32 v253, 0
    v_mov_b32 v254, 0
    v_mov_b32 v255, 0
    s_cmp_lg_u32 s29, 0
    s_cbranch_scc1 B_GWAIT
    s_mov_b32 s57, 0
B_GPOLL:
    buffer_load_dword v9, v10, s[68:71], 0 offen sc0 sc1
    s_waitcnt vmcnt(0)
    v_readfirstlane_b32 s58, v9
    s_add_u32 s57, s57, 1
    s_nop 2
    s_cmp_ge_u32 s58, 8
    s_cbranch_scc1 B_GWAIT
    s_cmp_lt_u32 s57, 0x40000
    s_cbranch_scc1 B_GPOLL
B_GWAIT:
    s_barrier
    s_nop 9
    s_cmp_eq_u32 s67, 1
    s_cbranch_scc1 B_NOINV
    buffer_inv sc1
    s_waitcnt vmcnt(0)
B_NOINV:
    s_nop 9
    s_add_u32 s24, s40, 0
    buffer_load_dwordx4 a[0:3], v1, s[4:7], s24 offen offset:0
    s_add_u32 s25, s40, 131072
    buffer_load_dwordx4 a[4:7], v1, s[4:7], s25 offen offset:0
    s_add_u32 s26, s40, 262144
    buffer_load_dwordx4 a[8:11], v1, s[4:7], s26 offen offset:0
    buffer_load_dwordx4 a[12:15], v1, s[4:7], s24 offen offset:1024
    buffer_load_dwordx4 a[16:19], v1, s[4:7], s25 offen offset:1024
    buffer_load_dwordx4 a[20:23], v1, s[4:7], s26 offen offset:1024
    buffer_load_dwordx4 a[24:27], v1, s[4:7], s24 offen offset:2048
    buffer_load_dwordx4 a[28:31], v1, s[4:7], s25 offen offset:2048
    buffer_load_dwordx4 a[32:35], v1, s[4:7], s26 offen offset:2048
    buffer_load_dwordx4 a[36:39], v1, s[4:7], s24 offen offset:3072
    buffer_load_dwordx4 a[40:43], v1, s[4:7], s25 offen offset:3072
    buffer_load_dwordx4 a[44:47], v1, s[4:7], s26 offen offset:3072
    s_add_u32 s24, s40, 4096
    buffer_load_dwordx4 a[48:51], v1, s[4:7], s24 offen offset:0
    s_add_u32 s25, s40, 135168
    buffer_load_dwordx4 a[52:55], v1, s[4:7], s25 offen offset:0
    s_add_u32 s26, s40, 266240
    buffer_load_dwordx4 a[56:59], v1, s[4:7], s26 offen offset:0
    buffer_load_dwordx4 a[60:63], v1, s[4:7], s24 offen offset:1024
    buffer_load_dwordx4 a[64:67], v1, s[4:7], s25 offen offset:1024
    buffer_load_dwordx4 a[68:71], v1, s[4:7], s26 offen offset:1024
    buffer_load_dwordx4 a[72:75], v1, s[4:7], s24 offen offset:2048
    buffer_load_dwordx4 a[76:79], v1, s[4:7], s25 offen offset:2048
    buffer_load_dwordx4 a[80:83], v1, s[4:7], s26 offen offset:2048
    buffer_load_dwordx4 a[84:87], v1, s[4:7], s24 offen offset:3072
    buffer_load_dwordx4 a[88:91], v1, s[4:7], s25 offen offset:3072
    buffer_load_dwordx4 a[92:95], v1, s[4:7], s26 offen offset:3072
    s_waitcnt vmcnt(12)
    s_waitcnt vmcnt(36)
    s_barrier
    ds_read_b64_tr_b16 a[192:193], v3 offset:0
    ds_read_b64_tr_b16 a[194:195], v3 offset:4224
    ds_read_b64_tr_b16 a[196:197], v3 offset:32
    ds_read_b64_tr_b16 a[198:199], v3 offset:4256
    ds_read_b64_tr_b16 a[200:201], v3 offset:256
    ds_read_b64_tr_b16 a[202:203], v3 offset:4480
    ds_read_b64_tr_b16 a[204:205], v3 offset:288
    ds_read_b64_tr_b16 a[206:207], v3 offset:4512
    ds_read_b64_tr_b16 a[208:209], v3 offset:512
    ds_read_b64_tr_b16 a[210:211], v3 offset:4736
    ds_read_b64_tr_b16 a[212:213], v3 offset:544
    ds_read_b64_tr_b16 a[214:215], v3 offset:4768
    ds_read_b64_tr_b16 a[216:217], v3 offset:768
    ds_read_b64_tr_b16 a[218:219], v3 offset:4992
    ds_read_b64_tr_b16 a[220:221], v3 offset:800
    ds_read_b64_tr_b16 a[222:223], v3 offset:5024
    s_mov_b32 s43, 0
B_LOOP:
    s_mov_b32 s41, s42
    s_mov_b32 s45, s40
    s_add_u32 s44, s44, 1
    s_and_b32 s44, s44, 3
    s_lshl_b32 s40, s44, 14
    s_lshl_b32 s42, s44, 19
    s_cmp_eq_u32 s43, 3
    s_cselect_b32 s40, 0x7ffffff0, s40
    s_cselect_b32 s18, 0, s18
    s_waitcnt lgkmcnt(0)
    s_waitcnt vmcnt(16)
    s_barrier
    v_add_u32 v3, 0x2100, v3
    v_mfma_f32_16x16x32_bf16 v[160:163], a[192:195], a[0:3], v[160:163]
    ds_read_b64_tr_b16 a[224:225], v3 offset:0
    v_mfma_f32_16x16x32_bf16 v[172:175], a[196:199], a[0:3], v[172:175]
    ds_read_b64_tr_b16 a[226:227], v3 offset:4224
    v_mfma_f32_16x16x32_bf16 v[184:187], a[200:203], a[0:3], v[184:187]
    ds_read_b64_tr_b16 a[228:229], v3 offset:32
    v_mfma_f32_16x16x32_bf16 v[196:199], a[204:207], a[0:3], v[196:199]
    ds_read_b64_tr_b16 a[230:231], v3 offset:4256
    v_mfma_f32_16x16x32_bf16 v[208:211], a[208:211], a[0:3], v[208:211]
    ds_read_b64_tr_b16 a[232:233], v3 offset:256
    v_mfma_f32_16x16x32_bf16 v[220:223], a[212:215], a[0:3], v[220:223]
    ds_read_b64_tr_b16 a[234:235], v3 offset:4480
    v_mfma_f32_16x16x32_bf16 v[232:235], a[216:219], a[0:3], v[232:235]
    ds_read_b64_tr_b16 a[236:237], v3 offset:288
    v_mfma_f32_16x16x32_bf16 v[244:247], a[220:223], a[0:3], v[244:247]
    ds_read_b64_tr_b16 a[238:239], v3 offset:4512
    v_mfma_f32_16x16x32_bf16 v[164:167], a[192:195], a[4:7], v[164:167]
    s_add_u32 s24, s45, 8192
    buffer_load_dwordx4 a[0:3], v1, s[4:7], s24 offen offset:0
    v_mfma_f32_16x16x32_bf16 v[176:179], a[196:199], a[4:7], v[176:179]
    ds_read_b64_tr_b16 a[240:241], v3 offset:512
    v_mfma_f32_16x16x32_bf16 v[188:191], a[200:203], a[4:7], v[188:191]
    ds_read_b64_tr_b16 a[242:243], v3 offset:4736
    v_mfma_f32_16x16x32_bf16 v[200:203], a[204:207], a[4:7], v[200:203]
    ds_read_b64_tr_b16 a[244:245], v3 offset:544
    v_mfma_f32_16x16x32_bf16 v[212:215], a[208:211], a[4:7], v[212:215]
    ds_read_b64_tr_b16 a[246:247], v3 offset:4768
    v_mfma_f32_16x16x32_bf16 v[224:227], a[212:215], a[4:7], v[224:227]
    ds_read_b64_tr_b16 a[248:249], v3 offset:768
    v_mfma_f32_16x16x32_bf16 v[236:239], a[216:219], a[4:7], v[236:239]
    ds_read_b64_tr_b16 a[250:251], v3 offset:4992
    v_mfma_f32_16x16x32_bf16 v[248:251], a[220:223], a[4:7], v[248:251]
    ds_read_b64_tr_b16 a[252:253], v3 offset:800
    v_mfma_f32_16x16x32_bf16 v[168:171], a[192:195], a[8:11], v[168:171]
    s_add_u32 s25, s45, 139264
    buffer_load_dwordx4 a[4:7], v1, s[4:7], s25 offen offset:0
    v_mfma_f32_16x16x32_bf16 v[180:183], a[196:199], a[8:11], v[180:183]
    ds_read_b64_tr_b16 a[254:255], v3 offset:5024
    v_mfma_f32_16x16x32_bf16 v[192:195], a[200:203], a[8:11], v[192:195]
    s_add_u32 m0, s28, 67584
    v_mfma_f32_16x16x32_bf16 v[204:207], a[204:207], a[8:11], v[204:207]
    s_add_u32 s27, s41, 262144
    buffer_load_dwordx4 v2, s[8:11], s27 offen lds
    v_mfma_f32_16x16x32_bf16 v[216:219], a[208:211], a[8:11], v[216:219]
    s_add_u32 m0, s28, 68640
    v_mfma_f32_16x16x32_bf16 v[228:231], a[212:215], a[8:11], v[228:231]
    s_add_u32 s27, s41, 266240
    v_mfma_f32_16x16x32_bf16 v[240:243], a[216:219], a[8:11], v[240:243]
    buffer_load_dwordx4 v2, s[8:11], s27 offen lds
    v_mfma_f32_16x16x32_bf16 v[252:255], a[220:223], a[8:11], v[252:255]
    s_add_u32 s26, s45, 270336
    buffer_load_dwordx4 a[8:11], v1, s[4:7], s26 offen offset:0
    s_waitcnt lgkmcnt(0)
    v_add_u32 v3, 0x2100, v3
    v_mfma_f32_16x16x32_bf16 v[160:163], a[224:227], a[12:15], v[160:163]
    ds_read_b64_tr_b16 a[192:193], v3 offset:0
    v_mfma_f32_16x16x32_bf16 v[172:175], a[228:231], a[12:15], v[172:175]
    ds_read_b64_tr_b16 a[194:195], v3 offset:4224
    v_mfma_f32_16x16x32_bf16 v[184:187], a[232:235], a[12:15], v[184:187]
    ds_read_b64_tr_b16 a[196:197], v3 offset:32
    v_mfma_f32_16x16x32_bf16 v[196:199], a[236:239], a[12:15], v[196:199]
    ds_read_b64_tr_b16 a[198:199], v3 offset:4256
    v_mfma_f32_16x16x32_bf16 v[208:211], a[240:243], a[12:15], v[208:211]
    ds_read_b64_tr_b16 a[200:201], v3 offset:256
    v_mfma_f32_16x16x32_bf16 v[220:223], a[244:247], a[12:15], v[220:223]
    ds_read_b64_tr_b16 a[202:203], v3 offset:4480
    v_mfma_f32_16x16x32_bf16 v[232:235], a[248:251], a[12:15], v[232:235]
    ds_read_b64_tr_b16 a[204:205], v3 offset:288
    v_mfma_f32_16x16x32_bf16 v[244:247], a[252:255], a[12:15], v[244:247]
    ds_read_b64_tr_b16 a[206:207], v3 offset:4512
    v_mfma_f32_16x16x32_bf16 v[164:167], a[224:227], a[16:19], v[164:167]
    buffer_load_dwordx4 a[12:15], v1, s[4:7], s24 offen offset:1024
    v_mfma_f32_16x16x32_bf16 v[176:179], a[228:231], a[16:19], v[176:179]
    ds_read_b64_tr_b16 a[208:209], v3 offset:512
    v_mfma_f32_16x16x32_bf16 v[188:191], a[232:235], a[16:19], v[188:191]
    ds_read_b64_tr_b16 a[210:211], v3 offset:4736
    v_mfma_f32_16x16x32_bf16 v[200:203], a[236:239], a[16:19], v[200:203]
    ds_read_b64_tr_b16 a[212:213], v3 offset:544
    v_mfma_f32_16x16x32_bf16 v[212:215], a[240:243], a[16:19], v[212:215]
    ds_read_b64_tr_b16 a[214:215], v3 offset:4768
    v_mfma_f32_16x16x32_bf16 v[224:227], a[244:247], a[16:19], v[224:227]
    ds_read_b64_tr_b16 a[216:217], v3 offset:768
    v_mfma_f32_16x16x32_bf16 v[236:239], a[248:251], a[16:19], v[236:239]
    ds_read_b64_tr_b16 a[218:219], v3 offset:4992
    v_mfma_f32_16x16x32_bf16 v[248:251], a[252:255], a[16:19], v[248:251]
    ds_read_b64_tr_b16 a[220:221], v3 offset:800
    v_mfma_f32_16x16x32_bf16 v[168:171], a[224:227], a[20:23], v[168:171]
    buffer_load_dwordx4 a[16:19], v1, s[4:7], s25 offen offset:1024
    v_mfma_f32_16x16x32_bf16 v[180:183], a[228:231], a[20:23], v[180:183]
    ds_read_b64_tr_b16 a[222:223], v3 offset:5024
    v_mfma_f32_16x16x32_bf16 v[192:195], a[232:235], a[20:23], v[192:195]
    s_add_u32 m0, s28, 76032
    v_mfma_f32_16x16x32_bf16 v[204:207], a[236:239], a[20:23], v[204:207]
    s_add_u32 s27, s41, 294912
    buffer_load_dwordx4 v2, s[8:11], s27 offen lds
    v_mfma_f32_16x16x32_bf16 v[216:219], a[240:243], a[20:23], v[216:219]
    s_add_u32 m0, s28, 77088
    v_mfma_f32_16x16x32_bf16 v[228:231], a[244:247], a[20:23], v[228:231]
    s_add_u32 s27, s41, 299008
    v_mfma_f32_16x16x32_bf16 v[240:243], a[248:251], a[20:23], v[240:243]
    buffer_load_dwordx4 v2, s[8:11], s27 offen lds
    v_mfma_f32_16x16x32_bf16 v[252:255], a[252:255], a[20:23], v[252:255]
    buffer_load_dwordx4 a[20:23], v1, s[4:7], s26 offen offset:1024
    s_waitcnt lgkmcnt(0)
    v_add_u32 v3, 0x2100, v3
    v_mfma_f32_16x16x32_bf16 v[160:163], a[192:195], a[24:27], v[160:163]
    ds_read_b64_tr_b16 a[224:225], v3 offset:0
    v_mfma_f32_16x16x32_bf16 v[172:175], a[196:199], a[24:27], v[172:175]
    ds_read_b64_tr_b16 a[226:227], v3 offset:4224
    v_mfma_f32_16x16x32_bf16 v[184:187], a[200:203], a[24:27], v[184:187]
    ds_read_b64_tr_b16 a[228:229], v3 offset:32
    v_mfma_f32_16x16x32_bf16 v[196:199], a[204:207], a[24:27], v[196:199]
    ds_read_b64_tr_b16 a[230:231], v3 offset:4256
    v_mfma_f32_16x16x32_bf16 v[208:211], a[208:211], a[24:27], v[208:211]
    ds_read_b64_tr_b16 a[232:233], v3 offset:256
    v_mfma_f32_16x16x32_bf16 v[220:223], a[212:215], a[24:27], v[220:223]
    ds_read_b64_tr_b16 a[234:235], v3 offset:4480
    v_mfma_f32_16x16x32_bf16 v[232:235], a[216:219], a[24:27], v[232:235]
    ds_read_b64_tr_b16 a[236:237], v3 offset:288
    v_mfma_f32_16x16x32_bf16 v[244:247], a[220:223], a[24:27], v[244:247]
    ds_read_b64_tr_b16 a[238:239], v3 offset:4512
    v_mfma_f32_16x16x32_bf16 v[164:167], a[192:195], a[28:31], v[164:167]
    buffer_load_dwordx4 a[24:27], v1, s[4:7], s24 offen offset:2048
    v_mfma_f32_16x16x32_bf16 v[176:179], a[196:199], a[28:31], v[176:179]
    ds_read_b64_tr_b16 a[240:241], v3 offset:512
    v_mfma_f32_16x16x32_bf16 v[188:191], a[200:203], a[28:31], v[188:191]
    ds_read_b64_tr_b16 a[242:243], v3 offset:4736
    v_mfma_f32_16x16x32_bf16 v[200:203], a[204:207], a[28:31], v[200:203]
    ds_read_b64_tr_b16 a[244:245], v3 offset:544
    v_mfma_f32_16x16x32_bf16 v[212:215], a[208:211], a[28:31], v[212:215]
    ds_read_b64_tr_b16 a[246:247], v3 offset:4768
    v_mfma_f32_16x16x32_bf16 v[224:227], a[212:215], a[28:31], v[224:227]
    ds_read_b64_tr_b16 a[248:249], v3 offset:768
    v_mfma_f32_16x16x32_bf16 v[236:239], a[216:219], a[28:31], v[236:239]
    ds_read_b64_tr_b16 a[250:251], v3 offset:4992
    v_mfma_f32_16x16x32_bf16 v[248:251], a[220:223], a[28:31], v[248:251]
    ds_read_b64_tr_b16 a[252:253], v3 offset:800
    v_mfma_f32_16x16x32_bf16 v[168:171], a[192:195], a[32:35], v[168:171]
    buffer_load_dwordx4 a[28:31], v1, s[4:7], s25 offen offset:2048
    v_mfma_f32_16x16x32_bf16 v[180:183], a[196:199], a[32:35], v[180:183]
    ds_read_b64_tr_b16 a[254:255], v3 offset:5024
    v_mfma_f32_16x16x32_bf16 v[192:195], a[200:203], a[32:35], v[192:195]
    s_add_u32 m0, s28, 84480
    v_mfma_f32_16x16x32_bf16 v[204:207], a[204:207], a[32:35], v[204:207]
    s_add_u32 s27, s41, 327680
    buffer_load_dwordx4 v2, s[8:11], s27 offen lds
    v_mfma_f32_16x16x32_bf16 v[216:219], a[208:211], a[32:35], v[216:219]
    s_add_u32 m0, s28, 85536
    v_mfma_f32_16x16x32_bf16 v[228:231], a[212:215], a[32:35], v[228:231]
    s_add_u32 s27, s41, 331776
    v_mfma_f32_16x16x32_bf16 v[240:243], a[216:219], a[32:35], v[240:243]
    buffer_load_dwordx4 v2, s[8:11], s27 offen lds
    v_mfma_f32_16x16x32_bf16 v[252:255], a[220:223], a[32:35], v[252:255]
    buffer_load_dwordx4 a[32:35], v1, s[4:7], s26 offen offset:2048
    s_waitcnt lgkmcnt(0)
    v_add_u32 v3, 0x2100, v3
    v_mfma_f32_16x16x32_bf16 v[160:163], a[224:227], a[36:39], v[160:163]
    ds_read_b64_tr_b16 a[192:193], v3 offset:0
    v_mfma_f32_16x16x32_bf16 v[172:175], a[228:231], a[36:39], v[172:175]
    ds_read_b64_tr_b16 a[194:195], v3 offset:4224
    v_mfma_f32_16x16x32_bf16 v[184:187], a[232:235], a[36:39], v[184:187]
    ds_read_b64_tr_b16 a[196:197], v3 offset:32
    v_mfma_f32_16x16x32_bf16 v[196:199], a[236:239], a[36:39], v[196:199]
    ds_read_b64_tr_b16 a[198:199], v3 offset:4256
    v_mfma_f32_16x16x32_bf16 v[208:211], a[240:243], a[36:39], v[208:211]
    ds_read_b64_tr_b16 a[200:201], v3 offset:256
    v_mfma_f32_16x16x32_bf16 v[220:223], a[244:247], a[36:39], v[220:223]
    ds_read_b64_tr_b16 a[202:203], v3 offset:4480
    v_mfma_f32_16x16x32_bf16 v[232:235], a[248:251], a[36:39], v[232:235]
    ds_read_b64_tr_b16 a[204:205], v3 offset:288
    v_mfma_f32_16x16x32_bf16 v[244:247], a[252:255], a[36:39], v[244:247]
    ds_read_b64_tr_b16 a[206:207], v3 offset:4512
    v_mfma_f32_16x16x32_bf16 v[164:167], a[224:227], a[40:43], v[164:167]
    buffer_load_dwordx4 a[36:39], v1, s[4:7], s24 offen offset:3072
    v_mfma_f32_16x16x32_bf16 v[176:179], a[228:231], a[40:43], v[176:179]
    ds_read_b64_tr_b16 a[208:209], v3 offset:512
    v_mfma_f32_16x16x32_bf16 v[188:191], a[232:235], a[40:43], v[188:191]
    ds_read_b64_tr_b16 a[210:211], v3 offset:4736
    v_mfma_f32_16x16x32_bf16 v[200:203], a[236:239], a[40:43], v[200:203]
    ds_read_b64_tr_b16 a[212:213], v3 offset:544
    v_mfma_f32_16x16x32_bf16 v[212:215], a[240:243], a[40:43], v[212:215]
    ds_read_b64_tr_b16 a[214:215], v3 offset:4768
    v_mfma_f32_16x16x32_bf16 v[224:227], a[244:247], a[40:43], v[224:227]
    ds_read_b64_tr_b16 a[216:217], v3 offset:768
    v_mfma_f32_16x16x32_bf16 v[236:239], a[248:251], a[40:43], v[236:239]
    ds_read_b64_tr_b16 a[218:219], v3 offset:4992
    v_mfma_f32_16x16x32_bf16 v[248:251], a[252:255], a[40:43], v[248:251]
    ds_read_b64_tr_b16 a[220:221], v3 offset:800
    v_mfma_f32_16x16x32_bf16 v[168:171], a[224:227], a[44:47], v[168:171]
    buffer_load_dwordx4 a[40:43], v1, s[4:7], s25 offen offset:3072
    v_mfma_f32_16x16x32_bf16 v[180:183], a[228:231], a[44:47], v[180:183]
    ds_read_b64_tr_b16 a[222:223], v3 offset:5024
    v_mfma_f32_16x16x32_bf16 v[192:195], a[232:235], a[44:47], v[192:195]
    s_add_u32 m0, s28, 92928
    v_mfma_f32_16x16x32_bf16 v[204:207], a[236:239], a[44:47], v[204:207]
    s_add_u32 s27, s41, 360448
    buffer_load_dwordx4 v2, s[8:11], s27 offen lds
    v_mfma_f32_16x16x32_bf16 v[216:219], a[240:243], a[44:47], v[216:219]
    s_add_u32 m0, s28, 93984
    v_mfma_f32_16x16x32_bf16 v[228:231], a[244:247], a[44:47], v[228:231]
    s_add_u32 s27, s41, 364544
    v_mfma_f32_16x16x32_bf16 v[240:243], a[248:251], a[44:47], v[240:243]
    buffer_load_dwordx4 v2, s[8:11], s27 offen lds
    v_mfma_f32_16x16x32_bf16 v[252:255], a[252:255], a[44:47], v[252:255]
    buffer_load_dwordx4 a[44:47], v1, s[4:7], s26 offen offset:3072
    s_waitcnt lgkmcnt(0)
    s_waitcnt vmcnt(16)
    s_barrier
    v_add_u32 v3, 0x2100, v3
    v_mfma_f32_16x16x32_bf16 v[160:163], a[192:195], a[48:51], v[160:163]
    ds_read_b64_tr_b16 a[224:225], v3 offset:0
    v_mfma_f32_16x16x32_bf16 v[172:175], a[196:199], a[48:51], v[172:175]
    ds_read_b64_tr_b16 a[226:227], v3 offset:4224
    v_mfma_f32_16x16x32_bf16 v[184:187], a[200:203], a[48:51], v[184:187]
    ds_read_b64_tr_b16 a[228:229], v3 offset:32
    v_mfma_f32_16x16x32_bf16 v[196:199], a[204:207], a[48:51], v[196:199]
    ds_read_b64_tr_b16 a[230:231], v3 offset:4256
    v_mfma_f32_16x16x32_bf16 v[208:211], a[208:211], a[48:51], v[208:211]
    ds_read_b64_tr_b16 a[232:233], v3 offset:256
    v_mfma_f32_16x16x32_bf16 v[220:223], a[212:215], a[48:51], v[220:223]
    ds_read_b64_tr_b16 a[234:235], v3 offset:4480
    v_mfma_f32_16x16x32_bf16 v[232:235], a[216:219], a[48:51], v[232:235]
    ds_read_b64_tr_b16 a[236:237], v3 offset:288
    v_mfma_f32_16x16x32_bf16 v[244:247], a[220:223], a[48:51], v[244:247]
    ds_read_b64_tr_b16 a[238:239], v3 offset:4512
    v_mfma_f32_16x16x32_bf16 v[164:167], a[192:195], a[52:55], v[164:167]
    s_add_u32 s24, s45, 12288
    buffer_load_dwordx4 a[48:51], v1, s[4:7], s24 offen offset:0
    v_mfma_f32_16x16x32_bf16 v[176:179], a[196:199], a[52:55], v[176:179]
    ds_read_b64_tr_b16 a[240:241], v3 offset:512
    v_mfma_f32_16x16x32_bf16 v[188:191], a[200:203], a[52:55], v[188:191]
    ds_read_b64_tr_b16 a[242:243], v3 offset:4736
    v_mfma_f32_16x16x32_bf16 v[200:203], a[204:207], a[52:55], v[200:203]
    ds_read_b64_tr_b16 a[244:245], v3 offset:544
    v_mfma_f32_16x16x32_bf16 v[212:215], a[208:211], a[52:55], v[212:215]
    ds_read_b64_tr_b16 a[246:247], v3 offset:4768
    v_mfma_f32_16x16x32_bf16 v[224:227], a[212:215], a[52:55], v[224:227]
    ds_read_b64_tr_b16 a[248:249], v3 offset:768
    v_mfma_f32_16x16x32_bf16 v[236:239], a[216:219], a[52:55], v[236:239]
    ds_read_b64_tr_b16 a[250:251], v3 offset:4992
    v_mfma_f32_16x16x32_bf16 v[248:251], a[220:223], a[52:55], v[248:251]
    ds_read_b64_tr_b16 a[252:253], v3 offset:800
    v_mfma_f32_16x16x32_bf16 v[168:171], a[192:195], a[56:59], v[168:171]
    s_add_u32 s25, s45, 143360
    buffer_load_dwordx4 a[52:55], v1, s[4:7], s25 offen offset:0
    v_mfma_f32_16x16x32_bf16 v[180:183], a[196:199], a[56:59], v[180:183]
    ds_read_b64_tr_b16 a[254:255], v3 offset:5024
    v_mfma_f32_16x16x32_bf16 v[192:195], a[200:203], a[56:59], v[192:195]
    s_add_u32 m0, s28, 101376
    v_mfma_f32_16x16x32_bf16 v[204:207], a[204:207], a[56:59], v[204:207]
    s_add_u32 s27, s41, 393216
    buffer_load_dwordx4 v2, s[8:11], s27 offen lds
    v_mfma_f32_16x16x32_bf16 v[216:219], a[208:211], a[56:59], v[216:219]
    s_add_u32 m0, s28, 102432
    v_mfma_f32_16x16x32_bf16 v[228:231], a[212:215], a[56:59], v[228:231]
    s_add_u32 s27, s41, 397312
    v_mfma_f32_16x16x32_bf16 v[240:243], a[216:219], a[56:59], v[240:243]
    buffer_load_dwordx4 v2, s[8:11], s27 offen lds
    v_mfma_f32_16x16x32_bf16 v[252:255], a[220:223], a[56:59], v[252:255]
    s_add_u32 s26, s45, 274432
    buffer_load_dwordx4 a[56:59], v1, s[4:7], s26 offen offset:0
    s_waitcnt lgkmcnt(0)
    v_add_u32 v3, 0x2100, v3
    v_mfma_f32_16x16x32_bf16 v[160:163], a[224:227], a[60:63], v[160:163]
    ds_read_b64_tr_b16 a[192:193], v3 offset:0
    v_mfma_f32_16x16x32_bf16 v[172:175], a[228:231], a[60:63], v[172:175]
    ds_read_b64_tr_b16 a[194:195], v3 offset:4224
    v_mfma_f32_16x16x32_bf16 v[184:187], a[232:235], a[60:63], v[184:187]
    ds_read_b64_tr_b16 a[196:197], v3 offset:32
    v_mfma_f32_16x16x32_bf16 v[196:199], a[236:239], a[60:63], v[196:199]
    ds_read_b64_tr_b16 a[198:199], v3 offset:4256
    v_mfma_f32_16x16x32_bf16 v[208:211], a[240:243], a[60:63], v[208:211]
    ds_read_b64_tr_b16 a[200:201], v3 offset:256
    v_mfma_f32_16x16x32_bf16 v[220:223], a[244:247], a[60:63], v[220:223]
    ds_read_b64_tr_b16 a[202:203], v3 offset:4480
    v_mfma_f32_16x16x32_bf16 v[232:235], a[248:251], a[60:63], v[232:235]
    ds_read_b64_tr_b16 a[204:205], v3 offset:288
    v_mfma_f32_16x16x32_bf16 v[244:247], a[252:255], a[60:63], v[244:247]
    ds_read_b64_tr_b16 a[206:207], v3 offset:4512
    v_mfma_f32_16x16x32_bf16 v[164:167], a[224:227], a[64:67], v[164:167]
    buffer_load_dwordx4 a[60:63], v1, s[4:7], s24 offen offset:1024
    v_mfma_f32_16x16x32_bf16 v[176:179], a[228:231], a[64:67], v[176:179]
    ds_read_b64_tr_b16 a[208:209], v3 offset:512
    v_mfma_f32_16x16x32_bf16 v[188:191], a[232:235], a[64:67], v[188:191]
    ds_read_b64_tr_b16 a[210:211], v3 offset:4736
    v_mfma_f32_16x16x32_bf16 v[200:203], a[236:239], a[64:67], v[200:203]
    ds_read_b64_tr_b16 a[212:213], v3 offset:544
    v_mfma_f32_16x16x32_bf16 v[212:215], a[240:243], a[64:67], v[212:215]
    ds_read_b64_tr_b16 a[214:215], v3 offset:4768
    v_mfma_f32_16x16x32_bf16 v[224:227], a[244:247], a[64:67], v[224:227]
    ds_read_b64_tr_b16 a[216:217], v3 offset:768
    v_mfma_f32_16x16x32_bf16 v[236:239], a[248:251], a[64:67], v[236:239]
    ds_read_b64_tr_b16 a[218:219], v3 offset:4992
    v_mfma_f32_16x16x32_bf16 v[248:251], a[252:255], a[64:67], v[248:251]
    ds_read_b64_tr_b16 a[220:221], v3 offset:800
    v_mfma_f32_16x16x32_bf16 v[168:171], a[224:227], a[68:71], v[168:171]
    buffer_load_dwordx4 a[64:67], v1, s[4:7], s25 offen offset:1024
    v_mfma_f32_16x16x32_bf16 v[180:183], a[228:231], a[68:71], v[180:183]
    ds_read_b64_tr_b16 a[222:223], v3 offset:5024
    v_mfma_f32_16x16x32_bf16 v[192:195], a[232:235], a[68:71], v[192:195]
    s_add_u32 m0, s28, 109824
    v_mfma_f32_16x16x32_bf16 v[204:207], a[236:239], a[68:71], v[204:207]
    s_add_u32 s27, s41, 425984
    buffer_load_dwordx4 v2, s[8:11], s27 offen lds
    v_mfma_f32_16x16x32_bf16 v[216:219], a[240:243], a[68:71], v[216:219]
    s_add_u32 m0, s28, 110880
    v_mfma_f32_16x16x32_bf16 v[228:231], a[244:247], a[68:71], v[228:231]
    s_add_u32 s27, s41, 430080
    v_mfma_f32_16x16x32_bf16 v[240:243], a[248:251], a[68:71], v[240:243]
    buffer_load_dwordx4 v2, s[8:11], s27 offen lds
    v_mfma_f32_16x16x32_bf16 v[252:255], a[252:255], a[68:71], v[252:255]
    buffer_load_dwordx4 a[68:71], v1, s[4:7], s26 offen offset:1024
    s_waitcnt lgkmcnt(0)
    v_add_u32 v3, 0x2100, v3
    v_mfma_f32_16x16x32_bf16 v[160:163], a[192:195], a[72:75], v[160:163]
    ds_read_b64_tr_b16 a[224:225], v3 offset:0
    v_mfma_f32_16x16x32_bf16 v[172:175], a[196:199], a[72:75], v[172:175]
    ds_read_b64_tr_b16 a[226:227], v3 offset:4224
    v_mfma_f32_16x16x32_bf16 v[184:187], a[200:203], a[72:75], v[184:187]
    ds_read_b64_tr_b16 a[228:229], v3 offset:32
    v_mfma_f32_16x16x32_bf16 v[196:199], a[204:207], a[72:75], v[196:199]
    ds_read_b64_tr_b16 a[230:231], v3 offset:4256
    v_mfma_f32_16x16x32_bf16 v[208:211], a[208:211], a[72:75], v[208:211]
    ds_read_b64_tr_b16 a[232:233], v3 offset:256
    v_mfma_f32_16x16x32_bf16 v[220:223], a[212:215], a[72:75], v[220:223]
    ds_read_b64_tr_b16 a[234:235], v3 offset:4480
    v_mfma_f32_16x16x32_bf16 v[232:235], a[216:219], a[72:75], v[232:235]
    ds_read_b64_tr_b16 a[236:237], v3 offset:288
    v_mfma_f32_16x16x32_bf16 v[244:247], a[220:223], a[72:75], v[244:247]
    ds_read_b64_tr_b16 a[238:239], v3 offset:4512
    v_mfma_f32_16x16x32_bf16 v[164:167], a[192:195], a[76:79], v[164:167]
    buffer_load_dwordx4 a[72:75], v1, s[4:7], s24 offen offset:2048
    v_mfma_f32_16x16x32_bf16 v[176:179], a[196:199], a[76:79], v[176:179]
    ds_read_b64_tr_b16 a[240:241], v3 offset:512
    v_mfma_f32_16x16x32_bf16 v[188:191], a[200:203], a[76:79], v[188:191]
    ds_read_b64_tr_b16 a[242:243], v3 offset:4736
    v_mfma_f32_16x16x32_bf16 v[200:203], a[204:207], a[76:79], v[200:203]
    ds_read_b64_tr_b16 a[244:245], v3 offset:544
    v_mfma_f32_16x16x32_bf16 v[212:215], a[208:211], a[76:79], v[212:215]
    ds_read_b64_tr_b16 a[246:247], v3 offset:4768
    v_mfma_f32_16x16x32_bf16 v[224:227], a[212:215], a[76:79], v[224:227]
    ds_read_b64_tr_b16 a[248:249], v3 offset:768
    v_mfma_f32_16x16x32_bf16 v[236:239], a[216:219], a[76:79], v[236:239]
    ds_read_b64_tr_b16 a[250:251], v3 offset:4992
    v_mfma_f32_16x16x32_bf16 v[248:251], a[220:223], a[76:79], v[248:251]
    ds_read_b64_tr_b16 a[252:253], v3 offset:800
    v_mfma_f32_16x16x32_bf16 v[168:171], a[192:195], a[80:83], v[168:171]
    buffer_load_dwordx4 a[76:79], v1, s[4:7], s25 offen offset:2048
    v_mfma_f32_16x16x32_bf16 v[180:183], a[196:199], a[80:83], v[180:183]
    ds_read_b64_tr_b16 a[254:255], v3 offset:5024
    v_mfma_f32_16x16x32_bf16 v[192:195], a[200:203], a[80:83], v[192:195]
    s_add_u32 m0, s28, 118272
    v_mfma_f32_16x16x32_bf16 v[204:207], a[204:207], a[80:83], v[204:207]
    s_add_u32 s27, s41, 458752
    buffer_load_dwordx4 v2, s[8:11], s27 offen lds
    v_mfma_f32_16x16x32_bf16 v[216:219], a[208:211], a[80:83], v[216:219]
    s_add_u32 m0, s28, 119328
    v_mfma_f32_16x16x32_bf16 v[228:231], a[212:215], a[80:83], v[228:231]
    s_add_u32 s27, s41, 462848
    v_mfma_f32_16x16x32_bf16 v[240:243], a[216:219], a[80:83], v[240:243]
    buffer_load_dwordx4 v2, s[8:11], s27 offen lds
    v_mfma_f32_16x16x32_bf16 v[252:255], a[220:223], a[80:83], v[252:255]
    buffer_load_dwordx4 a[80:83], v1, s[4:7], s26 offen offset:2048
    s_waitcnt lgkmcnt(0)
    v_add_u32 v3, 0x2100, v3
    v_mfma_f32_16x16x32_bf16 v[160:163], a[224:227], a[84:87], v[160:163]
    ds_read_b64_tr_b16 a[192:193], v3 offset:0
    v_mfma_f32_16x16x32_bf16 v[172:175], a[228:231], a[84:87], v[172:175]
    ds_read_b64_tr_b16 a[194:195], v3 offset:4224
    v_mfma_f32_16x16x32_bf16 v[184:187], a[232:235], a[84:87], v[184:187]
    ds_read_b64_tr_b16 a[196:197], v3 offset:32
    v_mfma_f32_16x16x32_bf16 v[196:199], a[236:239], a[84:87], v[196:199]
    ds_read_b64_tr_b16 a[198:199], v3 offset:4256
    v_mfma_f32_16x16x32_bf16 v[208:211], a[240:243], a[84:87], v[208:211]
    ds_read_b64_tr_b16 a[200:201], v3 offset:256
    v_mfma_f32_16x16x32_bf16 v[220:223], a[244:247], a[84:87], v[220:223]
    ds_read_b64_tr_b16 a[202:203], v3 offset:4480
    v_mfma_f32_16x16x32_bf16 v[232:235], a[248:251], a[84:87], v[232:235]
    ds_read_b64_tr_b16 a[204:205], v3 offset:288
    v_mfma_f32_16x16x32_bf16 v[244:247], a[252:255], a[84:87], v[244:247]
    ds_read_b64_tr_b16 a[206:207], v3 offset:4512
    v_mfma_f32_16x16x32_bf16 v[164:167], a[224:227], a[88:91], v[164:167]
    buffer_load_dwordx4 a[84:87], v1, s[4:7], s24 offen offset:3072
    v_mfma_f32_16x16x32_bf16 v[176:179], a[228:231], a[88:91], v[176:179]
    ds_read_b64_tr_b16 a[208:209], v3 offset:512
    v_mfma_f32_16x16x32_bf16 v[188:191], a[232:235], a[88:91], v[188:191]
    ds_read_b64_tr_b16 a[210:211], v3 offset:4736
    v_mfma_f32_16x16x32_bf16 v[200:203], a[236:239], a[88:91], v[200:203]
    ds_read_b64_tr_b16 a[212:213], v3 offset:544
    v_mfma_f32_16x16x32_bf16 v[212:215], a[240:243], a[88:91], v[212:215]
    ds_read_b64_tr_b16 a[214:215], v3 offset:4768
    v_mfma_f32_16x16x32_bf16 v[224:227], a[244:247], a[88:91], v[224:227]
    ds_read_b64_tr_b16 a[216:217], v3 offset:768
    v_mfma_f32_16x16x32_bf16 v[236:239], a[248:251], a[88:91], v[236:239]
    ds_read_b64_tr_b16 a[218:219], v3 offset:4992
    v_mfma_f32_16x16x32_bf16 v[248:251], a[252:255], a[88:91], v[248:251]
    ds_read_b64_tr_b16 a[220:221], v3 offset:800
    v_mfma_f32_16x16x32_bf16 v[168:171], a[224:227], a[92:95], v[168:171]
    buffer_load_dwordx4 a[88:91], v1, s[4:7], s25 offen offset:3072
    v_mfma_f32_16x16x32_bf16 v[180:183], a[228:231], a[92:95], v[180:183]
    ds_read_b64_tr_b16 a[222:223], v3 offset:5024
    v_mfma_f32_16x16x32_bf16 v[192:195], a[232:235], a[92:95], v[192:195]
    s_add_u32 m0, s28, 126720
    v_mfma_f32_16x16x32_bf16 v[204:207], a[236:239], a[92:95], v[204:207]
    s_add_u32 s27, s41, 491520
    buffer_load_dwordx4 v2, s[8:11], s27 offen lds
    v_mfma_f32_16x16x32_bf16 v[216:219], a[240:243], a[92:95], v[216:219]
    s_add_u32 m0, s28, 127776
    v_mfma_f32_16x16x32_bf16 v[228:231], a[244:247], a[92:95], v[228:231]
    s_add_u32 s27, s41, 495616
    v_mfma_f32_16x16x32_bf16 v[240:243], a[248:251], a[92:95], v[240:243]
    buffer_load_dwordx4 v2, s[8:11], s27 offen lds
    v_mfma_f32_16x16x32_bf16 v[252:255], a[252:255], a[92:95], v[252:255]
    buffer_load_dwordx4 a[92:95], v1, s[4:7], s26 offen offset:3072
    s_waitcnt lgkmcnt(0)
    s_waitcnt vmcnt(16)
    s_barrier
    v_add_u32 v3, 0x2100, v3
    v_mfma_f32_16x16x32_bf16 v[160:163], a[192:195], a[0:3], v[160:163]
    ds_read_b64_tr_b16 a[224:225], v3 offset:0
    v_mfma_f32_16x16x32_bf16 v[172:175], a[196:199], a[0:3], v[172:175]
    ds_read_b64_tr_b16 a[226:227], v3 offset:4224
    v_mfma_f32_16x16x32_bf16 v[184:187], a[200:203], a[0:3], v[184:187]
    ds_read_b64_tr_b16 a[228:229], v3 offset:32
    v_mfma_f32_16x16x32_bf16 v[196:199], a[204:207], a[0:3], v[196:199]
    ds_read_b64_tr_b16 a[230:231], v3 offset:4256
    v_mfma_f32_16x16x32_bf16 v[208:211], a[208:211], a[0:3], v[208:211]
    ds_read_b64_tr_b16 a[232:233], v3 offset:256
    v_mfma_f32_16x16x32_bf16 v[220:223], a[212:215], a[0:3], v[220:223]
    ds_read_b64_tr_b16 a[234:235], v3 offset:4480
    v_mfma_f32_16x16x32_bf16 v[232:235], a[216:219], a[0:3], v[232:235]
    ds_read_b64_tr_b16 a[236:237], v3 offset:288
    v_mfma_f32_16x16x32_bf16 v[244:247], a[220:223], a[0:3], v[244:247]
    ds_read_b64_tr_b16 a[238:239], v3 offset:4512
    v_mfma_f32_16x16x32_bf16 v[164:167], a[192:195], a[4:7], v[164:167]
    s_add_u32 s24, s40, 0
    buffer_load_dwordx4 a[0:3], v1, s[4:7], s24 offen offset:0
    v_mfma_f32_16x16x32_bf16 v[176:179], a[196:199], a[4:7], v[176:179]
    ds_read_b64_tr_b16 a[240:241], v3 offset:512
    v_mfma_f32_16x16x32_bf16 v[188:191], a[200:203], a[4:7], v[188:191]
    ds_read_b64_tr_b16 a[242:243], v3 offset:4736
    v_mfma_f32_16x16x32_bf16 v[200:203], a[204:207], a[4:7], v[200:203]
    ds_read_b64_tr_b16 a[244:245], v3 offset:544
    v_mfma_f32_16x16x32_bf16 v[212:215], a[208:211], a[4:7], v[212:215]
    ds_read_b64_tr_b16 a[246:247], v3 offset:4768
    v_mfma_f32_16x16x32_bf16 v[224:227], a[212:215], a[4:7], v[224:227]
    ds_read_b64_tr_b16 a[248:249], v3 offset:768
    v_mfma_f32_16x16x32_bf16 v[236:239], a[216:219], a[4:7], v[236:239]
    ds_read_b64_tr_b16 a[250:251], v3 offset:4992
    v_mfma_f32_16x16x32_bf16 v[248:251], a[220:223], a[4:7], v[248:251]
    ds_read_b64_tr_b16 a[252:253], v3 offset:800
    v_mfma_f32_16x16x32_bf16 v[168:171], a[192:195], a[8:11], v[168:171]
    s_add_u32 s25, s40, 131072
    buffer_load_dwordx4 a[4:7], v1, s[4:7], s25 offen offset:0
    v_mfma_f32_16x16x32_bf16 v[180:183], a[196:199], a[8:11], v[180:183]
    ds_read_b64_tr_b16 a[254:255], v3 offset:5024
    v_mfma_f32_16x16x32_bf16 v[192:195], a[200:203], a[8:11], v[192:195]
    s_add_u32 m0, s28, 0
    v_mfma_f32_16x16x32_bf16 v[204:207], a[204:207], a[8:11], v[204:207]
    s_add_u32 s27, s42, 0
    buffer_load_dwordx4 v2, s[16:19], s27 offen lds
    v_mfma_f32_16x16x32_bf16 v[216:219], a[208:211], a[8:11], v[216:219]
    s_add_u32 m0, s28, 1056
    v_mfma_f32_16x16x32_bf16 v[228:231], a[212:215], a[8:11], v[228:231]
    s_add_u32 s27, s42, 4096
    v_mfma_f32_16x16x32_bf16 v[240:243], a[216:219], a[8:11], v[240:243]
    buffer_load_dwordx4 v2, s[16:19], s27 offen lds
    v_mfma_f32_16x16x32_bf16 v[252:255], a[220:223], a[8:11], v[252:255]
    s_add_u32 s26, s40, 262144
    buffer_load_dwordx4 a[8:11], v1, s[4:7], s26 offen offset:0
    s_waitcnt lgkmcnt(0)
    v_add_u32 v3, 0x2100, v3
    v_mfma_f32_16x16x32_bf16 v[160:163], a[224:227], a[12:15], v[160:163]
    ds_read_b64_tr_b16 a[192:193], v3 offset:0
    v_mfma_f32_16x16x32_bf16 v[172:175], a[228:231], a[12:15], v[172:175]
    ds_read_b64_tr_b16 a[194:195], v3 offset:4224
    v_mfma_f32_16x16x32_bf16 v[184:187], a[232:235], a[12:15], v[184:187]
    ds_read_b64_tr_b16 a[196:197], v3 offset:32
    v_mfma_f32_16x16x32_bf16 v[196:199], a[236:239], a[12:15], v[196:199]
    ds_read_b64_tr_b16 a[198:199], v3 offset:4256
    v_mfma_f32_16x16x32_bf16 v[208:211], a[240:243], a[12:15], v[208:211]
    ds_read_b64_tr_b16 a[200:201], v3 offset:256
    v_mfma_f32_16x16x32_bf16 v[220:223], a[244:247], a[12:15], v[220:223]
    ds_read_b64_tr_b16 a[202:203], v3 offset:4480
    v_mfma_f32_16x16x32_bf16 v[232:235], a[248:251], a[12:15], v[232:235]
    ds_read_b64_tr_b16 a[204:205], v3 offset:288
    v_mfma_f32_16x16x32_bf16 v[244:247], a[252:255], a[12:15], v[244:247]
    ds_read_b64_tr_b16 a[206:207], v3 offset:4512
    v_mfma_f32_16x16x32_bf16 v[164:167], a[224:227], a[16:19], v[164:167]
    buffer_load_dwordx4 a[12:15], v1, s[4:7], s24 offen offset:1024
    v_mfma_f32_16x16x32_bf16 v[176:179], a[228:231], a[16:19], v[176:179]
    ds_read_b64_tr_b16 a[208:209], v3 offset:512
    v_mfma_f32_16x16x32_bf16 v[188:191], a[232:235], a[16:19], v[188:191]
    ds_read_b64_tr_b16 a[210:211], v3 offset:4736
    v_mfma_f32_16x16x32_bf16 v[200:203], a[236:239], a[16:19], v[200:203]
    ds_read_b64_tr_b16 a[212:213], v3 offset:544
    v_mfma_f32_16x16x32_bf16 v[212:215], a[240:243], a[16:19], v[212:215]
    ds_read_b64_tr_b16 a[214:215], v3 offset:4768
    v_mfma_f32_16x16x32_bf16 v[224:227], a[244:247], a[16:19], v[224:227]
    ds_read_b64_tr_b16 a[216:217], v3 offset:768
    v_mfma_f32_16x16x32_bf16 v[236:239], a[248:251], a[16:19], v[236:239]
    ds_read_b64_tr_b16 a[218:219], v3 offset:4992
    v_mfma_f32_16x16x32_bf16 v[248:251], a[252:255], a[16:19], v[248:251]
    ds_read_b64_tr_b16 a[220:221], v3 offset:800
    v_mfma_f32_16x16x32_bf16 v[168:171], a[224:227], a[20:23], v[168:171]
    buffer_load_dwordx4 a[16:19], v1, s[4:7], s25 offen offset:1024
    v_mfma_f32_16x16x32_bf16 v[180:183], a[228:231], a[20:23], v[180:183]
    ds_read_b64_tr_b16 a[222:223], v3 offset:5024
    v_mfma_f32_16x16x32_bf16 v[192:195], a[232:235], a[20:23], v[192:195]
    s_add_u32 m0, s28, 8448
    v_mfma_f32_16x16x32_bf16 v[204:207], a[236:239], a[20:23], v[204:207]
    s_add_u32 s27, s42, 32768
    buffer_load_dwordx4 v2, s[16:19], s27 offen lds
    v_mfma_f32_16x16x32_bf16 v[216:219], a[240:243], a[20:23], v[216:219]
    s_add_u32 m0, s28, 9504
    v_mfma_f32_16x16x32_bf16 v[228:231], a[244:247], a[20:23], v[228:231]
    s_add_u32 s27, s42, 36864
    v_mfma_f32_16x16x32_bf16 v[240:243], a[248:251], a[20:23], v[240:243]
    buffer_load_dwordx4 v2, s[16:19], s27 offen lds
    v_mfma_f32_16x16x32_bf16 v[252:255], a[252:255], a[20:23], v[252:255]
    buffer_load_dwordx4 a[20:23], v1, s[4:7], s26 offen offset:1024
    s_waitcnt lgkmcnt(0)
    v_add_u32 v3, 0x2100, v3
    v_mfma_f32_16x16x32_bf16 v[160:163], a[192:195], a[24:27], v[160:163]
    ds_read_b64_tr_b16 a[224:225], v3 offset:0
    v_mfma_f32_16x16x32_bf16 v[172:175], a[196:199], a[24:27], v[172:175]
    ds_read_b64_tr_b16 a[226:227], v3 offset:4224
    v_mfma_f32_16x16x32_bf16 v[184:187], a[200:203], a[24:27], v[184:187]
    ds_read_b64_tr_b16 a[228:229], v3 offset:32
    v_mfma_f32_16x16x32_bf16 v[196:199], a[204:207], a[24:27], v[196:199]
    ds_read_b64_tr_b16 a[230:231], v3 offset:4256
    v_mfma_f32_16x16x32_bf16 v[208:211], a[208:211], a[24:27], v[208:211]
    ds_read_b64_tr_b16 a[232:233], v3 offset:256
    v_mfma_f32_16x16x32_bf16 v[220:223], a[212:215], a[24:27], v[220:223]
    ds_read_b64_tr_b16 a[234:235], v3 offset:4480
    v_mfma_f32_16x16x32_bf16 v[232:235], a[216:219], a[24:27], v[232:235]
    ds_read_b64_tr_b16 a[236:237], v3 offset:288
    v_mfma_f32_16x16x32_bf16 v[244:247], a[220:223], a[24:27], v[244:247]
    ds_read_b64_tr_b16 a[238:239], v3 offset:4512
    v_mfma_f32_16x16x32_bf16 v[164:167], a[192:195], a[28:31], v[164:167]
    buffer_load_dwordx4 a[24:27], v1, s[4:7], s24 offen offset:2048
    v_mfma_f32_16x16x32_bf16 v[176:179], a[196:199], a[28:31], v[176:179]
    ds_read_b64_tr_b16 a[240:241], v3 offset:512
    v_mfma_f32_16x16x32_bf16 v[188:191], a[200:203], a[28:31], v[188:191]
    ds_read_b64_tr_b16 a[242:243], v3 offset:4736
    v_mfma_f32_16x16x32_bf16 v[200:203], a[204:207], a[28:31], v[200:203]
    ds_read_b64_tr_b16 a[244:245], v3 offset:544
    v_mfma_f32_16x16x32_bf16 v[212:215], a[208:211], a[28:31], v[212:215]
    ds_read_b64_tr_b16 a[246:247], v3 offset:4768
    v_mfma_f32_16x16x32_bf16 v[224:227], a[212:215], a[28:31], v[224:227]
    ds_read_b64_tr_b16 a[248:249], v3 offset:768
    v_mfma_f32_16x16x32_bf16 v[236:239], a[216:219], a[28:31], v[236:239]
    ds_read_b64_tr_b16 a[250:251], v3 offset:4992
    v_mfma_f32_16x16x32_bf16 v[248:251], a[220:223], a[28:31], v[248:251]
    ds_read_b64_tr_b16 a[252:253], v3 offset:800
    v_mfma_f32_16x16x32_bf16 v[168:171], a[192:195], a[32:35], v[168:171]
    buffer_load_dwordx4 a[28:31], v1, s[4:7], s25 offen offset:2048
    v_mfma_f32_16x16x32_bf16 v[180:183], a[196:199], a[32:35], v[180:183]
    ds_read_b64_tr_b16 a[254:255], v3 offset:5024
    v_mfma_f32_16x16x32_bf16 v[192:195], a[200:203], a[32:35], v[192:195]
    s_add_u32 m0, s28, 16896
    v_mfma_f32_16x16x32_bf16 v[204:207], a[204:207], a[32:35], v[204:207]
    s_add_u32 s27, s42, 65536
    buffer_load_dwordx4 v2, s[16:19], s27 offen lds
    v_mfma_f32_16x16x32_bf16 v[216:219], a[208:211], a[32:35], v[216:219]
    s_add_u32 m0, s28, 17952
    v_mfma_f32_16x16x32_bf16 v[228:231], a[212:215], a[32:35], v[228:231]
    s_add_u32 s27, s42, 69632
    v_mfma_f32_16x16x32_bf16 v[240:243], a[216:219], a[32:35], v[240:243]
    buffer_load_dwordx4 v2, s[16:19], s27 offen lds
    v_mfma_f32_16x16x32_bf16 v[252:255], a[220:223], a[32:35], v[252:255]
    buffer_load_dwordx4 a[32:35], v1, s[4:7], s26 offen offset:2048
    s_waitcnt lgkmcnt(0)
    v_add_u32 v3, 0x2100, v3
    v_mfma_f32_16x16x32_bf16 v[160:163], a[224:227], a[36:39], v[160:163]
    ds_read_b64_tr_b16 a[192:193], v3 offset:0
    v_mfma_f32_16x16x32_bf16 v[172:175], a[228:231], a[36:39], v[172:175]
    ds_read_b64_tr_b16 a[194:195], v3 offset:4224
    v_mfma_f32_16x16x32_bf16 v[184:187], a[232:235], a[36:39], v[184:187]
    ds_read_b64_tr_b16 a[196:197], v3 offset:32
    v_mfma_f32_16x16x32_bf16 v[196:199], a[236:239], a[36:39], v[196:199]
    ds_read_b64_tr_b16 a[198:199], v3 offset:4256
    v_mfma_f32_16x16x32_bf16 v[208:211], a[240:243], a[36:39], v[208:211]
    ds_read_b64_tr_b16 a[200:201], v3 offset:256
    v_mfma_f32_16x16x32_bf16 v[220:223], a[244:247], a[36:39], v[220:223]
    ds_read_b64_tr_b16 a[202:203], v3 offset:4480
    v_mfma_f32_16x16x32_bf16 v[232:235], a[248:251], a[36:39], v[232:235]
    ds_read_b64_tr_b16 a[204:205], v3 offset:288
    v_mfma_f32_16x16x32_bf16 v[244:247], a[252:255], a[36:39], v[244:247]
    ds_read_b64_tr_b16 a[206:207], v3 offset:4512
    v_mfma_f32_16x16x32_bf16 v[164:167], a[224:227], a[40:43], v[164:167]
    buffer_load_dwordx4 a[36:39], v1, s[4:7], s24 offen offset:3072
    v_mfma_f32_16x16x32_bf16 v[176:179], a[228:231], a[40:43], v[176:179]
    ds_read_b64_tr_b16 a[208:209], v3 offset:512
    v_mfma_f32_16x16x32_bf16 v[188:191], a[232:235], a[40:43], v[188:191]
    ds_read_b64_tr_b16 a[210:211], v3 offset:4736
    v_mfma_f32_16x16x32_bf16 v[200:203], a[236:239], a[40:43], v[200:203]
    ds_read_b64_tr_b16 a[212:213], v3 offset:544
    v_mfma_f32_16x16x32_bf16 v[212:215], a[240:243], a[40:43], v[212:215]
    ds_read_b64_tr_b16 a[214:215], v3 offset:4768
    v_mfma_f32_16x16x32_bf16 v[224:227], a[244:247], a[40:43], v[224:227]
    ds_read_b64_tr_b16 a[216:217], v3 offset:768
    v_mfma_f32_16x16x32_bf16 v[236:239], a[248:251], a[40:43], v[236:239]
    ds_read_b64_tr_b16 a[218:219], v3 offset:4992
    v_mfma_f32_16x16x32_bf16 v[248:251], a[252:255], a[40:43], v[248:251]
    ds_read_b64_tr_b16 a[220:221], v3 offset:800
    v_mfma_f32_16x16x32_bf16 v[168:171], a[224:227], a[44:47], v[168:171]
    buffer_load_dwordx4 a[40:43], v1, s[4:7], s25 offen offset:3072
    v_mfma_f32_16x16x32_bf16 v[180:183], a[228:231], a[44:47], v[180:183]
    ds_read_b64_tr_b16 a[222:223], v3 offset:5024
    v_mfma_f32_16x16x32_bf16 v[192:195], a[232:235], a[44:47], v[192:195]
    s_add_u32 m0, s28, 25344
    v_mfma_f32_16x16x32_bf16 v[204:207], a[236:239], a[44:47], v[204:207]
    s_add_u32 s27, s42, 98304
    buffer_load_dwordx4 v2, s[16:19], s27 offen lds
    v_mfma_f32_16x16x32_bf16 v[216:219], a[240:243], a[44:47], v[216:219]
    s_add_u32 m0, s28, 26400
    v_mfma_f32_16x16x32_bf16 v[228:231], a[244:247], a[44:47], v[228:231]
    s_add_u32 s27, s42, 102400
    v_mfma_f32_16x16x32_bf16 v[240:243], a[248:251], a[44:47], v[240:243]
    buffer_load_dwordx4 v2, s[16:19], s27 offen lds
    v_mfma_f32_16x16x32_bf16 v[252:255], a[252:255], a[44:47], v[252:255]
    buffer_load_dwordx4 a[44:47], v1, s[4:7], s26 offen offset:3072
    s_waitcnt lgkmcnt(0)
    s_waitcnt vmcnt(16)
    s_barrier
    v_add_u32 v3, 0x2100, v3
    v_mfma_f32_16x16x32_bf16 v[160:163], a[192:195], a[48:51], v[160:163]
    ds_read_b64_tr_b16 a[224:225], v3 offset:0
    v_mfma_f32_16x16x32_bf16 v[172:175], a[196:199], a[48:51], v[172:175]
    ds_read_b64_tr_b16 a[226:227], v3 offset:4224
    v_mfma_f32_16x16x32_bf16 v[184:187], a[200:203], a[48:51], v[184:187]
    ds_read_b64_tr_b16 a[228:229], v3 offset:32
    v_mfma_f32_16x16x32_bf16 v[196:199], a[204:207], a[48:51], v[196:199]
    ds_read_b64_tr_b16 a[230:231], v3 offset:4256
    v_mfma_f32_16x16x32_bf16 v[208:211], a[208:211], a[48:51], v[208:211]
    ds_read_b64_tr_b16 a[232:233], v3 offset:256
    v_mfma_f32_16x16x32_bf16 v[220:223], a[212:215], a[48:51], v[220:223]
    ds_read_b64_tr_b16 a[234:235], v3 offset:4480
    v_mfma_f32_16x16x32_bf16 v[232:235], a[216:219], a[48:51], v[232:235]
    ds_read_b64_tr_b16 a[236:237], v3 offset:288
    v_mfma_f32_16x16x32_bf16 v[244:247], a[220:223], a[48:51], v[244:247]
    ds_read_b64_tr_b16 a[238:239], v3 offset:4512
    v_mfma_f32_16x16x32_bf16 v[164:167], a[192:195], a[52:55], v[164:167]
    s_add_u32 s24, s40, 4096
    buffer_load_dwordx4 a[48:51], v1, s[4:7], s24 offen offset:0
    v_mfma_f32_16x16x32_bf16 v[176:179], a[196:199], a[52:55], v[176:179]
    ds_read_b64_tr_b16 a[240:241], v3 offset:512
    v_mfma_f32_16x16x32_bf16 v[188:191], a[200:203], a[52:55], v[188:191]
    ds_read_b64_tr_b16 a[242:243], v3 offset:4736
    v_mfma_f32_16x16x32_bf16 v[200:203], a[204:207], a[52:55], v[200:203]
    ds_read_b64_tr_b16 a[244:245], v3 offset:544
    v_mfma_f32_16x16x32_bf16 v[212:215], a[208:211], a[52:55], v[212:215]
    ds_read_b64_tr_b16 a[246:247], v3 offset:4768
    v_mfma_f32_16x16x32_bf16 v[224:227], a[212:215], a[52:55], v[224:227]
    ds_read_b64_tr_b16 a[248:249], v3 offset:768
    v_mfma_f32_16x16x32_bf16 v[236:239], a[216:219], a[52:55], v[236:239]
    ds_read_b64_tr_b16 a[250:251], v3 offset:4992
    v_mfma_f32_16x16x32_bf16 v[248:251], a[220:223], a[52:55], v[248:251]
    ds_read_b64_tr_b16 a[252:253], v3 offset:800
    v_mfma_f32_16x16x32_bf16 v[168:171], a[192:195], a[56:59], v[168:171]
    s_add_u32 s25, s40, 135168
    buffer_load_dwordx4 a[52:55], v1, s[4:7], s25 offen offset:0
    v_mfma_f32_16x16x32_bf16 v[180:183], a[196:199], a[56:59], v[180:183]
    ds_read_b64_tr_b16 a[254:255], v3 offset:5024
    v_mfma_f32_16x16x32_bf16 v[192:195], a[200:203], a[56:59], v[192:195]
    s_add_u32 m0, s28, 33792
    v_mfma_f32_16x16x32_bf16 v[204:207], a[204:207], a[56:59], v[204:207]
    s_add_u32 s27, s42, 131072
    buffer_load_dwordx4 v2, s[16:19], s27 offen lds
    v_mfma_f32_16x16x32_bf16 v[216:219], a[208:211], a[56:59], v[216:219]
    s_add_u32 m0, s28, 34848
    v_mfma_f32_16x16x32_bf16 v[228:231], a[212:215], a[56:59], v[228:231]
    s_add_u32 s27, s42, 135168
    v_mfma_f32_16x16x32_bf16 v[240:243], a[216:219], a[56:59], v[240:243]
    buffer_load_dwordx4 v2, s[16:19], s27 offen lds
    v_mfma_f32_16x16x32_bf16 v[252:255], a[220:223], a[56:59], v[252:255]
    s_add_u32 s26, s40, 266240
    buffer_load_dwordx4 a[56:59], v1, s[4:7], s26 offen offset:0
    s_waitcnt lgkmcnt(0)
    v_add_u32 v3, 0x2100, v3
    v_mfma_f32_16x16x32_bf16 v[160:163], a[224:227], a[60:63], v[160:163]
    ds_read_b64_tr_b16 a[192:193], v3 offset:0
    v_mfma_f32_16x16x32_bf16 v[172:175], a[228:231], a[60:63], v[172:175]
    ds_read_b64_tr_b16 a[194:195], v3 offset:4224
    v_mfma_f32_16x16x32_bf16 v[184:187], a[232:235], a[60:63], v[184:187]
    ds_read_b64_tr_b16 a[196:197], v3 offset:32
    v_mfma_f32_16x16x32_bf16 v[196:199], a[236:239], a[60:63], v[196:199]
    ds_read_b64_tr_b16 a[198:199], v3 offset:4256
    v_mfma_f32_16x16x32_bf16 v[208:211], a[240:243], a[60:63], v[208:211]
    ds_read_b64_tr_b16 a[200:201], v3 offset:256
    v_mfma_f32_16x16x32_bf16 v[220:223], a[244:247], a[60:63], v[220:223]
    ds_read_b64_tr_b16 a[202:203], v3 offset:4480
    v_mfma_f32_16x16x32_bf16 v[232:235], a[248:251], a[60:63], v[232:235]
    ds_read_b64_tr_b16 a[204:205], v3 offset:288
    v_mfma_f32_16x16x32_bf16 v[244:247], a[252:255], a[60:63], v[244:247]
    ds_read_b64_tr_b16 a[206:207], v3 offset:4512
    v_mfma_f32_16x16x32_bf16 v[164:167], a[224:227], a[64:67], v[164:167]
    buffer_load_dwordx4 a[60:63], v1, s[4:7], s24 offen offset:1024
    v_mfma_f32_16x16x32_bf16 v[176:179], a[228:231], a[64:67], v[176:179]
    ds_read_b64_tr_b16 a[208:209], v3 offset:512
    v_mfma_f32_16x16x32_bf16 v[188:191], a[232:235], a[64:67], v[188:191]
    ds_read_b64_tr_b16 a[210:211], v3 offset:4736
    v_mfma_f32_16x16x32_bf16 v[200:203], a[236:239], a[64:67], v[200:203]
    ds_read_b64_tr_b16 a[212:213], v3 offset:544
    v_mfma_f32_16x16x32_bf16 v[212:215], a[240:243], a[64:67], v[212:215]
    ds_read_b64_tr_b16 a[214:215], v3 offset:4768
    v_mfma_f32_16x16x32_bf16 v[224:227], a[244:247], a[64:67], v[224:227]
    ds_read_b64_tr_b16 a[216:217], v3 offset:768
    v_mfma_f32_16x16x32_bf16 v[236:239], a[248:251], a[64:67], v[236:239]
    ds_read_b64_tr_b16 a[218:219], v3 offset:4992
    v_mfma_f32_16x16x32_bf16 v[248:251], a[252:255], a[64:67], v[248:251]
    ds_read_b64_tr_b16 a[220:221], v3 offset:800
    v_mfma_f32_16x16x32_bf16 v[168:171], a[224:227], a[68:71], v[168:171]
    buffer_load_dwordx4 a[64:67], v1, s[4:7], s25 offen offset:1024
    v_mfma_f32_16x16x32_bf16 v[180:183], a[228:231], a[68:71], v[180:183]
    ds_read_b64_tr_b16 a[222:223], v3 offset:5024
    v_mfma_f32_16x16x32_bf16 v[192:195], a[232:235], a[68:71], v[192:195]
    s_add_u32 m0, s28, 42240
    v_mfma_f32_16x16x32_bf16 v[204:207], a[236:239], a[68:71], v[204:207]
    s_add_u32 s27, s42, 163840
    buffer_load_dwordx4 v2, s[16:19], s27 offen lds
    v_mfma_f32_16x16x32_bf16 v[216:219], a[240:243], a[68:71], v[216:219]
    s_add_u32 m0, s28, 43296
    v_mfma_f32_16x16x32_bf16 v[228:231], a[244:247], a[68:71], v[228:231]
    s_add_u32 s27, s42, 167936
    v_mfma_f32_16x16x32_bf16 v[240:243], a[248:251], a[68:71], v[240:243]
    buffer_load_dwordx4 v2, s[16:19], s27 offen lds
    v_mfma_f32_16x16x32_bf16 v[252:255], a[252:255], a[68:71], v[252:255]
    buffer_load_dwordx4 a[68:71], v1, s[4:7], s26 offen offset:1024
    s_waitcnt lgkmcnt(0)
    v_add_u32 v3, 0x2100, v3
    v_mfma_f32_16x16x32_bf16 v[160:163], a[192:195], a[72:75], v[160:163]
    ds_read_b64_tr_b16 a[224:225], v3 offset:0
    v_mfma_f32_16x16x32_bf16 v[172:175], a[196:199], a[72:75], v[172:175]
    ds_read_b64_tr_b16 a[226:227], v3 offset:4224
    v_mfma_f32_16x16x32_bf16 v[184:187], a[200:203], a[72:75], v[184:187]
    ds_read_b64_tr_b16 a[228:229], v3 offset:32
    v_mfma_f32_16x16x32_bf16 v[196:199], a[204:207], a[72:75], v[196:199]
    ds_read_b64_tr_b16 a[230:231], v3 offset:4256
    v_mfma_f32_16x16x32_bf16 v[208:211], a[208:211], a[72:75], v[208:211]
    ds_read_b64_tr_b16 a[232:233], v3 offset:256
    v_mfma_f32_16x16x32_bf16 v[220:223], a[212:215], a[72:75], v[220:223]
    ds_read_b64_tr_b16 a[234:235], v3 offset:4480
    v_mfma_f32_16x16x32_bf16 v[232:235], a[216:219], a[72:75], v[232:235]
    ds_read_b64_tr_b16 a[236:237], v3 offset:288
    v_mfma_f32_16x16x32_bf16 v[244:247], a[220:223], a[72:75], v[244:247]
    ds_read_b64_tr_b16 a[238:239], v3 offset:4512
    v_mfma_f32_16x16x32_bf16 v[164:167], a[192:195], a[76:79], v[164:167]
    buffer_load_dwordx4 a[72:75], v1, s[4:7], s24 offen offset:2048
    v_mfma_f32_16x16x32_bf16 v[176:179], a[196:199], a[76:79], v[176:179]
    ds_read_b64_tr_b16 a[240:241], v3 offset:512
    v_mfma_f32_16x16x32_bf16 v[188:191], a[200:203], a[76:79], v[188:191]
    ds_read_b64_tr_b16 a[242:243], v3 offset:4736
    v_mfma_f32_16x16x32_bf16 v[200:203], a[204:207], a[76:79], v[200:203]
    ds_read_b64_tr_b16 a[244:245], v3 offset:544
    v_mfma_f32_16x16x32_bf16 v[212:215], a[208:211], a[76:79], v[212:215]
    ds_read_b64_tr_b16 a[246:247], v3 offset:4768
    v_mfma_f32_16x16x32_bf16 v[224:227], a[212:215], a[76:79], v[224:227]
    ds_read_b64_tr_b16 a[248:249], v3 offset:768
    v_mfma_f32_16x16x32_bf16 v[236:239], a[216:219], a[76:79], v[236:239]
    ds_read_b64_tr_b16 a[250:251], v3 offset:4992
    v_mfma_f32_16x16x32_bf16 v[248:251], a[220:223], a[76:79], v[248:251]
    ds_read_b64_tr_b16 a[252:253], v3 offset:800
    v_mfma_f32_16x16x32_bf16 v[168:171], a[192:195], a[80:83], v[168:171]
    buffer_load_dwordx4 a[76:79], v1, s[4:7], s25 offen offset:2048
    v_mfma_f32_16x16x32_bf16 v[180:183], a[196:199], a[80:83], v[180:183]
    ds_read_b64_tr_b16 a[254:255], v3 offset:5024
    v_mfma_f32_16x16x32_bf16 v[192:195], a[200:203], a[80:83], v[192:195]
    s_add_u32 m0, s28, 50688
    v_mfma_f32_16x16x32_bf16 v[204:207], a[204:207], a[80:83], v[204:207]
    s_add_u32 s27, s42, 196608
    buffer_load_dwordx4 v2, s[16:19], s27 offen lds
    v_mfma_f32_16x16x32_bf16 v[216:219], a[208:211], a[80:83], v[216:219]
    s_add_u32 m0, s28, 51744
    v_mfma_f32_16x16x32_bf16 v[228:231], a[212:215], a[80:83], v[228:231]
    s_add_u32 s27, s42, 200704
    v_mfma_f32_16x16x32_bf16 v[240:243], a[216:219], a[80:83], v[240:243]
    buffer_load_dwordx4 v2, s[16:19], s27 offen lds
    v_mfma_f32_16x16x32_bf16 v[252:255], a[220:223], a[80:83], v[252:255]
    buffer_load_dwordx4 a[80:83], v1, s[4:7], s26 offen offset:2048
    s_waitcnt lgkmcnt(0)
    v_add_u32 v3, 0xfffe1100, v3
    v_mfma_f32_16x16x32_bf16 v[160:163], a[224:227], a[84:87], v[160:163]
    ds_read_b64_tr_b16 a[192:193], v3 offset:0
    v_mfma_f32_16x16x32_bf16 v[172:175], a[228:231], a[84:87], v[172:175]
    ds_read_b64_tr_b16 a[194:195], v3 offset:4224
    v_mfma_f32_16x16x32_bf16 v[184:187], a[232:235], a[84:87], v[184:187]
    ds_read_b64_tr_b16 a[196:197], v3 offset:32
    v_mfma_f32_16x16x32_bf16 v[196:199], a[236:239], a[84:87], v[196:199]
    ds_read_b64_tr_b16 a[198:199], v3 offset:4256
    v_mfma_f32_16x16x32_bf16 v[208:211], a[240:243], a[84:87], v[208:211]
    ds_read_b64_tr_b16 a[200:201], v3 offset:256
    v_mfma_f32_16x16x32_bf16 v[220:223], a[244:247], a[84:87], v[220:223]
    ds_read_b64_tr_b16 a[202:203], v3 offset:4480
    v_mfma_f32_16x16x32_bf16 v[232:235], a[248:251], a[84:87], v[232:235]
    ds_read_b64_tr_b16 a[204:205], v3 offset:288
    v_mfma_f32_16x16x32_bf16 v[244:247], a[252:255], a[84:87], v[244:247]
    ds_read_b64_tr_b16 a[206:207], v3 offset:4512
    v_mfma_f32_16x16x32_bf16 v[164:167], a[224:227], a[88:91], v[164:167]
    buffer_load_dwordx4 a[84:87], v1, s[4:7], s24 offen offset:3072
    v_mfma_f32_16x16x32_bf16 v[176:179], a[228:231], a[88:91], v[176:179]
    ds_read_b64_tr_b16 a[208:209], v3 offset:512
    v_mfma_f32_16x16x32_bf16 v[188:191], a[232:235], a[88:91], v[188:191]
    ds_read_b64_tr_b16 a[210:211], v3 offset:4736
    v_mfma_f32_16x16x32_bf16 v[200:203], a[236:239], a[88:91], v[200:203]
    ds_read_b64_tr_b16 a[212:213], v3 offset:544
    v_mfma_f32_16x16x32_bf16 v[212:215], a[240:243], a[88:91], v[212:215]
    ds_read_b64_tr_b16 a[214:215], v3 offset:4768
    v_mfma_f32_16x16x32_bf16 v[224:227], a[244:247], a[88:91], v[224:227]
    ds_read_b64_tr_b16 a[216:217], v3 offset:768
    v_mfma_f32_16x16x32_bf16 v[236:239], a[248:251], a[88:91], v[236:239]
    ds_read_b64_tr_b16 a[218:219], v3 offset:4992
    v_mfma_f32_16x16x32_bf16 v[248:251], a[252:255], a[88:91], v[248:251]
    ds_read_b64_tr_b16 a[220:221], v3 offset:800
    v_mfma_f32_16x16x32_bf16 v[168:171], a[224:227], a[92:95], v[168:171]
    buffer_load_dwordx4 a[88:91], v1, s[4:7], s25 offen offset:3072
    v_mfma_f32_16x16x32_bf16 v[180:183], a[228:231], a[92:95], v[180:183]
    ds_read_b64_tr_b16 a[222:223], v3 offset:5024
    v_mfma_f32_16x16x32_bf16 v[192:195], a[232:235], a[92:95], v[192:195]
    s_add_u32 m0, s28, 59136
    v_mfma_f32_16x16x32_bf16 v[204:207], a[236:239], a[92:95], v[204:207]
    s_add_u32 s27, s42, 229376
    buffer_load_dwordx4 v2, s[16:19], s27 offen lds
    v_mfma_f32_16x16x32_bf16 v[216:219], a[240:243], a[92:95], v[216:219]
    s_add_u32 m0, s28, 60192
    v_mfma_f32_16x16x32_bf16 v[228:231], a[244:247], a[92:95], v[228:231]
    s_add_u32 s27, s42, 233472
    v_mfma_f32_16x16x32_bf16 v[240:243], a[248:251], a[92:95], v[240:243]
    buffer_load_dwordx4 v2, s[16:19], s27 offen lds
    v_mfma_f32_16x16x32_bf16 v[252:255], a[252:255], a[92:95], v[252:255]
    buffer_load_dwordx4 a[92:95], v1, s[4:7], s26 offen offset:3072
    s_add_u32 s43, s43, 1
    s_cmp_lt_u32 s43, 4
    s_cbranch_scc1 B_LOOP
    s_waitcnt lgkmcnt(0)
    s_nop 9
    s_cmp_lg_u32 s60, 0
    s_cbranch_scc1 B_KH1
    s_cmp_eq_u32 s67, 1
    s_mov_b32 s57, 0
    s_cbranch_scc1 B_FAST0
    s_add_u32 s58, s57, 0
    buffer_store_dwordx4 v[208:211], v5, s[20:23], s58 offen offset:0 sc0 sc1
    buffer_store_dwordx4 v[220:223], v5, s[20:23], s58 offen offset:1024 sc0 sc1
    buffer_store_dwordx4 v[232:235], v5, s[20:23], s58 offen offset:2048 sc0 sc1
    buffer_store_dwordx4 v[244:247], v5, s[20:23], s58 offen offset:3072 sc0 sc1
    s_add_u32 s58, s57, 4096
    buffer_store_dwordx4 v[212:215], v5, s[20:23], s58 offen offset:0 sc0 sc1
    buffer_store_dwordx4 v[224:227], v5, s[20:23], s58 offen offset:1024 sc0 sc1
    buffer_store_dwordx4 v[236:239], v5, s[20:23], s58 offen offset:2048 sc0 sc1
    buffer_store_dwordx4 v[248:251], v5, s[20:23], s58 offen offset:3072 sc0 sc1
    s_add_u32 s58, s57, 8192
    buffer_store_dwordx4 v[216:219], v5, s[20:23], s58 offen offset:0 sc0 sc1
    buffer_store_dwordx4 v[228:231], v5, s[20:23], s58 offen offset:1024 sc0 sc1
    buffer_store_dwordx4 v[240:243], v5, s[20:23], s58 offen offset:2048 sc0 sc1
    buffer_store_dwordx4 v[252:255], v5, s[20:23], s58 offen offset:3072 sc0 sc1
    s_branch B_SENT0
B_FAST0:
    s_add_u32 s58, s57, 0
    buffer_store_dwordx4 v[208:211], v5, s[20:23], s58 offen offset:0
    buffer_store_dwordx4 v[220:223], v5, s[20:23], s58 offen offset:1024
    buffer_store_dwordx4 v[232:235], v5, s[20:23], s58 offen offset:2048
    buffer_store_dwordx4 v[244:247], v5, s[20:23], s58 offen offset:3072
    s_add_u32 s58, s57, 4096
    buffer_store_dwordx4 v[212:215], v5, s[20:23], s58 offen offset:0
    buffer_store_dwordx4 v[224:227], v5, s[20:23], s58 offen offset:1024
    buffer_store_dwordx4 v[236:239], v5, s[20:23], s58 offen offset:2048
    buffer_store_dwordx4 v[248:251], v5, s[20:23], s58 offen offset:3072
    s_add_u32 s58, s57, 8192
    buffer_store_dwordx4 v[216:219], v5, s[20:23], s58 offen offset:0
    buffer_store_dwordx4 v[228:231], v5, s[20:23], s58 offen offset:1024
    buffer_store_dwordx4 v[240:243], v5, s[20:23], s58 offen offset:2048
    buffer_store_dwordx4 v[252:255], v5, s[20:23], s58 offen offset:3072
B_SENT0:
    s_waitcnt vmcnt(0)
    s_barrier
    s_lshl_b32 s58, s2, 7
    v_mov_b32 v12, s58
    v_mov_b32 v13, 1
    s_cmp_lg_u32 s29, 0
    s_cbranch_scc1 B_POLLED0
    s_cmp_eq_u32 s67, 1
    s_cbranch_scc1 B_FF0
    buffer_store_dword v13, v12, s[68:71], 0 offen offset:64 sc0 sc1
    s_branch B_FD0
B_FF0:
    buffer_store_dword v13, v12, s[68:71], 0 offen offset:64
B_FD0:
    s_mov_b32 s57, 0
B_POLL0:
    buffer_load_dword v15, v7, s[68:71], 0 offen offset:64 sc1
    s_waitcnt vmcnt(0)
    v_readfirstlane_b32 s58, v15
    s_add_u32 s57, s57, 1
    s_nop 2
    s_cmp_lg_u32 s58, 0
    s_cbranch_scc1 B_POLLED0
    s_cmp_lt_u32 s57, 0x40000
    s_cbranch_scc1 B_POLL0
B_POLLED0:
    s_barrier
    s_nop 9
    s_mov_b32 s57, 49152
    s_add_u32 s58, s57, 0
    buffer_load_dwordx4 v[16:19], v5, s[20:23], s58 offen offset:0 nt
    buffer_load_dwordx4 v[20:23], v5, s[20:23], s58 offen offset:1024 nt
    buffer_load_dwordx4 v[24:27], v5, s[20:23], s58 offen offset:2048 nt
    buffer_load_dwordx4 v[28:31], v5, s[20:23], s58 offen offset:3072 nt
    s_add_u32 s58, s57, 4096
    buffer_load_dwordx4 v[32:35], v5, s[20:23], s58 offen offset:0 nt
    buffer_load_dwordx4 v[36:39], v5, s[20:23], s58 offen offset:1024 nt
    buffer_load_dwordx4 v[40:43], v5, s[20:23], s58 offen offset:2048 nt
    buffer_load_dwordx4 v[44:47], v5, s[20:23], s58 offen offset:3072 nt
    s_add_u32 s58, s57, 8192
    buffer_load_dwordx4 v[48:51], v5, s[20:23], s58 offen offset:0 nt
    buffer_load_dwordx4 v[52:55], v5, s[20:23], s58 offen offset:1024 nt
    buffer_load_dwordx4 v[56:59], v5, s[20:23], s58 offen offset:2048 nt
    buffer_load_dwordx4 v[60:63], v5, s[20:23], s58 offen offset:3072 nt
    s_mov_b32 s40, 0
    s_waitcnt vmcnt(11)
    v_add_f32 v160, v160, v16
    v_add_f32 v161, v161, v17
    v_add_f32 v162, v162, v18
    v_add_f32 v163, v163, v19
    v_cvt_pk_bf16_f32 v64, v160, v161
    v_cvt_pk_bf16_f32 v65, v162, v163
    buffer_store_dwordx2 v[64:65], v4, s[12:15], s40 offen offset:0
    s_waitcnt vmcnt(11)
    v_add_f32 v172, v172, v20
    v_add_f32 v173, v173, v21
    v_add_f32 v174, v174, v22
    v_add_f32 v175, v175, v23
    v_cvt_pk_bf16_f32 v66, v172, v173
    v_cvt_pk_bf16_f32 v67, v174, v175
    buffer_store_dwordx2 v[66:67], v4, s[12:15], s40 offen offset:32
    s_waitcnt vmcnt(11)
    v_add_f32 v184, v184, v24
    v_add_f32 v185, v185, v25
    v_add_f32 v186, v186, v26
    v_add_f32 v187, v187, v27
    v_cvt_pk_bf16_f32 v68, v184, v185
    v_cvt_pk_bf16_f32 v69, v186, v187
    buffer_store_dwordx2 v[68:69], v4, s[12:15], s40 offen offset:64
    s_waitcnt vmcnt(11)
    v_add_f32 v196, v196, v28
    v_add_f32 v197, v197, v29
    v_add_f32 v198, v198, v30
    v_add_f32 v199, v199, v31
    v_cvt_pk_bf16_f32 v70, v196, v197
    v_cvt_pk_bf16_f32 v71, v198, v199
    buffer_store_dwordx2 v[70:71], v4, s[12:15], s40 offen offset:96
    s_mov_b32 s40, 32768
    s_waitcnt vmcnt(11)
    v_add_f32 v164, v164, v32
    v_add_f32 v165, v165, v33
    v_add_f32 v166, v166, v34
    v_add_f32 v167, v167, v35
    v_cvt_pk_bf16_f32 v72, v164, v165
    v_cvt_pk_bf16_f32 v73, v166, v167
    buffer_store_dwordx2 v[72:73], v4, s[12:15], s40 offen offset:0
    s_waitcnt vmcnt(11)
    v_add_f32 v176, v176, v36
    v_add_f32 v177, v177, v37
    v_add_f32 v178, v178, v38
    v_add_f32 v179, v179, v39
    v_cvt_pk_bf16_f32 v74, v176, v177
    v_cvt_pk_bf16_f32 v75, v178, v179
    buffer_store_dwordx2 v[74:75], v4, s[12:15], s40 offen offset:32
    s_waitcnt vmcnt(11)
    v_add_f32 v188, v188, v40
    v_add_f32 v189, v189, v41
    v_add_f32 v190, v190, v42
    v_add_f32 v191, v191, v43
    v_cvt_pk_bf16_f32 v76, v188, v189
    v_cvt_pk_bf16_f32 v77, v190, v191
    buffer_store_dwordx2 v[76:77], v4, s[12:15], s40 offen offset:64
    s_waitcnt vmcnt(11)
    v_add_f32 v200, v200, v44
    v_add_f32 v201, v201, v45
    v_add_f32 v202, v202, v46
    v_add_f32 v203, v203, v47
    v_cvt_pk_bf16_f32 v78, v200, v201
    v_cvt_pk_bf16_f32 v79, v202, v203
    buffer_store_dwordx2 v[78:79], v4, s[12:15], s40 offen offset:96
    s_mov_b32 s40, 65536
    s_waitcnt vmcnt(11)
    v_add_f32 v168, v168, v48
    v_add_f32 v169, v169, v49
    v_add_f32 v170, v170, v50
    v_add_f32 v171, v171, v51
    v_cvt_pk_bf16_f32 v80, v168, v169
    v_cvt_pk_bf16_f32 v81, v170, v171
    buffer_store_dwordx2 v[80:81], v4, s[12:15], s40 offen offset:0
    s_waitcnt vmcnt(11)
    v_add_f32 v180, v180, v52
    v_add_f32 v181, v181, v53
    v_add_f32 v182, v182, v54
    v_add_f32 v183, v183, v55
    v_cvt_pk_bf16_f32 v82, v180, v181
    v_cvt_pk_bf16_f32 v83, v182, v183
    buffer_store_dwordx2 v[82:83], v4, s[12:15], s40 offen offset:32
    s_waitcnt vmcnt(11)
    v_add_f32 v192, v192, v56
    v_add_f32 v193, v193, v57
    v_add_f32 v194, v194, v58
    v_add_f32 v195, v195, v59
    v_cvt_pk_bf16_f32 v84, v192, v193
    v_cvt_pk_bf16_f32 v85, v194, v195
    buffer_store_dwordx2 v[84:85], v4, s[12:15], s40 offen offset:64
    s_waitcnt vmcnt(11)
    v_add_f32 v204, v204, v60
    v_add_f32 v205, v205, v61
    v_add_f32 v206, v206, v62
    v_add_f32 v207, v207, v63
    v_cvt_pk_bf16_f32 v86, v204, v205
    v_cvt_pk_bf16_f32 v87, v206, v207
    buffer_store_dwordx2 v[86:87], v4, s[12:15], s40 offen offset:96
    s_branch B_FIN
B_KH1:
    s_nop 9
    s_cmp_eq_u32 s67, 1
    s_mov_b32 s57, 49152
    s_cbranch_scc1 B_FAST1
    s_add_u32 s58, s57, 0
    buffer_store_dwordx4 v[160:163], v5, s[20:23], s58 offen offset:0 sc0 sc1
    buffer_store_dwordx4 v[172:175], v5, s[20:23], s58 offen offset:1024 sc0 sc1
    buffer_store_dwordx4 v[184:187], v5, s[20:23], s58 offen offset:2048 sc0 sc1
    buffer_store_dwordx4 v[196:199], v5, s[20:23], s58 offen offset:3072 sc0 sc1
    s_add_u32 s58, s57, 4096
    buffer_store_dwordx4 v[164:167], v5, s[20:23], s58 offen offset:0 sc0 sc1
    buffer_store_dwordx4 v[176:179], v5, s[20:23], s58 offen offset:1024 sc0 sc1
    buffer_store_dwordx4 v[188:191], v5, s[20:23], s58 offen offset:2048 sc0 sc1
    buffer_store_dwordx4 v[200:203], v5, s[20:23], s58 offen offset:3072 sc0 sc1
    s_add_u32 s58, s57, 8192
    buffer_store_dwordx4 v[168:171], v5, s[20:23], s58 offen offset:0 sc0 sc1
    buffer_store_dwordx4 v[180:183], v5, s[20:23], s58 offen offset:1024 sc0 sc1
    buffer_store_dwordx4 v[192:195], v5, s[20:23], s58 offen offset:2048 sc0 sc1
    buffer_store_dwordx4 v[204:207], v5, s[20:23], s58 offen offset:3072 sc0 sc1
    s_branch B_SENT1
B_FAST1:
    s_add_u32 s58, s57, 0
    buffer_store_dwordx4 v[160:163], v5, s[20:23], s58 offen offset:0
    buffer_store_dwordx4 v[172:175], v5, s[20:23], s58 offen offset:1024
    buffer_store_dwordx4 v[184:187], v5, s[20:23], s58 offen offset:2048
    buffer_store_dwordx4 v[196:199], v5, s[20:23], s58 offen offset:3072
    s_add_u32 s58, s57, 4096
    buffer_store_dwordx4 v[164:167], v5, s[20:23], s58 offen offset:0
    buffer_store_dwordx4 v[176:179], v5, s[20:23], s58 offen offset:1024
    buffer_store_dwordx4 v[188:191], v5, s[20:23], s58 offen offset:2048
    buffer_store_dwordx4 v[200:203], v5, s[20:23], s58 offen offset:3072
    s_add_u32 s58, s57, 8192
    buffer_store_dwordx4 v[168:171], v5, s[20:23], s58 offen offset:0
    buffer_store_dwordx4 v[180:183], v5, s[20:23], s58 offen offset:1024
    buffer_store_dwordx4 v[192:195], v5, s[20:23], s58 offen offset:2048
    buffer_store_dwordx4 v[204:207], v5, s[20:23], s58 offen offset:3072
B_SENT1:
    s_waitcnt vmcnt(0)
    s_barrier
    s_lshl_b32 s58, s2, 7
    v_mov_b32 v12, s58
    v_mov_b32 v13, 1
    s_cmp_lg_u32 s29, 0
    s_cbranch_scc1 B_POLLED1
    s_cmp_eq_u32 s67, 1
    s_cbranch_scc1 B_FF1
    buffer_store_dword v13, v12, s[68:71], 0 offen offset:64 sc0 sc1
    s_branch B_FD1
B_FF1:
    buffer_store_dword v13, v12, s[68:71], 0 offen offset:64
B_FD1:
    s_mov_b32 s57, 0
B_POLL1:
    buffer_load_dword v15, v7, s[68:71], 0 offen offset:64 sc1
    s_waitcnt vmcnt(0)
    v_readfirstlane_b32 s58, v15
    s_add_u32 s57, s57, 1
    s_nop 2
    s_cmp_lg_u32 s58, 0
    s_cbranch_scc1 B_POLLED1
    s_cmp_lt_u32 s57, 0x40000
    s_cbranch_scc1 B_POLL1
B_POLLED1:
    s_barrier
    s_nop 9
    s_mov_b32 s57, 0
    s_add_u32 s58, s57, 0
    buffer_load_dwordx4 v[16:19], v5, s[20:23], s58 offen offset:0 nt
    buffer_load_dwordx4 v[20:23], v5, s[20:23], s58 offen offset:1024 nt
    buffer_load_dwordx4 v[24:27], v5, s[20:23], s58 offen offset:2048 nt
    buffer_load_dwordx4 v[28:31], v5, s[20:23], s58 offen offset:3072 nt
    s_add_u32 s58, s57, 4096
    buffer_load_dwordx4 v[32:35], v5, s[20:23], s58 offen offset:0 nt
    buffer_load_dwordx4 v[36:39], v5, s[20:23], s58 offen offset:1024 nt
    buffer_load_dwordx4 v[40:43], v5, s[20:23], s58 offen offset:2048 nt
    buffer_load_dwordx4 v[44:47], v5, s[20:23], s58 offen offset:3072 nt
    s_add_u32 s58, s57, 8192
    buffer_load_dwordx4 v[48:51], v5, s[20:23], s58 offen offset:0 nt
    buffer_load_dwordx4 v[52:55], v5, s[20:23], s58 offen offset:1024 nt
    buffer_load_dwordx4 v[56:59], v5, s[20:23], s58 offen offset:2048 nt
    buffer_load_dwordx4 v[60:63], v5, s[20:23], s58 offen offset:3072 nt
    s_mov_b32 s40, 0
    s_waitcnt vmcnt(11)
    v_add_f32 v208, v208, v16
    v_add_f32 v209, v209, v17
    v_add_f32 v210, v210, v18
    v_add_f32 v211, v211, v19
    v_cvt_pk_bf16_f32 v64, v208, v209
    v_cvt_pk_bf16_f32 v65, v210, v211
    buffer_store_dwordx2 v[64:65], v4, s[12:15], s40 offen offset:0
    s_waitcnt vmcnt(11)
    v_add_f32 v220, v220, v20
    v_add_f32 v221, v221, v21
    v_add_f32 v222, v222, v22
    v_add_f32 v223, v223, v23
    v_cvt_pk_bf16_f32 v66, v220, v221
    v_cvt_pk_bf16_f32 v67, v222, v223
    buffer_store_dwordx2 v[66:67], v4, s[12:15], s40 offen offset:32
    s_waitcnt vmcnt(11)
    v_add_f32 v232, v232, v24
    v_add_f32 v233, v233, v25
    v_add_f32 v234, v234, v26
    v_add_f32 v235, v235, v27
    v_cvt_pk_bf16_f32 v68, v232, v233
    v_cvt_pk_bf16_f32 v69, v234, v235
    buffer_store_dwordx2 v[68:69], v4, s[12:15], s40 offen offset:64
    s_waitcnt vmcnt(11)
    v_add_f32 v244, v244, v28
    v_add_f32 v245, v245, v29
    v_add_f32 v246, v246, v30
    v_add_f32 v247, v247, v31
    v_cvt_pk_bf16_f32 v70, v244, v245
    v_cvt_pk_bf16_f32 v71, v246, v247
    buffer_store_dwordx2 v[70:71], v4, s[12:15], s40 offen offset:96
    s_mov_b32 s40, 32768
    s_waitcnt vmcnt(11)
    v_add_f32 v212, v212, v32
    v_add_f32 v213, v213, v33
    v_add_f32 v214, v214, v34
    v_add_f32 v215, v215, v35
    v_cvt_pk_bf16_f32 v72, v212, v213
    v_cvt_pk_bf16_f32 v73, v214, v215
    buffer_store_dwordx2 v[72:73], v4, s[12:15], s40 offen offset:0
    s_waitcnt vmcnt(11)
    v_add_f32 v224, v224, v36
    v_add_f32 v225, v225, v37
    v_add_f32 v226, v226, v38
    v_add_f32 v227, v227, v39
    v_cvt_pk_bf16_f32 v74, v224, v225
    v_cvt_pk_bf16_f32 v75, v226, v227
    buffer_store_dwordx2 v[74:75], v4, s[12:15], s40 offen offset:32
    s_waitcnt vmcnt(11)
    v_add_f32 v236, v236, v40
    v_add_f32 v237, v237, v41
    v_add_f32 v238, v238, v42
    v_add_f32 v239, v239, v43
    v_cvt_pk_bf16_f32 v76, v236, v237
    v_cvt_pk_bf16_f32 v77, v238, v239
    buffer_store_dwordx2 v[76:77], v4, s[12:15], s40 offen offset:64
    s_waitcnt vmcnt(11)
    v_add_f32 v248, v248, v44
    v_add_f32 v249, v249, v45
    v_add_f32 v250, v250, v46
    v_add_f32 v251, v251, v47
    v_cvt_pk_bf16_f32 v78, v248, v249
    v_cvt_pk_bf16_f32 v79, v250, v251
    buffer_store_dwordx2 v[78:79], v4, s[12:15], s40 offen offset:96
    s_mov_b32 s40, 65536
    s_waitcnt vmcnt(11)
    v_add_f32 v216, v216, v48
    v_add_f32 v217, v217, v49
    v_add_f32 v218, v218, v50
    v_add_f32 v219, v219, v51
    v_cvt_pk_bf16_f32 v80, v216, v217
    v_cvt_pk_bf16_f32 v81, v218, v219
    buffer_store_dwordx2 v[80:81], v4, s[12:15], s40 offen offset:0
    s_waitcnt vmcnt(11)
    v_add_f32 v228, v228, v52
    v_add_f32 v229, v229, v53
    v_add_f32 v230, v230, v54
    v_add_f32 v231, v231, v55
    v_cvt_pk_bf16_f32 v82, v228, v229
    v_cvt_pk_bf16_f32 v83, v230, v231
    buffer_store_dwordx2 v[82:83], v4, s[12:15], s40 offen offset:32
    s_waitcnt vmcnt(11)
    v_add_f32 v240, v240, v56
    v_add_f32 v241, v241, v57
    v_add_f32 v242, v242, v58
    v_add_f32 v243, v243, v59
    v_cvt_pk_bf16_f32 v84, v240, v241
    v_cvt_pk_bf16_f32 v85, v242, v243
    buffer_store_dwordx2 v[84:85], v4, s[12:15], s40 offen offset:64
    s_waitcnt vmcnt(11)
    v_add_f32 v252, v252, v60
    v_add_f32 v253, v253, v61
    v_add_f32 v254, v254, v62
    v_add_f32 v255, v255, v63
    v_cvt_pk_bf16_f32 v86, v252, v253
    v_cvt_pk_bf16_f32 v87, v254, v255
    buffer_store_dwordx2 v[86:87], v4, s[12:15], s40 offen offset:96
B_FIN:
A_EXIT:
    s_endpgm
A_CODE_END:
.section .rodata,"a"
.p2align 6
.amdhsa_kernel concat_heads__mha_block_cached__mha_block_cached__near_ridge_kernel
  .amdhsa_next_free_vgpr 512
  .amdhsa_next_free_sgpr 102
  .amdhsa_accum_offset 256
  .amdhsa_group_segment_fixed_size 0
  .amdhsa_kernarg_size 104
  .amdhsa_user_sgpr_count 2
  .amdhsa_user_sgpr_kernarg_segment_ptr 1
  .amdhsa_system_sgpr_workgroup_id_x 1
  .amdhsa_float_denorm_mode_32 3
  .amdhsa_float_denorm_mode_16_64 3
.end_amdhsa_kernel
.text
```
